```python
import torch

def _softmax(x, axis=-1):
    return torch.softmax(x, dim=axis)
def _gelu(x):
    return torch.nn.functional.gelu(x, approximate="tanh")
def _silu(x):
    return torch.nn.functional.silu(x)
def _sigmoid(x):
    return torch.sigmoid(x)
def _layernorm(x, axis=-1, eps=1e-5):
    m = x.mean(dim=axis, keepdim=True)
    v = x.var(dim=axis, keepdim=True, unbiased=False)
    return (x - m) / torch.sqrt(v + eps)
def _scatter_add(tgt, idx, src, axis=0):
    return tgt.clone().index_add_(axis, idx, src)
def _segment_sum(src, seg, n):
    out = torch.zeros((n,) + src.shape[1:], dtype=src.dtype)
    return out.index_add_(0, seg, src)
def _pad(x, pw):
    flat = tuple(v for pair in reversed(pw) for v in pair)
    return torch.nn.functional.pad(x, flat)

kernel_name = 'standalone__modern_conv_block_slak__vision'

def setup_inputs():

    _w = (lambda a: (lambda t: t.to(torch.bfloat16) if t.is_floating_point() else t)(torch.as_tensor(a)))
    H = W = 224
    C = 96
    K = 3
    return {
        "x": _w((lambda *s: torch.randn(*s, dtype=torch.bfloat16) * 0.05)(1, H, W, C)),
        "dw": _w((lambda *s: torch.randn(*s, dtype=torch.bfloat16) * 0.05)(K, K, C)),
        "w1": _w((lambda *s: torch.randn(*s, dtype=torch.bfloat16) * 0.05)(C, 4 * C)),
        "w2": _w((lambda *s: torch.randn(*s, dtype=torch.bfloat16) * 0.05)(4 * C, C)),
        "grn_g": _w((lambda *s: torch.randn(*s, dtype=torch.bfloat16) * 0.05)(4 * C)),
        "grn_b": _w((lambda *s: torch.randn(*s, dtype=torch.bfloat16) * 0.05)(4 * C)),
    }

def reference(x, dw, w1, w2, grn_g, grn_b):
    B, H, W, C = x.shape
    K = dw.shape[0]
    pad = K // 2
    xp = _pad(x, ((0,0),(pad,pad),(pad,pad),(0,0)))
    out = torch.zeros_like(x)
    for i in range(K):
        for j in range(K):
            out = out + xp[:, i:i+H, j:j+W, :] * dw[i, j][None, None, None, :]
    h = _layernorm(out, axis=-1)
    h = _gelu(h @ w1)
    gx = torch.sqrt((h * h).sum(axis=(1, 2), keepdims=True) + 1e-6)
    nx = gx / (gx.mean(axis=-1, keepdims=True) + 1e-6)
    h = grn_g[None, None, None, :] * (h * nx) + grn_b[None, None, None, :] + h
    return x + h @ w2
```

```asm
; @launch grid=(256,1,1) block=(256,1,1) lds=163840
.amdgcn_target "amdgcn-amd-amdhsa--gfx950"
.text
.p2align 12
.globl standalone__modern_conv_block_slak__vision_kernel
.p2align 8
.type standalone__modern_conv_block_slak__vision_kernel,@function
standalone__modern_conv_block_slak__vision_kernel:
    s_cmp_ge_u32 s2, 256
    s_cbranch_scc1 L_END
    s_load_dwordx2 s[4:5], s[0:1], 0
    s_load_dwordx2 s[12:13], s[0:1], 8
    s_getpc_b64 s[66:67]
L_PC:
    v_lshrrev_b32 v1, 4, v0
    v_and_or_b32 v1, v0, 3, v1
    s_lshr_b32 s47, s2, 3
    s_and_b32 s47, s47, 31
    s_lshl_b32 s47, s47, 7
    v_lshl_add_u32 v1, v1, 12, s47
    v_min_u32 v1, L_TABLE-L_PC+28668, v1
    s_mov_b64 exec, 0xf
    global_load_dword a202, v1, s[66:67]
    s_mov_b64 exec, -1
    v_lshrrev_b32 v1, 6, v0
    v_lshlrev_b32 v3, 1, v0
    v_and_b32 v0, 63, v0
    v_readfirstlane_b32 s44, v1
    s_and_b32 s47, s2, 1
    s_lshl_b32 s47, s47, 3
    s_bfe_u32 s48, s2, 0x30003
    s_add_u32 s47, s47, s48
    s_mul_i32 s46, s47, 14
    s_cmp_eq_u32 s47, 0
    s_cselect_b32 s49, 12, 0
    s_cmp_eq_u32 s47, 15
    s_cselect_b32 s50, 52, 64
    s_mul_i32 s48, s46, 192
    s_add_u32 s48, s48, 320
    v_bfrev_b32 v8, 1
    v_mul_u32_u24 v9, 5462, v0
    v_lshl_add_u32 v10, v0, 4, s48
    v_cmp_le_u32 s[62:63], s49, v0
    v_cmp_gt_u32 s[64:65], s50, v0
    s_and_b32 s47, s2, 6
    s_lshl_b32 s47, s47, 1
    s_lshr_b32 s48, s2, 6
    s_add_u32 s47, s47, s48
    s_mul_i32 s45, s47, 14
    v_lshrrev_b32_e64 v11, 16, v9
    v_bfe_u32 v12, v9, 18, 2
    v_mad_i32_i24 v11, v11, -12, v0
    v_add_u32_e64 v11, 0, v11
    v_xor_b32_e64 v12, v11, v12
    v_sub_u32_e64 v11, v12, v11
    v_lshl_add_u32 v24, v11, 4, v10
    v_cndmask_b32 v24, v8, v24, s[62:63]
    v_add_u32 v9, 349568, v9
    v_lshrrev_b32_e64 v11, 16, v9
    v_bfe_u32 v12, v9, 18, 2
    v_mad_i32_i24 v11, v11, -12, v0
    v_add_u32_e64 v11, 64, v11
    v_xor_b32_e64 v12, v11, v12
    v_sub_u32_e64 v11, v12, v11
    v_lshl_add_u32 v25, v11, 4, v10
    v_add_u32 v9, 349568, v9
    v_lshrrev_b32_e64 v11, 16, v9
    v_bfe_u32 v12, v9, 18, 2
    v_mad_i32_i24 v11, v11, -12, v0
    v_add_u32 v11, 128, v11
    v_xor_b32_e64 v12, v11, v12
    v_sub_u32_e64 v11, v12, v11
    v_lshl_add_u32 v26, v11, 4, v10
    v_cndmask_b32 v26, v8, v26, s[64:65]
    s_mov_b32 s7, 0x20000
    s_movk_i32 s14, 1728
    s_mov_b32 s15, 0x20000
    s_add_u32 s68, s44, s45
    s_sub_u32 s68, s68, 1
    s_mul_i32 s69, s68, 43008
    s_mul_i32 s70, s44, 3072
    s_add_u32 s70, s70, 73728
    s_waitcnt lgkmcnt(0)
    buffer_load_ushort v56, v3, s[12:15], 0 offen offset:0
    buffer_load_ushort v57, v3, s[12:15], 0 offen offset:512
    buffer_load_ushort v58, v3, s[12:15], 0 offen offset:1024
    buffer_load_ushort v59, v3, s[12:15], 0 offen offset:1536
    s_sub_u32 s4, s4, 512
    s_subb_u32 s5, s5, 0
    s_load_dwordx2 s[16:17], s[0:1], 16
    s_load_dwordx2 s[20:21], s[0:1], 24
    s_load_dwordx2 s[40:41], s[0:1], 64
    s_load_dwordx2 s[36:37], s[0:1], 56
    s_load_dwordx2 s[24:25], s[0:1], 32
    s_load_dwordx2 s[28:29], s[0:1], 40
    s_load_dwordx2 s[32:33], s[0:1], 48
    s_mov_b32 m0, s70
    s_cmp_lt_u32 s68, 224
    s_cselect_b32 s6, 9634304, 0
    buffer_load_dwordx4 v24, s[4:7], s69 offen offset:0 lds
    buffer_load_dwordx4 v25, s[4:7], s69 offen offset:1024 lds
    buffer_load_dwordx4 v26, s[4:7], s69 offen offset:2048 lds
    s_add_u32 s68, s68, 4
    s_add_u32 s69, s69, 172032
    s_add_u32 s70, s70, 12288
    s_mov_b32 m0, s70
    s_cmp_lt_u32 s68, 224
    s_cselect_b32 s6, 9634304, 0
    buffer_load_dwordx4 v24, s[4:7], s69 offen offset:0 lds
    buffer_load_dwordx4 v25, s[4:7], s69 offen offset:1024 lds
    buffer_load_dwordx4 v26, s[4:7], s69 offen offset:2048 lds
    v_mov_b32 v60, 0
    v_mov_b32 v61, 0
    v_mov_b32 v62, 0
    v_mov_b32 v63, 0
    v_lshrrev_b32_e64 v9, 4, v3
    v_mul_u32_u24 v9, 144, v9
    v_and_b32 v11, 7, v0
    v_lshl_add_u32 v9, v11, 4, v9
    v_add_u32 v52, 141312, v9
    v_cmp_lt_u32 vcc, 63, v3
    v_add_u32 v9, 192, v52
    s_cmp_ge_u32 s44, 1
    s_cselect_b64 s[62:63], -1, 0
    v_cndmask_b32_e64 v53, v52, v9, vcc
    v_cndmask_b32 v54, v52, v9, s[62:63]
    v_min_u32 v55, 143040, v52
    v_min_u32_e64 v9, 35, v0
    v_mul_u32_u24 v9, 144, v9
    v_add_u32 v9, 141440, v9
    ds_write_b128 v9, v[60:63]
    ds_write_b128 v52, v[60:63] offset:0
    ds_write_b128 v53, v[60:63] offset:4608
    ds_write_b128 v54, v[60:63] offset:9408
    ds_write_b128 v55, v[60:63] offset:14208
    v_lshlrev_b32_e64 v10, 3, v3
    v_add_u32 v9, 157696, v10
    v_min_u32 v13, 159728, v9
    v_lshl_add_u32 v52, v11, 1, v52
    v_lshl_add_u32 v53, v11, 1, v53
    v_lshl_add_u32 v54, v11, 1, v54
    v_lshl_add_u32 v55, v11, 1, v55
    ds_write_b128 v9, v[60:63]
    ds_write_b128 v13, v[60:63] offset:4096
    v_and_b32 v1, 15, v0
    v_lshrrev_b32 v2, 4, v0
    v_lshrrev_b32 v9, 3, v1
    v_sub_u32 v9, v2, v9
    v_cmp_gt_u32 vcc, 3, v9
    v_mul_u32_u24 v9, 336, v9
    v_and_or_b32 v9, v0, 7, v9
    v_cndmask_b32 v9, 8, v9, vcc
    v_lshlrev_b32_e64 v9, 4, v9
    v_add_u32 v12, 141312, v9
    v_add_u32 v10, L_TABLE-L_PC+4096, v10
    v_add_u32 v17, 8192, v10
    s_mov_b32 s3, s2
    s_lshl_b32 s52, s3, 14
    s_add_u32 s55, s52, 0x1000
    s_add_u32 s56, s52, 0x2000
    s_add_u32 s57, s52, 0x3000
    s_sub_u32 s59, s3, 24
    s_cmp_lt_u32 s3, 24
    s_cbranch_scc1 L_CLEAR
    s_waitcnt vmcnt(6)
    ds_write_b16 v52, v56 offset:0
    ds_write_b16 v53, v57 offset:4608
    ds_write_b16 v54, v58 offset:9408
    ds_write_b16 v55, v59 offset:14208
    s_branch L_SCATTERED
L_CLEAR:
    s_mov_b32 s42, 426368
    s_mov_b32 s43, 0x20000
    v_lshlrev_b32 v9, 3, v3
    v_mov_b32 v64, -1
    v_mov_b32 v65, -1
    v_mov_b32 v66, -1
    v_mov_b32 v67, -1
    v_lshrrev_b32 v11, 4, v3
    v_lshlrev_b32 v11, 12, v11
    v_and_b32_e64 v13, 7, v0
    v_lshl_add_u32 v11, v13, 4, v11
    s_lshl_b32 s47, s3, 7
    s_add_u32 s47, s47, 393216
    s_cmp_lt_u32 s44, 1
    s_cselect_b64 vcc, -1, 0
    v_cndmask_b32 v11, v8, v11, vcc
    s_waitcnt lgkmcnt(0)
    buffer_store_dwordx4 v[64:67], v9, s[40:43], s52 offen sc1
    buffer_store_dwordx4 v[64:67], v9, s[40:43], s55 offen sc1
    buffer_store_dwordx4 v[64:67], v9, s[40:43], s56 offen sc1
    buffer_store_dwordx4 v[64:67], v9, s[40:43], s57 offen sc1
    buffer_store_dwordx4 v[64:67], v11, s[40:43], s47 offen sc1
    s_waitcnt vmcnt(11)
    ds_write_b16 v52, v56 offset:0
    ds_write_b16 v53, v57 offset:4608
    ds_write_b16 v54, v58 offset:9408
    ds_write_b16 v55, v59 offset:14208
L_SCATTERED:
    s_waitcnt lgkmcnt(0)
    s_barrier
    ds_read_b128 v[112:115], v12 offset:0
    ds_read_b128 v[116:119], v12 offset:144
    ds_read_b128 v[120:123], v12 offset:288
    ds_read_b128 v[124:127], v12 offset:432
    ds_read_b128 v[128:131], v12 offset:576
    ds_read_b128 v[132:135], v12 offset:720
    global_load_dwordx4 v[28:31], v10, s[66:67] offset:-4096
    ds_read_b128 v[136:139], v12 offset:864
    ds_read_b128 v[140:143], v12 offset:1008
    ds_read_b128 v[144:147], v12 offset:1152
    global_load_dwordx4 v[32:35], v10, s[66:67] offset:0
    ds_read_b128 v[148:151], v12 offset:1296
    ds_read_b128 v[152:155], v12 offset:1440
    ds_read_b128 v[156:159], v12 offset:1584
    global_load_dwordx4 v[36:39], v17, s[66:67] offset:-4096
    ds_read_b128 v[160:163], v12 offset:1728
    ds_read_b128 v[164:167], v12 offset:1872
    ds_read_b128 v[168:171], v12 offset:2016
    s_add_u32 s68, s68, 4
    s_add_u32 s69, s69, 172032
    s_add_u32 s70, s70, 12288
    s_mov_b32 m0, s70
    s_cmp_lt_u32 s68, 224
    s_cselect_b32 s6, 9634304, 0
    buffer_load_dwordx4 v24, s[4:7], s69 offen offset:0 lds
    ds_read_b128 v[172:175], v12 offset:2160
    ds_read_b128 v[176:179], v12 offset:2304
    ds_read_b128 v[180:183], v12 offset:2448
    buffer_load_dwordx4 v25, s[4:7], s69 offen offset:1024 lds
    ds_read_b128 v[184:187], v12 offset:2592
    ds_read_b128 v[188:191], v12 offset:2736
    ds_read_b128 v[192:195], v12 offset:2880
    buffer_load_dwordx4 v26, s[4:7], s69 offen offset:2048 lds
    ds_read_b128 v[196:199], v12 offset:3024
    ds_read_b128 v[200:203], v12 offset:3168
    ds_read_b128 v[204:207], v12 offset:3312
    s_mov_b64 exec, 0
    s_cmp_eq_u32 s44, 0
    s_cbranch_scc1 L_PAD0
    s_cmp_eq_u32 s44, 1
    s_cbranch_scc1 L_PAD1
    s_cmp_eq_u32 s44, 2
    s_cbranch_scc1 L_PAD2
    s_branch L_PAD3
L_BACKA:
    s_mov_b64 exec, -1
    s_add_u32 s68, s68, 4
    s_add_u32 s69, s69, 172032
    s_add_u32 s70, s70, 12288
    s_mov_b32 m0, s70
    s_cmp_lt_u32 s68, 224
    s_nop 0
    s_cselect_b32 s6, 9634304, 0
    buffer_load_dwordx4 v24, s[4:7], s69 offen offset:0 lds
    ds_read_b128 v[208:211], v12 offset:3456
    ds_read_b128 v[212:215], v12 offset:3600
    ds_read_b128 v[216:219], v12 offset:3744
    buffer_load_dwordx4 v25, s[4:7], s69 offen offset:1024 lds
    ds_read_b128 v[220:223], v12 offset:3888
    ds_read_b128 v[224:227], v12 offset:4032
    ds_read_b128 v[228:231], v12 offset:4176
    buffer_load_dwordx4 v26, s[4:7], s69 offen offset:2048 lds
    ds_read_b128 v[232:235], v12 offset:4320
    ds_read_b128 v[236:239], v12 offset:4464
    ds_read_b128 v[240:243], v12 offset:4608
    s_mov_b32 s18, 73728
    s_mov_b32 s19, 0x20000
    s_mov_b32 s22, 73728
    s_mov_b32 s23, 0x20000
    s_lshr_b32 s47, s2, 3
    s_lshl_b32 s47, s47, 2
    s_add_u32 s47, s47, s44
    s_mul_i32 s47, s47, 640
    v_lshl_add_u32 v9, v0, 7, s47
    s_mov_b64 exec, 31
    buffer_load_dword a200, v9, s[16:19], 0 offen
    buffer_load_dword a201, v9, s[20:23], 0 offen
    s_mov_b64 exec, -1
    s_nop 0
    s_mov_b32 s6, 9634304
    ds_read_b128 v[244:247], v12 offset:4752
    ds_read_b128 v[248:251], v12 offset:4896
    ds_read_b128 v[252:255], v12 offset:5040
    s_mul_i32 s47, s44, 6144
    s_add_u32 s47, s47, 73728
    v_mul_u32_u24 v9, 3072, v2
    v_mul_u32_u24 v11, 192, v1
    v_add3_u32 v9, v9, v11, s47
    v_lshrrev_b32 v11, 2, v1
    v_add_u32 v15, 16384, v10
    v_add_u32 v16, 24576, v10
    v_xor_b32 v13, 0, v11
    v_lshl_add_u32 v4, v13, 4, v9
    v_xor_b32 v13, 1, v11
    v_lshl_add_u32 v5, v13, 4, v9
    v_xor_b32 v13, 2, v11
    v_lshl_add_u32 v6, v13, 4, v9
    v_xor_b32_e64 v13, 3, v11
    v_lshl_add_u32 v7, v13, 4, v9
    v_add_u32 v11, 2, v1
    v_bfe_u32 v11, v11, 2, 2
    v_xor_b32 v13, 0, v11
    v_lshl_add_u32 v40, v13, 4, v9
    v_xor_b32_e64 v13, 1, v11
    v_lshl_add_u32 v41, v13, 4, v9
    v_xor_b32_e64 v13, 2, v11
    v_lshl_add_u32 v42, v13, 4, v9
    v_xor_b32_e64 v13, 3, v11
    v_lshl_add_u32 v43, v13, 4, v9
    s_mul_i32 s50, s44, 18432
    v_lshlrev_b32_e64 v10, 4, v0
    v_add_u32 v18, 122880, v10
    v_add_u32 v19, 73728, v10
    v_add_u32_e64 v14, s50, v10
    s_mov_b32 s60, 0xc09d30fc
    s_mov_b32 s61, 0xc09d30fc
    v_mov_b32_e64 v13, 1
    s_mov_b32 s64, 0x3fff3fff
    s_mov_b32 s65, 0x3fff3fff
    s_mov_b64 s[8:9], s[40:41]
    s_mov_b64 s[12:13], s[36:37]
    s_cmp_lt_u32 s3, 24
    s_cselect_b32 s10, 426368, 0
    s_cmp_lt_u32 s3, 48
    s_cselect_b32 s14, 256, 0
    s_mov_b32 s11, 0x20000
    s_lshl_b32 s53, s2, 6
    s_mul_i32 s51, s45, 224
    s_add_u32 s51, s51, s46
    s_mul_i32 s51, s51, 192
    s_and_b32 s58, s2, 3
    s_lshl_b32 s58, s58, 12
    s_add_u32 s58, s58, 393216
    s_mov_b32 s26, 768
    s_mov_b32 s27, 0x20000
    s_mov_b32 s30, 768
    s_mov_b32 s31, 0x20000
    s_mov_b32 s34, 9633792
    s_mov_b32 s35, 0x20000
    s_mov_b32 s38, 256
    s_mov_b32 s39, 0x20000
    s_mov_b32 s42, 426368
    s_mov_b32 s43, 0x20000
    s_waitcnt vmcnt(11)
    s_barrier
    s_cmp_eq_u32 s44, 3
    s_cbranch_scc1 L_WAVE3
    ds_read_b128 a[0:3], v4 offset:0
    ds_read_b128 a[4:7], v40 offset:384
    ds_read_b128 a[8:11], v5 offset:0
    ds_read_b128 a[12:15], v41 offset:384
    ds_read_b128 a[16:19], v6 offset:0
    ds_read_b128 a[20:23], v42 offset:384
    ds_read_b128 a[24:27], v7 offset:0
    ds_read_b128 a[28:31], v43 offset:384
    ds_read_b128 a[32:35], v4 offset:64
    ds_read_b128 a[36:39], v40 offset:448
    s_waitcnt lgkmcnt(6)
    v_mfma_f32_16x16x32_bf16 v[20:23], v[160:163], a[0:3], 0
    ds_read_b128 a[40:43], v5 offset:64
    v_mfma_f32_16x16x32_bf16 v[64:67], v[112:115], a[0:3], 0
    ds_read_b128 a[44:47], v41 offset:448
    v_mfma_f32_16x16x32_bf16 v[64:67], v[208:211], a[4:7], v[64:67]
    v_mfma_f32_16x16x32_bf16 v[24:27], v[164:167], a[8:11], 0
    ds_read_b128 a[48:51], v6 offset:64
    v_mfma_f32_16x16x32_bf16 v[68:71], v[116:119], a[8:11], 0
    ds_read_b128 a[52:55], v42 offset:448
    v_mfma_f32_16x16x32_bf16 v[68:71], v[212:215], a[12:15], v[68:71]
    s_waitcnt lgkmcnt(6)
    v_mfma_f32_16x16x32_bf16 v[44:47], v[168:171], a[16:19], 0
    ds_read_b128 a[56:59], v7 offset:64
    v_add_f32_dpp v64, v20, v64 row_shl:1 row_mask:0xf bank_mask:0xf
    v_mfma_f32_16x16x32_bf16 v[72:75], v[120:123], a[16:19], 0
    ds_read_b128 a[60:63], v43 offset:448
    v_add_f32_dpp v65, v21, v65 row_shl:1 row_mask:0xf bank_mask:0xf
    v_mfma_f32_16x16x32_bf16 v[72:75], v[216:219], a[20:23], v[72:75]
    v_add_f32_dpp v66, v22, v66 row_shl:1 row_mask:0xf bank_mask:0xf
    v_add_f32_dpp v67, v23, v67 row_shl:1 row_mask:0xf bank_mask:0xf
    v_mfma_f32_16x16x32_bf16 v[20:23], v[172:175], a[24:27], 0
    ds_read_b128 a[64:67], v4 offset:128
    v_add_f32_dpp v68, v24, v68 row_shl:1 row_mask:0xf bank_mask:0xf
    v_mfma_f32_16x16x32_bf16 v[76:79], v[124:127], a[24:27], 0
    ds_read_b128 a[68:71], v40 offset:512
    v_add_f32_dpp v69, v25, v69 row_shl:1 row_mask:0xf bank_mask:0xf
    v_mfma_f32_16x16x32_bf16 v[76:79], v[220:223], a[28:31], v[76:79]
    v_add_f32_dpp v70, v26, v70 row_shl:1 row_mask:0xf bank_mask:0xf
    v_add_f32_dpp v71, v27, v71 row_shl:1 row_mask:0xf bank_mask:0xf
    s_waitcnt lgkmcnt(6)
    v_mfma_f32_16x16x32_bf16 v[24:27], v[176:179], a[32:35], 0
    s_nop 0
    ds_read_b128 a[72:75], v5 offset:128
    v_add_f32_dpp v72, v44, v72 row_shl:1 row_mask:0xf bank_mask:0xf
    v_mfma_f32_16x16x32_bf16 v[80:83], v[128:131], a[32:35], 0
    ds_read_b128 a[76:79], v41 offset:512
    v_add_f32_dpp v73, v45, v73 row_shl:1 row_mask:0xf bank_mask:0xf
    v_mfma_f32_16x16x32_bf16 v[80:83], v[224:227], a[36:39], v[80:83]
    v_add_f32_dpp v74, v46, v74 row_shl:1 row_mask:0xf bank_mask:0xf
    v_add_f32_dpp v75, v47, v75 row_shl:1 row_mask:0xf bank_mask:0xf
    v_mfma_f32_16x16x32_bf16 v[44:47], v[180:183], a[40:43], 0
    ds_read_b128 a[80:83], v6 offset:128
    v_add_f32_dpp v76, v20, v76 row_shl:1 row_mask:0xf bank_mask:0xf
    v_mfma_f32_16x16x32_bf16 v[84:87], v[132:135], a[40:43], 0
    ds_read_b128 a[84:87], v42 offset:512
    v_add_f32_dpp v77, v21, v77 row_shl:1 row_mask:0xf bank_mask:0xf
    v_mfma_f32_16x16x32_bf16 v[84:87], v[228:231], a[44:47], v[84:87]
    v_add_f32_dpp v78, v22, v78 row_shl:1 row_mask:0xf bank_mask:0xf
    v_add_f32_dpp v79, v23, v79 row_shl:1 row_mask:0xf bank_mask:0xf
    s_waitcnt lgkmcnt(6)
    v_mfma_f32_16x16x32_bf16 v[20:23], v[184:187], a[48:51], 0
    ds_read_b128 a[88:91], v7 offset:128
    s_nop 0
    v_add_f32_dpp v80, v24, v80 row_shl:1 row_mask:0xf bank_mask:0xf
    v_mfma_f32_16x16x32_bf16 v[88:91], v[136:139], a[48:51], 0
    ds_read_b128 a[92:95], v43 offset:512
    v_add_f32_dpp v81, v25, v81 row_shl:1 row_mask:0xf bank_mask:0xf
    v_mfma_f32_16x16x32_bf16 v[88:91], v[232:235], a[52:55], v[88:91]
    v_add_f32_dpp v82, v26, v82 row_shl:1 row_mask:0xf bank_mask:0xf
    v_add_f32_dpp v83, v27, v83 row_shl:1 row_mask:0xf bank_mask:0xf
    v_mfma_f32_16x16x32_bf16 v[24:27], v[188:191], a[56:59], 0
    v_add_f32_dpp v84, v44, v84 row_shl:1 row_mask:0xf bank_mask:0xf
    v_add_f32_dpp v85, v45, v85 row_shl:1 row_mask:0xf bank_mask:0xf
    v_mfma_f32_16x16x32_bf16 v[92:95], v[140:143], a[56:59], 0
    v_add_f32_dpp v86, v46, v86 row_shl:1 row_mask:0xf bank_mask:0xf
    v_add_f32_dpp v87, v47, v87 row_shl:1 row_mask:0xf bank_mask:0xf
    v_mfma_f32_16x16x32_bf16 v[92:95], v[236:239], a[60:63], v[92:95]
    s_waitcnt lgkmcnt(4)
    v_mfma_f32_16x16x32_bf16 v[44:47], v[192:195], a[64:67], 0
    s_nop 0
    v_add_f32_dpp v88, v20, v88 row_shl:1 row_mask:0xf bank_mask:0xf
    v_add_f32_dpp v89, v21, v89 row_shl:1 row_mask:0xf bank_mask:0xf
    v_mfma_f32_16x16x32_bf16 v[96:99], v[144:147], a[64:67], 0
    v_add_f32_dpp v90, v22, v90 row_shl:1 row_mask:0xf bank_mask:0xf
    v_add_f32_dpp v91, v23, v91 row_shl:1 row_mask:0xf bank_mask:0xf
    v_mfma_f32_16x16x32_bf16 v[96:99], v[240:243], a[68:71], v[96:99]
    v_mfma_f32_16x16x32_bf16 v[20:23], v[196:199], a[72:75], 0
    v_add_f32_dpp v92, v24, v92 row_shl:1 row_mask:0xf bank_mask:0xf
    v_add_f32_dpp v93, v25, v93 row_shl:1 row_mask:0xf bank_mask:0xf
    v_mfma_f32_16x16x32_bf16 v[100:103], v[148:151], a[72:75], 0
    v_add_f32_dpp v94, v26, v94 row_shl:1 row_mask:0xf bank_mask:0xf
    v_add_f32_dpp v95, v27, v95 row_shl:1 row_mask:0xf bank_mask:0xf
    v_mfma_f32_16x16x32_bf16 v[100:103], v[244:247], a[76:79], v[100:103]
    s_waitcnt lgkmcnt(0)
    v_mfma_f32_16x16x32_bf16 v[24:27], v[200:203], a[80:83], 0
    v_add_f32_dpp v96, v44, v96 row_shl:1 row_mask:0xf bank_mask:0xf
    s_nop 0
    v_add_f32_dpp v97, v45, v97 row_shl:1 row_mask:0xf bank_mask:0xf
    v_mfma_f32_16x16x32_bf16 v[104:107], v[152:155], a[80:83], 0
    v_add_f32_dpp v98, v46, v98 row_shl:1 row_mask:0xf bank_mask:0xf
    v_add_f32_dpp v99, v47, v99 row_shl:1 row_mask:0xf bank_mask:0xf
    v_mfma_f32_16x16x32_bf16 v[104:107], v[248:251], a[84:87], v[104:107]
    v_mfma_f32_16x16x32_bf16 v[44:47], v[204:207], a[88:91], 0
    v_add_f32_dpp v100, v20, v100 row_shl:1 row_mask:0xf bank_mask:0xf
    v_add_f32_dpp v101, v21, v101 row_shl:1 row_mask:0xf bank_mask:0xf
    v_mfma_f32_16x16x32_bf16 v[108:111], v[156:159], a[88:91], 0
    v_add_f32_dpp v102, v22, v102 row_shl:1 row_mask:0xf bank_mask:0xf
    v_add_f32_dpp v103, v23, v103 row_shl:1 row_mask:0xf bank_mask:0xf
    v_mfma_f32_16x16x32_bf16 v[108:111], v[252:255], a[92:95], v[108:111]
    s_nop 0
    v_add_f32_dpp v104, v24, v104 row_shl:1 row_mask:0xf bank_mask:0xf
    v_add_f32_dpp v105, v25, v105 row_shl:1 row_mask:0xf bank_mask:0xf
    v_add_f32_dpp v106, v26, v106 row_shl:1 row_mask:0xf bank_mask:0xf
    v_add_f32_dpp v107, v27, v107 row_shl:1 row_mask:0xf bank_mask:0xf
    s_nop 2
    v_add_f32_dpp v108, v44, v108 row_shl:1 row_mask:0xf bank_mask:0xf
    v_add_f32_dpp v109, v45, v109 row_shl:1 row_mask:0xf bank_mask:0xf
    v_add_f32_dpp v110, v46, v110 row_shl:1 row_mask:0xf bank_mask:0xf
    v_add_f32_dpp v111, v47, v111 row_shl:1 row_mask:0xf bank_mask:0xf
    v_pk_add_f32 v[20:21], v[64:65], v[66:67]
    v_pk_mul_f32 v[22:23], v[64:65], v[64:65]
    v_pk_add_f32 v[24:25], v[68:69], v[70:71]
    v_pk_mul_f32 v[26:27], v[66:67], v[66:67]
    v_pk_fma_f32 v[22:23], v[68:69], v[68:69], v[22:23]
    v_pk_fma_f32 v[26:27], v[70:71], v[70:71], v[26:27]
    v_pk_add_f32 v[20:21], v[20:21], v[72:73]
    v_pk_fma_f32 v[22:23], v[72:73], v[72:73], v[22:23]
    v_pk_add_f32 v[24:25], v[24:25], v[74:75]
    v_pk_fma_f32 v[26:27], v[74:75], v[74:75], v[26:27]
    v_pk_add_f32 v[20:21], v[20:21], v[76:77]
    v_pk_fma_f32 v[22:23], v[76:77], v[76:77], v[22:23]
    v_pk_add_f32 v[24:25], v[24:25], v[78:79]
    v_pk_fma_f32 v[26:27], v[78:79], v[78:79], v[26:27]
    v_pk_add_f32 v[20:21], v[20:21], v[80:81]
    v_pk_fma_f32 v[22:23], v[80:81], v[80:81], v[22:23]
    v_pk_add_f32 v[24:25], v[24:25], v[82:83]
    v_pk_fma_f32 v[26:27], v[82:83], v[82:83], v[26:27]
    v_pk_add_f32 v[20:21], v[20:21], v[84:85]
    v_pk_fma_f32 v[22:23], v[84:85], v[84:85], v[22:23]
L_PAD0:
    s_cbranch_execz L_PAD4
    v_pk_add_f32 v[24:25], v[24:25], v[86:87]
    v_pk_fma_f32 v[26:27], v[86:87], v[86:87], v[26:27]
    s_nop 0
    v_pk_add_f32 v[20:21], v[20:21], v[88:89]
    v_pk_fma_f32 v[22:23], v[88:89], v[88:89], v[22:23]
    v_pk_add_f32 v[24:25], v[24:25], v[90:91]
    v_pk_fma_f32 v[26:27], v[90:91], v[90:91], v[26:27]
    v_pk_add_f32 v[20:21], v[20:21], v[92:93]
    v_pk_fma_f32 v[22:23], v[92:93], v[92:93], v[22:23]
    v_pk_add_f32 v[24:25], v[24:25], v[94:95]
    v_pk_fma_f32 v[26:27], v[94:95], v[94:95], v[26:27]
    v_pk_add_f32 v[20:21], v[20:21], v[96:97]
    v_pk_fma_f32 v[22:23], v[96:97], v[96:97], v[22:23]
    v_pk_add_f32 v[24:25], v[24:25], v[98:99]
    v_pk_fma_f32 v[26:27], v[98:99], v[98:99], v[26:27]
    v_pk_add_f32 v[20:21], v[20:21], v[100:101]
    v_pk_fma_f32 v[22:23], v[100:101], v[100:101], v[22:23]
    v_pk_add_f32 v[24:25], v[24:25], v[102:103]
    v_pk_fma_f32 v[26:27], v[102:103], v[102:103], v[26:27]
    v_pk_add_f32 v[20:21], v[20:21], v[104:105]
    v_pk_fma_f32 v[22:23], v[104:105], v[104:105], v[22:23]
    v_pk_add_f32 v[24:25], v[24:25], v[106:107]
    v_pk_fma_f32 v[26:27], v[106:107], v[106:107], v[26:27]
    v_pk_add_f32 v[20:21], v[20:21], v[108:109]
    v_pk_fma_f32 v[22:23], v[108:109], v[108:109], v[22:23]
    v_pk_add_f32 v[24:25], v[24:25], v[110:111]
    v_pk_fma_f32 v[26:27], v[110:111], v[110:111], v[26:27]
    v_pk_add_f32 v[20:21], v[20:21], v[24:25]
    v_pk_add_f32 v[22:23], v[22:23], v[26:27]
    v_add_f32 v20, v20, v21
    v_add_f32 v22, v22, v23
    v_mov_b32 v24, 0x383ef424
    s_nop 0
    v_permlane16_swap_b32 v20, v22
    v_add_f32 v20, v20, v22
    v_mov_b32 v22, v20
    s_nop 1
    v_permlane16_swap_b32 v20, v22
    v_mul_f32 v21, 0x3cb61376, v20
    v_fmac_f32 v24, 0x3d423f85, v22
    v_mul_f32 v20, 0xbc2aaaab, v20
    v_fma_f32 v24, -v21, v21, v24
    v_max_f32 v24, 0x383ef424, v24
    v_rsq_f32 v22, v24
    s_nop 0
    v_mul_f32_e64 v23, v20, v22
    s_waitcnt vmcnt(2)
    s_barrier
    ds_read_b128 a[0:3], v4 offset:18432
    ds_read_b128 a[4:7], v40 offset:18816
    ds_read_b128 a[8:11], v5 offset:18432
    ds_read_b128 a[12:15], v41 offset:18816
    ds_read_b128 a[16:19], v6 offset:18432
    ds_read_b128 a[20:23], v42 offset:18816
    ds_read_b128 a[24:27], v7 offset:18432
    ds_read_b128 a[28:31], v43 offset:18816
    v_pk_fma_f32 v[64:65], v[64:65], v[22:23], v[22:23] op_sel:[0,0,1] op_sel_hi:[1,0,1]
    v_pk_fma_f32 v[66:67], v[66:67], v[22:23], v[22:23] op_sel:[0,0,1] op_sel_hi:[1,0,1]
    v_pk_fma_f32 v[68:69], v[68:69], v[22:23], v[22:23] op_sel:[0,0,1] op_sel_hi:[1,0,1]
    v_pk_fma_f32 v[70:71], v[70:71], v[22:23], v[22:23] op_sel:[0,0,1] op_sel_hi:[1,0,1]
    v_cvt_pk_bf16_f32 v48, v64, v65
    v_cvt_pk_bf16_f32 v49, v66, v67
    v_cvt_pk_bf16_f32 v50, v68, v69
    v_cvt_pk_bf16_f32 v51, v70, v71
    v_pk_fma_f32 v[72:73], v[72:73], v[22:23], v[22:23] op_sel:[0,0,1] op_sel_hi:[1,0,1]
    v_pk_fma_f32 v[74:75], v[74:75], v[22:23], v[22:23] op_sel:[0,0,1] op_sel_hi:[1,0,1]
    v_pk_fma_f32 v[76:77], v[76:77], v[22:23], v[22:23] op_sel:[0,0,1] op_sel_hi:[1,0,1]
    v_pk_fma_f32 v[78:79], v[78:79], v[22:23], v[22:23] op_sel:[0,0,1] op_sel_hi:[1,0,1]
    v_cvt_pk_bf16_f32 v52, v72, v73
    v_cvt_pk_bf16_f32 v53, v74, v75
    v_cvt_pk_bf16_f32 v54, v76, v77
    v_cvt_pk_bf16_f32 v55, v78, v79
    v_pk_fma_f32 v[80:81], v[80:81], v[22:23], v[22:23] op_sel:[0,0,1] op_sel_hi:[1,0,1]
    v_pk_fma_f32 v[82:83], v[82:83], v[22:23], v[22:23] op_sel:[0,0,1] op_sel_hi:[1,0,1]
    v_pk_fma_f32 v[84:85], v[84:85], v[22:23], v[22:23] op_sel:[0,0,1] op_sel_hi:[1,0,1]
    v_pk_fma_f32 v[86:87], v[86:87], v[22:23], v[22:23] op_sel:[0,0,1] op_sel_hi:[1,0,1]
    v_cvt_pk_bf16_f32 v56, v80, v81
    v_cvt_pk_bf16_f32 v57, v82, v83
    v_cvt_pk_bf16_f32 v58, v84, v85
    v_cvt_pk_bf16_f32 v59, v86, v87
    v_pk_fma_f32 v[88:89], v[88:89], v[22:23], v[22:23] op_sel:[0,0,1] op_sel_hi:[1,0,1]
    v_pk_fma_f32 v[90:91], v[90:91], v[22:23], v[22:23] op_sel:[0,0,1] op_sel_hi:[1,0,1]
    v_pk_fma_f32 v[92:93], v[92:93], v[22:23], v[22:23] op_sel:[0,0,1] op_sel_hi:[1,0,1]
    v_pk_fma_f32 v[94:95], v[94:95], v[22:23], v[22:23] op_sel:[0,0,1] op_sel_hi:[1,0,1]
    v_cvt_pk_bf16_f32 v60, v88, v89
    v_cvt_pk_bf16_f32 v61, v90, v91
    v_cvt_pk_bf16_f32 v62, v92, v93
    v_cvt_pk_bf16_f32 v63, v94, v95
    v_pk_fma_f32 v[96:97], v[96:97], v[22:23], v[22:23] op_sel:[0,0,1] op_sel_hi:[1,0,1]
    v_pk_fma_f32 v[98:99], v[98:99], v[22:23], v[22:23] op_sel:[0,0,1] op_sel_hi:[1,0,1]
    v_pk_fma_f32 v[100:101], v[100:101], v[22:23], v[22:23] op_sel:[0,0,1] op_sel_hi:[1,0,1]
    v_pk_fma_f32 v[102:103], v[102:103], v[22:23], v[22:23] op_sel:[0,0,1] op_sel_hi:[1,0,1]
    v_cvt_pk_bf16_f32 v8, v96, v97
    v_cvt_pk_bf16_f32 v9, v98, v99
    v_cvt_pk_bf16_f32 v10, v100, v101
    v_cvt_pk_bf16_f32 v11, v102, v103
    v_pk_fma_f32 v[104:105], v[104:105], v[22:23], v[22:23] op_sel:[0,0,1] op_sel_hi:[1,0,1]
    v_pk_fma_f32 v[106:107], v[106:107], v[22:23], v[22:23] op_sel:[0,0,1] op_sel_hi:[1,0,1]
    v_pk_fma_f32 v[108:109], v[108:109], v[22:23], v[22:23] op_sel:[0,0,1] op_sel_hi:[1,0,1]
    v_pk_fma_f32 v[110:111], v[110:111], v[22:23], v[22:23] op_sel:[0,0,1] op_sel_hi:[1,0,1]
    v_cvt_pk_bf16_f32 v32, v104, v105
    v_cvt_pk_bf16_f32 v33, v106, v107
    v_cvt_pk_bf16_f32 v34, v108, v109
    v_cvt_pk_bf16_f32 v35, v110, v111
    ds_read_b128 a[32:35], v4 offset:18496
    ds_read_b128 a[36:39], v40 offset:18880
    s_waitcnt lgkmcnt(6)
    v_mfma_f32_16x16x32_bf16 v[20:23], v[160:163], a[0:3], 0
    ds_read_b128 a[40:43], v5 offset:18496
    v_mfma_f32_16x16x32_bf16 v[64:67], v[112:115], a[0:3], 0
    ds_read_b128 a[44:47], v41 offset:18880
    v_mfma_f32_16x16x32_bf16 v[64:67], v[208:211], a[4:7], v[64:67]
    v_mfma_f32_16x16x32_bf16 v[24:27], v[164:167], a[8:11], 0
    ds_read_b128 a[48:51], v6 offset:18496
    v_mfma_f32_16x16x32_bf16 v[68:71], v[116:119], a[8:11], 0
    ds_read_b128 a[52:55], v42 offset:18880
    v_mfma_f32_16x16x32_bf16 v[68:71], v[212:215], a[12:15], v[68:71]
    s_waitcnt lgkmcnt(6)
    v_mfma_f32_16x16x32_bf16 v[44:47], v[168:171], a[16:19], 0
    ds_read_b128 a[56:59], v7 offset:18496
    v_add_f32_dpp v64, v20, v64 row_shl:1 row_mask:0xf bank_mask:0xf
    v_mfma_f32_16x16x32_bf16 v[72:75], v[120:123], a[16:19], 0
    ds_read_b128 a[60:63], v43 offset:18880
    v_add_f32_dpp v65, v21, v65 row_shl:1 row_mask:0xf bank_mask:0xf
    v_mfma_f32_16x16x32_bf16 v[72:75], v[216:219], a[20:23], v[72:75]
    v_add_f32_dpp v66, v22, v66 row_shl:1 row_mask:0xf bank_mask:0xf
    v_add_f32_dpp v67, v23, v67 row_shl:1 row_mask:0xf bank_mask:0xf
    v_mfma_f32_16x16x32_bf16 v[20:23], v[172:175], a[24:27], 0
    ds_read_b128 a[64:67], v4 offset:18560
    v_add_f32_dpp v68, v24, v68 row_shl:1 row_mask:0xf bank_mask:0xf
    v_mfma_f32_16x16x32_bf16 v[76:79], v[124:127], a[24:27], 0
    ds_read_b128 a[68:71], v40 offset:18944
    v_add_f32_dpp v69, v25, v69 row_shl:1 row_mask:0xf bank_mask:0xf
    v_mfma_f32_16x16x32_bf16 v[76:79], v[220:223], a[28:31], v[76:79]
    v_add_f32_dpp v70, v26, v70 row_shl:1 row_mask:0xf bank_mask:0xf
    v_add_f32_dpp v71, v27, v71 row_shl:1 row_mask:0xf bank_mask:0xf
    s_waitcnt lgkmcnt(6)
    v_mfma_f32_16x16x32_bf16 v[24:27], v[176:179], a[32:35], 0
    s_nop 0
    ds_read_b128 a[72:75], v5 offset:18560
    v_add_f32_dpp v72, v44, v72 row_shl:1 row_mask:0xf bank_mask:0xf
    v_mfma_f32_16x16x32_bf16 v[80:83], v[128:131], a[32:35], 0
    ds_read_b128 a[76:79], v41 offset:18944
    v_add_f32_dpp v73, v45, v73 row_shl:1 row_mask:0xf bank_mask:0xf
    v_mfma_f32_16x16x32_bf16 v[80:83], v[224:227], a[36:39], v[80:83]
    v_add_f32_dpp v74, v46, v74 row_shl:1 row_mask:0xf bank_mask:0xf
    v_add_f32_dpp v75, v47, v75 row_shl:1 row_mask:0xf bank_mask:0xf
    v_mfma_f32_16x16x32_bf16 v[44:47], v[180:183], a[40:43], 0
    ds_read_b128 a[80:83], v6 offset:18560
    v_add_f32_dpp v76, v20, v76 row_shl:1 row_mask:0xf bank_mask:0xf
    v_mfma_f32_16x16x32_bf16 v[84:87], v[132:135], a[40:43], 0
    ds_read_b128 a[84:87], v42 offset:18944
    v_add_f32_dpp v77, v21, v77 row_shl:1 row_mask:0xf bank_mask:0xf
    v_mfma_f32_16x16x32_bf16 v[84:87], v[228:231], a[44:47], v[84:87]
    v_add_f32_dpp v78, v22, v78 row_shl:1 row_mask:0xf bank_mask:0xf
    v_add_f32_dpp v79, v23, v79 row_shl:1 row_mask:0xf bank_mask:0xf
    s_waitcnt lgkmcnt(6)
    v_mfma_f32_16x16x32_bf16 v[20:23], v[184:187], a[48:51], 0
    ds_read_b128 a[88:91], v7 offset:18560
    s_nop 0
    v_add_f32_dpp v80, v24, v80 row_shl:1 row_mask:0xf bank_mask:0xf
    v_mfma_f32_16x16x32_bf16 v[88:91], v[136:139], a[48:51], 0
    ds_read_b128 a[92:95], v43 offset:18944
    v_add_f32_dpp v81, v25, v81 row_shl:1 row_mask:0xf bank_mask:0xf
    v_mfma_f32_16x16x32_bf16 v[88:91], v[232:235], a[52:55], v[88:91]
    v_add_f32_dpp v82, v26, v82 row_shl:1 row_mask:0xf bank_mask:0xf
    v_add_f32_dpp v83, v27, v83 row_shl:1 row_mask:0xf bank_mask:0xf
    v_mfma_f32_16x16x32_bf16 v[24:27], v[188:191], a[56:59], 0
    v_add_f32_dpp v84, v44, v84 row_shl:1 row_mask:0xf bank_mask:0xf
    v_add_f32_dpp v85, v45, v85 row_shl:1 row_mask:0xf bank_mask:0xf
    v_mfma_f32_16x16x32_bf16 v[92:95], v[140:143], a[56:59], 0
    v_add_f32_dpp v86, v46, v86 row_shl:1 row_mask:0xf bank_mask:0xf
    v_add_f32_dpp v87, v47, v87 row_shl:1 row_mask:0xf bank_mask:0xf
    v_mfma_f32_16x16x32_bf16 v[92:95], v[236:239], a[60:63], v[92:95]
    s_waitcnt lgkmcnt(4)
    v_mfma_f32_16x16x32_bf16 v[44:47], v[192:195], a[64:67], 0
    s_nop 0
    v_add_f32_dpp v88, v20, v88 row_shl:1 row_mask:0xf bank_mask:0xf
    v_add_f32_dpp v89, v21, v89 row_shl:1 row_mask:0xf bank_mask:0xf
    v_mfma_f32_16x16x32_bf16 v[96:99], v[144:147], a[64:67], 0
    v_add_f32_dpp v90, v22, v90 row_shl:1 row_mask:0xf bank_mask:0xf
    v_add_f32_dpp v91, v23, v91 row_shl:1 row_mask:0xf bank_mask:0xf
    v_mfma_f32_16x16x32_bf16 v[96:99], v[240:243], a[68:71], v[96:99]
    v_mfma_f32_16x16x32_bf16 v[20:23], v[196:199], a[72:75], 0
    v_add_f32_dpp v92, v24, v92 row_shl:1 row_mask:0xf bank_mask:0xf
    v_add_f32_dpp v93, v25, v93 row_shl:1 row_mask:0xf bank_mask:0xf
    v_mfma_f32_16x16x32_bf16 v[100:103], v[148:151], a[72:75], 0
    v_add_f32_dpp v94, v26, v94 row_shl:1 row_mask:0xf bank_mask:0xf
    v_add_f32_dpp v95, v27, v95 row_shl:1 row_mask:0xf bank_mask:0xf
    v_mfma_f32_16x16x32_bf16 v[100:103], v[244:247], a[76:79], v[100:103]
    s_waitcnt lgkmcnt(0)
    v_mfma_f32_16x16x32_bf16 v[24:27], v[200:203], a[80:83], 0
    v_add_f32_dpp v96, v44, v96 row_shl:1 row_mask:0xf bank_mask:0xf
    s_nop 0
    v_add_f32_dpp v97, v45, v97 row_shl:1 row_mask:0xf bank_mask:0xf
    v_mfma_f32_16x16x32_bf16 v[104:107], v[152:155], a[80:83], 0
    v_add_f32_dpp v98, v46, v98 row_shl:1 row_mask:0xf bank_mask:0xf
    v_add_f32_dpp v99, v47, v99 row_shl:1 row_mask:0xf bank_mask:0xf
    v_mfma_f32_16x16x32_bf16 v[104:107], v[248:251], a[84:87], v[104:107]
    v_mfma_f32_16x16x32_bf16 v[44:47], v[204:207], a[88:91], 0
    v_add_f32_dpp v100, v20, v100 row_shl:1 row_mask:0xf bank_mask:0xf
    v_add_f32_dpp v101, v21, v101 row_shl:1 row_mask:0xf bank_mask:0xf
    v_mfma_f32_16x16x32_bf16 v[108:111], v[156:159], a[88:91], 0
    v_add_f32_dpp v102, v22, v102 row_shl:1 row_mask:0xf bank_mask:0xf
    v_add_f32_dpp v103, v23, v103 row_shl:1 row_mask:0xf bank_mask:0xf
    v_mfma_f32_16x16x32_bf16 v[108:111], v[252:255], a[92:95], v[108:111]
    s_nop 0
    v_add_f32_dpp v104, v24, v104 row_shl:1 row_mask:0xf bank_mask:0xf
    v_add_f32_dpp v105, v25, v105 row_shl:1 row_mask:0xf bank_mask:0xf
    v_add_f32_dpp v106, v26, v106 row_shl:1 row_mask:0xf bank_mask:0xf
    v_add_f32_dpp v107, v27, v107 row_shl:1 row_mask:0xf bank_mask:0xf
    s_nop 2
    v_add_f32_dpp v108, v44, v108 row_shl:1 row_mask:0xf bank_mask:0xf
    v_add_f32_dpp v109, v45, v109 row_shl:1 row_mask:0xf bank_mask:0xf
    v_add_f32_dpp v110, v46, v110 row_shl:1 row_mask:0xf bank_mask:0xf
    v_add_f32_dpp v111, v47, v111 row_shl:1 row_mask:0xf bank_mask:0xf
    s_mov_b64 exec, s[64:65]
    v_pk_add_f32 v[20:21], v[64:65], v[66:67]
    v_pk_mul_f32 v[22:23], v[64:65], v[64:65]
    s_nop 0
    v_pk_add_f32 v[24:25], v[68:69], v[70:71]
    v_pk_mul_f32 v[26:27], v[66:67], v[66:67]
    v_pk_fma_f32 v[22:23], v[68:69], v[68:69], v[22:23]
    v_pk_fma_f32 v[26:27], v[70:71], v[70:71], v[26:27]
    ds_write_b128 v28, v[48:51] offset:0
    v_pk_add_f32 v[20:21], v[20:21], v[72:73]
    v_pk_fma_f32 v[22:23], v[72:73], v[72:73], v[22:23]
    v_pk_add_f32 v[24:25], v[24:25], v[74:75]
    v_pk_fma_f32 v[26:27], v[74:75], v[74:75], v[26:27]
    v_pk_add_f32 v[20:21], v[20:21], v[76:77]
    v_pk_fma_f32 v[22:23], v[76:77], v[76:77], v[22:23]
    v_pk_add_f32 v[24:25], v[24:25], v[78:79]
    v_pk_fma_f32 v[26:27], v[78:79], v[78:79], v[26:27]
    ds_write_b128 v28, v[52:55] offset:1024
    v_pk_add_f32 v[20:21], v[20:21], v[80:81]
    v_pk_fma_f32 v[22:23], v[80:81], v[80:81], v[22:23]
    v_pk_add_f32 v[24:25], v[24:25], v[82:83]
    v_pk_fma_f32 v[26:27], v[82:83], v[82:83], v[26:27]
    v_pk_add_f32 v[20:21], v[20:21], v[84:85]
    v_pk_fma_f32 v[22:23], v[84:85], v[84:85], v[22:23]
    v_pk_add_f32 v[24:25], v[24:25], v[86:87]
    v_pk_fma_f32 v[26:27], v[86:87], v[86:87], v[26:27]
    ds_write_b128 v28, v[56:59] offset:2048
    v_pk_add_f32 v[20:21], v[20:21], v[88:89]
    v_pk_fma_f32 v[22:23], v[88:89], v[88:89], v[22:23]
    v_pk_add_f32 v[24:25], v[24:25], v[90:91]
    v_pk_fma_f32 v[26:27], v[90:91], v[90:91], v[26:27]
    v_pk_add_f32 v[20:21], v[20:21], v[92:93]
    v_pk_fma_f32 v[22:23], v[92:93], v[92:93], v[22:23]
    v_pk_add_f32 v[24:25], v[24:25], v[94:95]
    v_pk_fma_f32 v[26:27], v[94:95], v[94:95], v[26:27]
    ds_write_b128 v28, v[60:63] offset:3072
    v_pk_add_f32 v[20:21], v[20:21], v[96:97]
    v_pk_fma_f32 v[22:23], v[96:97], v[96:97], v[22:23]
    v_pk_add_f32 v[24:25], v[24:25], v[98:99]
    v_pk_fma_f32 v[26:27], v[98:99], v[98:99], v[26:27]
    v_pk_add_f32 v[20:21], v[20:21], v[100:101]
    v_pk_fma_f32 v[22:23], v[100:101], v[100:101], v[22:23]
    v_pk_add_f32 v[24:25], v[24:25], v[102:103]
    v_pk_fma_f32 v[26:27], v[102:103], v[102:103], v[26:27]
    ds_write_b128 v28, v[8:11] offset:4096
    v_pk_add_f32 v[20:21], v[20:21], v[104:105]
    v_pk_fma_f32 v[22:23], v[104:105], v[104:105], v[22:23]
    v_pk_add_f32 v[24:25], v[24:25], v[106:107]
    v_pk_fma_f32 v[26:27], v[106:107], v[106:107], v[26:27]
    v_pk_add_f32 v[20:21], v[20:21], v[108:109]
    v_pk_fma_f32 v[22:23], v[108:109], v[108:109], v[22:23]
    v_pk_add_f32 v[24:25], v[24:25], v[110:111]
    v_pk_fma_f32 v[26:27], v[110:111], v[110:111], v[26:27]
    ds_write_b128 v28, v[32:35] offset:5120
    s_mov_b64 exec, -1
    v_pk_add_f32 v[20:21], v[20:21], v[24:25]
    v_pk_add_f32 v[22:23], v[22:23], v[26:27]
    v_add_f32 v20, v20, v21
    v_add_f32 v22, v22, v23
    v_mov_b32 v24, 0x383ef424
    s_nop 0
    v_permlane16_swap_b32 v20, v22
    v_add_f32 v20, v20, v22
    v_mov_b32_e64 v22, v20
    s_nop 1
    v_permlane16_swap_b32 v20, v22
    v_mul_f32 v21, 0x3cb61376, v20
    v_fmac_f32 v24, 0x3d423f85, v22
    v_mul_f32 v20, 0xbc2aaaab, v20
    v_fma_f32 v24, -v21, v21, v24
    v_max_f32 v24, 0x383ef424, v24
    v_rsq_f32 v22, v24
    s_nop 0
    v_mul_f32 v23, v20, v22
    s_mov_b64 exec, s[64:65]
    v_pk_fma_f32 v[64:65], v[64:65], v[22:23], v[22:23] op_sel:[0,0,1] op_sel_hi:[1,0,1]
    v_pk_fma_f32 v[66:67], v[66:67], v[22:23], v[22:23] op_sel:[0,0,1] op_sel_hi:[1,0,1]
    v_pk_fma_f32 v[68:69], v[68:69], v[22:23], v[22:23] op_sel:[0,0,1] op_sel_hi:[1,0,1]
    v_pk_fma_f32 v[70:71], v[70:71], v[22:23], v[22:23] op_sel:[0,0,1] op_sel_hi:[1,0,1]
    v_cvt_pk_bf16_f32 v64, v64, v65
    v_cvt_pk_bf16_f32 v65, v66, v67
    v_cvt_pk_bf16_f32 v66, v68, v69
    v_cvt_pk_bf16_f32 v67, v70, v71
    ds_write_b128 v29, v[64:67] offset:0
    v_pk_fma_f32 v[72:73], v[72:73], v[22:23], v[22:23] op_sel:[0,0,1] op_sel_hi:[1,0,1]
    v_pk_fma_f32 v[74:75], v[74:75], v[22:23], v[22:23] op_sel:[0,0,1] op_sel_hi:[1,0,1]
    v_pk_fma_f32 v[76:77], v[76:77], v[22:23], v[22:23] op_sel:[0,0,1] op_sel_hi:[1,0,1]
    v_pk_fma_f32 v[78:79], v[78:79], v[22:23], v[22:23] op_sel:[0,0,1] op_sel_hi:[1,0,1]
    v_cvt_pk_bf16_f32 v72, v72, v73
    v_cvt_pk_bf16_f32 v73, v74, v75
    v_cvt_pk_bf16_f32 v74, v76, v77
    v_cvt_pk_bf16_f32 v75, v78, v79
    ds_write_b128 v29, v[72:75] offset:1024
    v_pk_fma_f32 v[80:81], v[80:81], v[22:23], v[22:23] op_sel:[0,0,1] op_sel_hi:[1,0,1]
    v_pk_fma_f32 v[82:83], v[82:83], v[22:23], v[22:23] op_sel:[0,0,1] op_sel_hi:[1,0,1]
    v_pk_fma_f32 v[84:85], v[84:85], v[22:23], v[22:23] op_sel:[0,0,1] op_sel_hi:[1,0,1]
    v_pk_fma_f32 v[86:87], v[86:87], v[22:23], v[22:23] op_sel:[0,0,1] op_sel_hi:[1,0,1]
    v_cvt_pk_bf16_f32 v80, v80, v81
    v_cvt_pk_bf16_f32 v81, v82, v83
    v_cvt_pk_bf16_f32 v82, v84, v85
    v_cvt_pk_bf16_f32 v83, v86, v87
    ds_write_b128 v29, v[80:83] offset:2048
    v_pk_fma_f32 v[88:89], v[88:89], v[22:23], v[22:23] op_sel:[0,0,1] op_sel_hi:[1,0,1]
    v_pk_fma_f32 v[90:91], v[90:91], v[22:23], v[22:23] op_sel:[0,0,1] op_sel_hi:[1,0,1]
    v_pk_fma_f32 v[92:93], v[92:93], v[22:23], v[22:23] op_sel:[0,0,1] op_sel_hi:[1,0,1]
    v_pk_fma_f32 v[94:95], v[94:95], v[22:23], v[22:23] op_sel:[0,0,1] op_sel_hi:[1,0,1]
    v_cvt_pk_bf16_f32 v88, v88, v89
    v_cvt_pk_bf16_f32 v89, v90, v91
    v_cvt_pk_bf16_f32 v90, v92, v93
    v_cvt_pk_bf16_f32 v91, v94, v95
    ds_write_b128 v29, v[88:91] offset:3072
    v_pk_fma_f32 v[96:97], v[96:97], v[22:23], v[22:23] op_sel:[0,0,1] op_sel_hi:[1,0,1]
    v_pk_fma_f32 v[98:99], v[98:99], v[22:23], v[22:23] op_sel:[0,0,1] op_sel_hi:[1,0,1]
    v_pk_fma_f32 v[100:101], v[100:101], v[22:23], v[22:23] op_sel:[0,0,1] op_sel_hi:[1,0,1]
    v_pk_fma_f32 v[102:103], v[102:103], v[22:23], v[22:23] op_sel:[0,0,1] op_sel_hi:[1,0,1]
    v_cvt_pk_bf16_f32 v96, v96, v97
    v_cvt_pk_bf16_f32 v97, v98, v99
    v_cvt_pk_bf16_f32 v98, v100, v101
    v_cvt_pk_bf16_f32 v99, v102, v103
    ds_write_b128 v29, v[96:99] offset:4096
    v_pk_fma_f32 v[104:105], v[104:105], v[22:23], v[22:23] op_sel:[0,0,1] op_sel_hi:[1,0,1]
    v_pk_fma_f32 v[106:107], v[106:107], v[22:23], v[22:23] op_sel:[0,0,1] op_sel_hi:[1,0,1]
    v_pk_fma_f32 v[108:109], v[108:109], v[22:23], v[22:23] op_sel:[0,0,1] op_sel_hi:[1,0,1]
    v_pk_fma_f32 v[110:111], v[110:111], v[22:23], v[22:23] op_sel:[0,0,1] op_sel_hi:[1,0,1]
    v_cvt_pk_bf16_f32 v104, v104, v105
    v_cvt_pk_bf16_f32 v105, v106, v107
    v_cvt_pk_bf16_f32 v106, v108, v109
    v_cvt_pk_bf16_f32 v107, v110, v111
    ds_write_b128 v29, v[104:107] offset:5120
    s_mov_b64 exec, -1
    s_waitcnt lgkmcnt(0)
    s_branch L_CONVDONE
L_WAVE3:
L_PAD1:
    s_cbranch_execz L_PAD5
    s_mov_b32 m0, 0
    s_mov_b32 s48, 0
    s_waitcnt vmcnt(9)
    buffer_load_dwordx4 v32, s[16:19], s48 offen offset:0 lds
    s_nop 0
    buffer_load_dwordx4 v33, s[16:19], s48 offen offset:1024 lds
    buffer_load_dwordx4 v34, s[16:19], s48 offen offset:2048 lds
    s_mov_b32 m0, 18432
    s_mov_b32 s48, 192
    buffer_load_dwordx4 v32, s[16:19], s48 offen offset:0 lds
    buffer_load_dwordx4 v33, s[16:19], s48 offen offset:1024 lds
    buffer_load_dwordx4 v34, s[16:19], s48 offen offset:2048 lds
    s_mov_b32 m0, 36864
    s_mov_b32 s48, 384
    buffer_load_dwordx4 v32, s[16:19], s48 offen offset:0 lds
    buffer_load_dwordx4 v33, s[16:19], s48 offen offset:1024 lds
    buffer_load_dwordx4 v34, s[16:19], s48 offen offset:2048 lds
    s_mov_b32 m0, 55296
    s_mov_b32 s48, 576
    buffer_load_dwordx4 v32, s[16:19], s48 offen offset:0 lds
    buffer_load_dwordx4 v33, s[16:19], s48 offen offset:1024 lds
    buffer_load_dwordx4 v34, s[16:19], s48 offen offset:2048 lds
    s_mov_b32 m0, 3072
    s_mov_b32 s48, 12288
    buffer_load_dwordx4 v32, s[16:19], s48 offen offset:0 lds
    buffer_load_dwordx4 v33, s[16:19], s48 offen offset:1024 lds
    buffer_load_dwordx4 v34, s[16:19], s48 offen offset:2048 lds
    s_mov_b32 m0, 21504
    s_mov_b32 s48, 12480
    buffer_load_dwordx4 v32, s[16:19], s48 offen offset:0 lds
    buffer_load_dwordx4 v33, s[16:19], s48 offen offset:1024 lds
    buffer_load_dwordx4 v34, s[16:19], s48 offen offset:2048 lds
    s_mov_b32 m0, 39936
    s_mov_b32 s48, 12672
    buffer_load_dwordx4 v32, s[16:19], s48 offen offset:0 lds
    buffer_load_dwordx4 v33, s[16:19], s48 offen offset:1024 lds
    buffer_load_dwordx4 v34, s[16:19], s48 offen offset:2048 lds
    s_mov_b32 m0, 58368
    s_mov_b32 s48, 12864
    buffer_load_dwordx4 v32, s[16:19], s48 offen offset:0 lds
    buffer_load_dwordx4 v33, s[16:19], s48 offen offset:1024 lds
    buffer_load_dwordx4 v34, s[16:19], s48 offen offset:2048 lds
    s_mov_b32 m0, 6144
    s_mov_b32 s48, 24576
    buffer_load_dwordx4 v32, s[16:19], s48 offen offset:0 lds
    buffer_load_dwordx4 v33, s[16:19], s48 offen offset:1024 lds
    buffer_load_dwordx4 v34, s[16:19], s48 offen offset:2048 lds
    s_mov_b32 m0, 24576
    s_mov_b32 s48, 24768
    buffer_load_dwordx4 v32, s[16:19], s48 offen offset:0 lds
    buffer_load_dwordx4 v33, s[16:19], s48 offen offset:1024 lds
    buffer_load_dwordx4 v34, s[16:19], s48 offen offset:2048 lds
    s_mov_b32 m0, 43008
    s_mov_b32 s48, 24960
    buffer_load_dwordx4 v32, s[16:19], s48 offen offset:0 lds
    buffer_load_dwordx4 v33, s[16:19], s48 offen offset:1024 lds
    buffer_load_dwordx4 v34, s[16:19], s48 offen offset:2048 lds
    s_mov_b32 m0, 61440
    s_mov_b32 s48, 25152
    buffer_load_dwordx4 v32, s[16:19], s48 offen offset:0 lds
    buffer_load_dwordx4 v33, s[16:19], s48 offen offset:1024 lds
    buffer_load_dwordx4 v34, s[16:19], s48 offen offset:2048 lds
    s_mov_b32 m0, 9216
    s_mov_b32 s48, 36864
    buffer_load_dwordx4 v32, s[16:19], s48 offen offset:0 lds
    buffer_load_dwordx4 v33, s[16:19], s48 offen offset:1024 lds
    buffer_load_dwordx4 v34, s[16:19], s48 offen offset:2048 lds
    s_mov_b32 m0, 27648
    s_mov_b32 s48, 37056
    buffer_load_dwordx4 v32, s[16:19], s48 offen offset:0 lds
    buffer_load_dwordx4 v33, s[16:19], s48 offen offset:1024 lds
    buffer_load_dwordx4 v34, s[16:19], s48 offen offset:2048 lds
    s_mov_b32 m0, 46080
    s_mov_b32 s48, 37248
    buffer_load_dwordx4 v32, s[16:19], s48 offen offset:0 lds
    buffer_load_dwordx4 v33, s[16:19], s48 offen offset:1024 lds
    buffer_load_dwordx4 v34, s[16:19], s48 offen offset:2048 lds
    s_mov_b32 m0, 64512
    s_mov_b32 s48, 37440
    buffer_load_dwordx4 v32, s[16:19], s48 offen offset:0 lds
    buffer_load_dwordx4 v33, s[16:19], s48 offen offset:1024 lds
    buffer_load_dwordx4 v34, s[16:19], s48 offen offset:2048 lds
    s_mov_b64 exec, 0
    s_branch L_PAD8
L_BACKC:
    s_mov_b64 exec, -1
    s_waitcnt vmcnt(50)
    s_waitcnt lgkmcnt(0)
    s_barrier
    s_mov_b32 m0, 12288
    s_mov_b32 s48, 49152
    buffer_load_dwordx4 v32, s[16:19], s48 offen offset:0 lds
    buffer_load_dwordx4 v33, s[16:19], s48 offen offset:1024 lds
    buffer_load_dwordx4 v34, s[16:19], s48 offen offset:2048 lds
    s_mov_b32 m0, 30720
    s_mov_b32 s48, 49344
    buffer_load_dwordx4 v32, s[16:19], s48 offen offset:0 lds
    buffer_load_dwordx4 v33, s[16:19], s48 offen offset:1024 lds
    buffer_load_dwordx4 v34, s[16:19], s48 offen offset:2048 lds
    s_mov_b32 m0, 49152
    s_mov_b32 s48, 49536
    buffer_load_dwordx4 v32, s[16:19], s48 offen offset:0 lds
    buffer_load_dwordx4 v33, s[16:19], s48 offen offset:1024 lds
    buffer_load_dwordx4 v34, s[16:19], s48 offen offset:2048 lds
    s_mov_b32 m0, 67584
    s_mov_b32 s48, 49728
    buffer_load_dwordx4 v32, s[16:19], s48 offen offset:0 lds
    buffer_load_dwordx4 v33, s[16:19], s48 offen offset:1024 lds
    buffer_load_dwordx4 v34, s[16:19], s48 offen offset:2048 lds
    s_mov_b32 m0, 15360
    s_mov_b32 s48, 61440
    buffer_load_dwordx4 v32, s[16:19], s48 offen offset:0 lds
    buffer_load_dwordx4 v33, s[16:19], s48 offen offset:1024 lds
    buffer_load_dwordx4 v34, s[16:19], s48 offen offset:2048 lds
    s_mov_b32 m0, 33792
    s_mov_b32 s48, 61632
    buffer_load_dwordx4 v32, s[16:19], s48 offen offset:0 lds
    buffer_load_dwordx4 v33, s[16:19], s48 offen offset:1024 lds
    buffer_load_dwordx4 v34, s[16:19], s48 offen offset:2048 lds
    s_mov_b32 m0, 52224
    s_mov_b32 s48, 61824
    buffer_load_dwordx4 v32, s[16:19], s48 offen offset:0 lds
    buffer_load_dwordx4 v33, s[16:19], s48 offen offset:1024 lds
    buffer_load_dwordx4 v34, s[16:19], s48 offen offset:2048 lds
    s_mov_b32 m0, 70656
    s_mov_b32 s48, 62016
    buffer_load_dwordx4 v32, s[16:19], s48 offen offset:0 lds
    buffer_load_dwordx4 v33, s[16:19], s48 offen offset:1024 lds
    buffer_load_dwordx4 v34, s[16:19], s48 offen offset:2048 lds
    s_cmp_ge_u32 s59, 24
    s_cbranch_scc1 L_NOBLOAD
    v_mul_u32_u24 v10, 384, v0
    v_lshlrev_b32 v11, 2, v0
    s_lshl_b32 s47, s59, 3
    buffer_load_dwordx2 v[48:49], v10, s[20:23], s47 offen offset:0
    buffer_load_dwordx2 v[50:51], v10, s[20:23], s47 offen offset:192
    buffer_load_dword v60, v11, s[28:31], 0 offen offset:0
    s_add_u32 s47, s47, 24576
    buffer_load_dwordx2 v[52:53], v10, s[20:23], s47 offen offset:0
    buffer_load_dwordx2 v[54:55], v10, s[20:23], s47 offen offset:192
    buffer_load_dword v61, v11, s[28:31], 0 offen offset:256
    s_add_u32 s47, s47, 24576
    buffer_load_dwordx2 v[56:57], v10, s[20:23], s47 offen offset:0
    buffer_load_dwordx2 v[58:59], v10, s[20:23], s47 offen offset:192
    buffer_load_dword v62, v11, s[28:31], 0 offen offset:512
    s_add_u32 s47, s47, 24576
L_NOBLOAD:
    ds_read_b128 a[0:3], v4 offset:18432
    ds_read_b128 a[4:7], v40 offset:18816
    ds_read_b128 a[8:11], v5 offset:18432
    ds_read_b128 a[12:15], v41 offset:18816
    ds_read_b128 a[16:19], v6 offset:18432
    ds_read_b128 a[20:23], v42 offset:18816
    ds_read_b128 a[24:27], v7 offset:18432
    ds_read_b128 a[28:31], v43 offset:18816
    ds_read_b128 a[32:35], v4 offset:18496
    ds_read_b128 a[36:39], v40 offset:18880
    s_waitcnt lgkmcnt(6)
    v_mfma_f32_16x16x32_bf16 v[20:23], v[160:163], a[0:3], 0
    ds_read_b128 a[40:43], v5 offset:18496
    v_mfma_f32_16x16x32_bf16 v[64:67], v[112:115], a[0:3], 0
    ds_read_b128 a[44:47], v41 offset:18880
    v_mfma_f32_16x16x32_bf16 v[64:67], v[208:211], a[4:7], v[64:67]
    v_mfma_f32_16x16x32_bf16 v[24:27], v[164:167], a[8:11], 0
    ds_read_b128 a[48:51], v6 offset:18496
    v_mfma_f32_16x16x32_bf16 v[68:71], v[116:119], a[8:11], 0
    ds_read_b128 a[52:55], v42 offset:18880
    v_mfma_f32_16x16x32_bf16 v[68:71], v[212:215], a[12:15], v[68:71]
    s_waitcnt lgkmcnt(6)
    v_mfma_f32_16x16x32_bf16 v[44:47], v[168:171], a[16:19], 0
    ds_read_b128 a[56:59], v7 offset:18496
    v_add_f32_dpp v64, v20, v64 row_shl:1 row_mask:0xf bank_mask:0xf
    v_mfma_f32_16x16x32_bf16 v[72:75], v[120:123], a[16:19], 0
    ds_read_b128 a[60:63], v43 offset:18880
    v_add_f32_dpp v65, v21, v65 row_shl:1 row_mask:0xf bank_mask:0xf
    v_mfma_f32_16x16x32_bf16 v[72:75], v[216:219], a[20:23], v[72:75]
    v_add_f32_dpp v66, v22, v66 row_shl:1 row_mask:0xf bank_mask:0xf
    v_add_f32_dpp v67, v23, v67 row_shl:1 row_mask:0xf bank_mask:0xf
    v_mfma_f32_16x16x32_bf16 v[20:23], v[172:175], a[24:27], 0
    ds_read_b128 a[64:67], v4 offset:18560
    v_add_f32_dpp v68, v24, v68 row_shl:1 row_mask:0xf bank_mask:0xf
    v_mfma_f32_16x16x32_bf16 v[76:79], v[124:127], a[24:27], 0
    ds_read_b128 a[68:71], v40 offset:18944
    v_add_f32_dpp v69, v25, v69 row_shl:1 row_mask:0xf bank_mask:0xf
    v_mfma_f32_16x16x32_bf16 v[76:79], v[220:223], a[28:31], v[76:79]
    v_add_f32_dpp v70, v26, v70 row_shl:1 row_mask:0xf bank_mask:0xf
    v_add_f32_dpp v71, v27, v71 row_shl:1 row_mask:0xf bank_mask:0xf
    s_waitcnt lgkmcnt(6)
    v_mfma_f32_16x16x32_bf16 v[24:27], v[176:179], a[32:35], 0
    s_nop 0
    ds_read_b128 a[72:75], v5 offset:18560
    v_add_f32_dpp v72, v44, v72 row_shl:1 row_mask:0xf bank_mask:0xf
    v_mfma_f32_16x16x32_bf16 v[80:83], v[128:131], a[32:35], 0
    ds_read_b128 a[76:79], v41 offset:18944
    v_add_f32_dpp v73, v45, v73 row_shl:1 row_mask:0xf bank_mask:0xf
L_PAD2:
    s_cbranch_execz L_PAD6
    v_mfma_f32_16x16x32_bf16 v[80:83], v[224:227], a[36:39], v[80:83]
    v_add_f32_dpp v74, v46, v74 row_shl:1 row_mask:0xf bank_mask:0xf
    s_nop 0
    v_add_f32_dpp v75, v47, v75 row_shl:1 row_mask:0xf bank_mask:0xf
    v_mfma_f32_16x16x32_bf16 v[44:47], v[180:183], a[40:43], 0
    ds_read_b128 a[80:83], v6 offset:18560
    v_add_f32_dpp v76, v20, v76 row_shl:1 row_mask:0xf bank_mask:0xf
    v_mfma_f32_16x16x32_bf16 v[84:87], v[132:135], a[40:43], 0
    ds_read_b128 a[84:87], v42 offset:18944
    v_add_f32_dpp v77, v21, v77 row_shl:1 row_mask:0xf bank_mask:0xf
    v_mfma_f32_16x16x32_bf16 v[84:87], v[228:231], a[44:47], v[84:87]
    v_add_f32_dpp v78, v22, v78 row_shl:1 row_mask:0xf bank_mask:0xf
    v_add_f32_dpp v79, v23, v79 row_shl:1 row_mask:0xf bank_mask:0xf
    s_waitcnt lgkmcnt(6)
    v_mfma_f32_16x16x32_bf16 v[20:23], v[184:187], a[48:51], 0
    s_nop 0
    ds_read_b128 a[88:91], v7 offset:18560
    v_add_f32_dpp v80, v24, v80 row_shl:1 row_mask:0xf bank_mask:0xf
    v_mfma_f32_16x16x32_bf16 v[88:91], v[136:139], a[48:51], 0
    ds_read_b128 a[92:95], v43 offset:18944
    v_add_f32_dpp v81, v25, v81 row_shl:1 row_mask:0xf bank_mask:0xf
    v_mfma_f32_16x16x32_bf16 v[88:91], v[232:235], a[52:55], v[88:91]
    v_add_f32_dpp v82, v26, v82 row_shl:1 row_mask:0xf bank_mask:0xf
    v_add_f32_dpp v83, v27, v83 row_shl:1 row_mask:0xf bank_mask:0xf
    v_mfma_f32_16x16x32_bf16 v[24:27], v[188:191], a[56:59], 0
    v_add_f32_dpp v84, v44, v84 row_shl:1 row_mask:0xf bank_mask:0xf
    v_add_f32_dpp v85, v45, v85 row_shl:1 row_mask:0xf bank_mask:0xf
    v_mfma_f32_16x16x32_bf16 v[92:95], v[140:143], a[56:59], 0
    v_add_f32_dpp v86, v46, v86 row_shl:1 row_mask:0xf bank_mask:0xf
    v_add_f32_dpp v87, v47, v87 row_shl:1 row_mask:0xf bank_mask:0xf
    v_mfma_f32_16x16x32_bf16 v[92:95], v[236:239], a[60:63], v[92:95]
    s_waitcnt lgkmcnt(4)
    s_nop 0
    v_mfma_f32_16x16x32_bf16 v[44:47], v[192:195], a[64:67], 0
    v_add_f32_dpp v88, v20, v88 row_shl:1 row_mask:0xf bank_mask:0xf
    v_add_f32_dpp v89, v21, v89 row_shl:1 row_mask:0xf bank_mask:0xf
    v_mfma_f32_16x16x32_bf16 v[96:99], v[144:147], a[64:67], 0
    v_add_f32_dpp v90, v22, v90 row_shl:1 row_mask:0xf bank_mask:0xf
    v_add_f32_dpp v91, v23, v91 row_shl:1 row_mask:0xf bank_mask:0xf
    v_mfma_f32_16x16x32_bf16 v[96:99], v[240:243], a[68:71], v[96:99]
    v_mfma_f32_16x16x32_bf16 v[20:23], v[196:199], a[72:75], 0
    v_add_f32_dpp v92, v24, v92 row_shl:1 row_mask:0xf bank_mask:0xf
    v_add_f32_dpp v93, v25, v93 row_shl:1 row_mask:0xf bank_mask:0xf
    v_mfma_f32_16x16x32_bf16 v[100:103], v[148:151], a[72:75], 0
    v_add_f32_dpp v94, v26, v94 row_shl:1 row_mask:0xf bank_mask:0xf
    v_add_f32_dpp v95, v27, v95 row_shl:1 row_mask:0xf bank_mask:0xf
    v_mfma_f32_16x16x32_bf16 v[100:103], v[244:247], a[76:79], v[100:103]
    s_waitcnt lgkmcnt(0)
    v_mfma_f32_16x16x32_bf16 v[24:27], v[200:203], a[80:83], 0
    s_nop 0
    v_add_f32_dpp v96, v44, v96 row_shl:1 row_mask:0xf bank_mask:0xf
    v_add_f32_dpp v97, v45, v97 row_shl:1 row_mask:0xf bank_mask:0xf
    v_mfma_f32_16x16x32_bf16 v[104:107], v[152:155], a[80:83], 0
    v_add_f32_dpp v98, v46, v98 row_shl:1 row_mask:0xf bank_mask:0xf
    v_add_f32_dpp v99, v47, v99 row_shl:1 row_mask:0xf bank_mask:0xf
    v_mfma_f32_16x16x32_bf16 v[104:107], v[248:251], a[84:87], v[104:107]
    v_mfma_f32_16x16x32_bf16 v[44:47], v[204:207], a[88:91], 0
    v_add_f32_dpp v100, v20, v100 row_shl:1 row_mask:0xf bank_mask:0xf
    v_add_f32_dpp v101, v21, v101 row_shl:1 row_mask:0xf bank_mask:0xf
    v_mfma_f32_16x16x32_bf16 v[108:111], v[156:159], a[88:91], 0
    v_add_f32_dpp v102, v22, v102 row_shl:1 row_mask:0xf bank_mask:0xf
    v_add_f32_dpp v103, v23, v103 row_shl:1 row_mask:0xf bank_mask:0xf
    v_mfma_f32_16x16x32_bf16 v[108:111], v[252:255], a[92:95], v[108:111]
    s_nop 0
    v_add_f32_dpp v104, v24, v104 row_shl:1 row_mask:0xf bank_mask:0xf
    v_add_f32_dpp v105, v25, v105 row_shl:1 row_mask:0xf bank_mask:0xf
    v_add_f32_dpp v106, v26, v106 row_shl:1 row_mask:0xf bank_mask:0xf
    v_add_f32_dpp v107, v27, v107 row_shl:1 row_mask:0xf bank_mask:0xf
    s_nop 2
    v_add_f32_dpp v108, v44, v108 row_shl:1 row_mask:0xf bank_mask:0xf
    v_add_f32_dpp v109, v45, v109 row_shl:1 row_mask:0xf bank_mask:0xf
    v_add_f32_dpp v110, v46, v110 row_shl:1 row_mask:0xf bank_mask:0xf
    v_add_f32_dpp v111, v47, v111 row_shl:1 row_mask:0xf bank_mask:0xf
    v_pk_add_f32 v[20:21], v[64:65], v[66:67]
    v_pk_mul_f32 v[22:23], v[64:65], v[64:65]
    v_pk_add_f32 v[24:25], v[68:69], v[70:71]
    v_pk_mul_f32 v[26:27], v[66:67], v[66:67]
    v_pk_fma_f32 v[22:23], v[68:69], v[68:69], v[22:23]
    v_pk_fma_f32 v[26:27], v[70:71], v[70:71], v[26:27]
    v_pk_add_f32 v[20:21], v[20:21], v[72:73]
    v_pk_fma_f32 v[22:23], v[72:73], v[72:73], v[22:23]
    v_pk_add_f32 v[24:25], v[24:25], v[74:75]
    v_pk_fma_f32 v[26:27], v[74:75], v[74:75], v[26:27]
    v_pk_add_f32 v[20:21], v[20:21], v[76:77]
    v_pk_fma_f32 v[22:23], v[76:77], v[76:77], v[22:23]
    v_pk_add_f32 v[24:25], v[24:25], v[78:79]
    v_pk_fma_f32 v[26:27], v[78:79], v[78:79], v[26:27]
    v_pk_add_f32 v[20:21], v[20:21], v[80:81]
    v_pk_fma_f32 v[22:23], v[80:81], v[80:81], v[22:23]
    v_pk_add_f32 v[24:25], v[24:25], v[82:83]
    v_pk_fma_f32 v[26:27], v[82:83], v[82:83], v[26:27]
    v_pk_add_f32 v[20:21], v[20:21], v[84:85]
    v_pk_fma_f32 v[22:23], v[84:85], v[84:85], v[22:23]
    v_pk_add_f32 v[24:25], v[24:25], v[86:87]
    v_pk_fma_f32 v[26:27], v[86:87], v[86:87], v[26:27]
    v_pk_add_f32 v[20:21], v[20:21], v[88:89]
    v_pk_fma_f32 v[22:23], v[88:89], v[88:89], v[22:23]
    v_pk_add_f32 v[24:25], v[24:25], v[90:91]
    v_pk_fma_f32 v[26:27], v[90:91], v[90:91], v[26:27]
    v_pk_add_f32 v[20:21], v[20:21], v[92:93]
    v_pk_fma_f32 v[22:23], v[92:93], v[92:93], v[22:23]
    v_pk_add_f32 v[24:25], v[24:25], v[94:95]
    v_pk_fma_f32 v[26:27], v[94:95], v[94:95], v[26:27]
    v_pk_add_f32 v[20:21], v[20:21], v[96:97]
    v_pk_fma_f32 v[22:23], v[96:97], v[96:97], v[22:23]
    v_pk_add_f32 v[24:25], v[24:25], v[98:99]
    v_pk_fma_f32 v[26:27], v[98:99], v[98:99], v[26:27]
    v_pk_add_f32 v[20:21], v[20:21], v[100:101]
    v_pk_fma_f32 v[22:23], v[100:101], v[100:101], v[22:23]
    v_pk_add_f32 v[24:25], v[24:25], v[102:103]
    v_pk_fma_f32 v[26:27], v[102:103], v[102:103], v[26:27]
    v_pk_add_f32 v[20:21], v[20:21], v[104:105]
    v_pk_fma_f32 v[22:23], v[104:105], v[104:105], v[22:23]
    v_pk_add_f32 v[24:25], v[24:25], v[106:107]
    v_pk_fma_f32 v[26:27], v[106:107], v[106:107], v[26:27]
    v_pk_add_f32 v[20:21], v[20:21], v[108:109]
    v_pk_fma_f32 v[22:23], v[108:109], v[108:109], v[22:23]
    v_pk_add_f32 v[24:25], v[24:25], v[110:111]
    v_pk_fma_f32 v[26:27], v[110:111], v[110:111], v[26:27]
    v_pk_add_f32 v[20:21], v[20:21], v[24:25]
    v_pk_add_f32 v[22:23], v[22:23], v[26:27]
    v_add_f32 v20, v20, v21
    v_add_f32 v22, v22, v23
    v_mov_b32 v24, 0x383ef424
    s_nop 0
    v_permlane16_swap_b32 v20, v22
    v_add_f32 v20, v20, v22
    v_mov_b32 v22, v20
    s_nop 1
    v_permlane16_swap_b32 v20, v22
    v_mul_f32 v21, 0x3cb61376, v20
    v_fmac_f32 v24, 0x3d423f85, v22
    v_mul_f32 v20, 0xbc2aaaab, v20
    v_fma_f32 v24, -v21, v21, v24
    v_max_f32 v24, 0x383ef424, v24
    v_rsq_f32 v22, v24
    s_nop 0
    v_mul_f32 v23, v20, v22
    s_mov_b64 exec, s[64:65]
    v_pk_fma_f32 v[64:65], v[64:65], v[22:23], v[22:23] op_sel:[0,0,1] op_sel_hi:[1,0,1]
    v_pk_fma_f32 v[66:67], v[66:67], v[22:23], v[22:23] op_sel:[0,0,1] op_sel_hi:[1,0,1]
    v_pk_fma_f32 v[68:69], v[68:69], v[22:23], v[22:23] op_sel:[0,0,1] op_sel_hi:[1,0,1]
    v_pk_fma_f32 v[70:71], v[70:71], v[22:23], v[22:23] op_sel:[0,0,1] op_sel_hi:[1,0,1]
    v_cvt_pk_bf16_f32 v64, v64, v65
    v_cvt_pk_bf16_f32 v65, v66, v67
    v_cvt_pk_bf16_f32 v66, v68, v69
    v_cvt_pk_bf16_f32 v67, v70, v71
    ds_write_b128 v29, v[64:67] offset:0
    v_pk_fma_f32 v[72:73], v[72:73], v[22:23], v[22:23] op_sel:[0,0,1] op_sel_hi:[1,0,1]
    v_pk_fma_f32 v[74:75], v[74:75], v[22:23], v[22:23] op_sel:[0,0,1] op_sel_hi:[1,0,1]
    v_pk_fma_f32 v[76:77], v[76:77], v[22:23], v[22:23] op_sel:[0,0,1] op_sel_hi:[1,0,1]
    v_pk_fma_f32 v[78:79], v[78:79], v[22:23], v[22:23] op_sel:[0,0,1] op_sel_hi:[1,0,1]
    v_cvt_pk_bf16_f32 v72, v72, v73
    v_cvt_pk_bf16_f32 v73, v74, v75
    v_cvt_pk_bf16_f32 v74, v76, v77
    v_cvt_pk_bf16_f32 v75, v78, v79
    ds_write_b128 v29, v[72:75] offset:1024
    v_pk_fma_f32 v[80:81], v[80:81], v[22:23], v[22:23] op_sel:[0,0,1] op_sel_hi:[1,0,1]
    v_pk_fma_f32 v[82:83], v[82:83], v[22:23], v[22:23] op_sel:[0,0,1] op_sel_hi:[1,0,1]
    v_pk_fma_f32 v[84:85], v[84:85], v[22:23], v[22:23] op_sel:[0,0,1] op_sel_hi:[1,0,1]
    v_pk_fma_f32 v[86:87], v[86:87], v[22:23], v[22:23] op_sel:[0,0,1] op_sel_hi:[1,0,1]
    v_cvt_pk_bf16_f32 v80, v80, v81
    v_cvt_pk_bf16_f32 v81, v82, v83
    v_cvt_pk_bf16_f32 v82, v84, v85
    v_cvt_pk_bf16_f32 v83, v86, v87
    ds_write_b128 v29, v[80:83] offset:2048
    v_pk_fma_f32 v[88:89], v[88:89], v[22:23], v[22:23] op_sel:[0,0,1] op_sel_hi:[1,0,1]
    v_pk_fma_f32 v[90:91], v[90:91], v[22:23], v[22:23] op_sel:[0,0,1] op_sel_hi:[1,0,1]
    v_pk_fma_f32 v[92:93], v[92:93], v[22:23], v[22:23] op_sel:[0,0,1] op_sel_hi:[1,0,1]
    v_pk_fma_f32 v[94:95], v[94:95], v[22:23], v[22:23] op_sel:[0,0,1] op_sel_hi:[1,0,1]
    v_cvt_pk_bf16_f32 v88, v88, v89
    v_cvt_pk_bf16_f32 v89, v90, v91
    v_cvt_pk_bf16_f32 v90, v92, v93
    v_cvt_pk_bf16_f32 v91, v94, v95
    ds_write_b128 v29, v[88:91] offset:3072
    v_pk_fma_f32 v[96:97], v[96:97], v[22:23], v[22:23] op_sel:[0,0,1] op_sel_hi:[1,0,1]
    v_pk_fma_f32 v[98:99], v[98:99], v[22:23], v[22:23] op_sel:[0,0,1] op_sel_hi:[1,0,1]
    v_pk_fma_f32 v[100:101], v[100:101], v[22:23], v[22:23] op_sel:[0,0,1] op_sel_hi:[1,0,1]
    v_pk_fma_f32 v[102:103], v[102:103], v[22:23], v[22:23] op_sel:[0,0,1] op_sel_hi:[1,0,1]
    v_cvt_pk_bf16_f32 v96, v96, v97
    v_cvt_pk_bf16_f32 v97, v98, v99
    v_cvt_pk_bf16_f32 v98, v100, v101
    v_cvt_pk_bf16_f32 v99, v102, v103
    ds_write_b128 v29, v[96:99] offset:4096
    v_pk_fma_f32 v[104:105], v[104:105], v[22:23], v[22:23] op_sel:[0,0,1] op_sel_hi:[1,0,1]
    v_pk_fma_f32 v[106:107], v[106:107], v[22:23], v[22:23] op_sel:[0,0,1] op_sel_hi:[1,0,1]
    v_pk_fma_f32 v[108:109], v[108:109], v[22:23], v[22:23] op_sel:[0,0,1] op_sel_hi:[1,0,1]
    v_pk_fma_f32 v[110:111], v[110:111], v[22:23], v[22:23] op_sel:[0,0,1] op_sel_hi:[1,0,1]
    v_cvt_pk_bf16_f32 v104, v104, v105
    v_cvt_pk_bf16_f32 v105, v106, v107
    v_cvt_pk_bf16_f32 v106, v108, v109
    v_cvt_pk_bf16_f32 v107, v110, v111
    ds_write_b128 v29, v[104:107] offset:5120
    s_mov_b64 exec, -1
    s_waitcnt vmcnt(0)
    s_cmp_ge_u32 s59, 24
    s_cbranch_scc1 L_NOBIAS
    s_mov_b32 s47, 0x05040100
    s_mov_b32 s48, 0x07060302
    v_perm_b32 v84, v50, v48, s47
    v_perm_b32 v85, v50, v48, s48
    v_perm_b32 v86, v51, v49, s47
    v_perm_b32 v87, v51, v49, s48
    v_dot2_f32_bf16 v88, v84, v60, 0
    v_dot2_f32_bf16 v89, v85, v60, 0
    v_dot2_f32_bf16 v90, v86, v60, 0
    v_dot2_f32_bf16 v91, v87, v60, 0
    v_perm_b32 v84, v54, v52, s47
    v_perm_b32 v85, v54, v52, s48
    v_perm_b32 v86, v55, v53, s47
    v_perm_b32 v87, v55, v53, s48
    v_dot2_f32_bf16 v88, v84, v61, v88
    v_dot2_f32_bf16 v89, v85, v61, v89
    v_dot2_f32_bf16 v90, v86, v61, v90
    v_dot2_f32_bf16 v91, v87, v61, v91
    v_perm_b32 v84, v58, v56, s47
    v_perm_b32 v85, v58, v56, s48
    v_perm_b32 v86, v59, v57, s47
    v_perm_b32 v87, v59, v57, s48
    v_dot2_f32_bf16 v88, v84, v62, v88
    v_dot2_f32_bf16 v89, v85, v62, v89
    v_dot2_f32_bf16 v90, v86, v62, v90
    v_dot2_f32_bf16 v91, v87, v62, v91
    v_lshrrev_b32_e64 v10, 5, v0
    v_bfe_u32 v11, v0, 4, 1
    v_permlane32_swap_b32 v88, v89
    v_permlane32_swap_b32 v90, v91
    v_lshl_add_u32 v10, v11, 1, v10
    v_add_f32 v88, v88, v89
    v_add_f32 v90, v90, v91
    v_lshlrev_b32_e64 v10, 2, v10
    v_cmp_eq_u32_e64 vcc, 0, v1
    v_permlane16_swap_b32 v88, v90
    s_lshl_b32 s47, s59, 4
    s_add_u32 s47, s47, 425984
    v_add_f32_e64 v88, v88, v90
    v_cndmask_b32_e64 v10, v8, v10, vcc
    s_nop 0
    v_add_f32_dpp v88, v88, v88 row_ror:1 row_mask:0xf bank_mask:0xf
    s_nop 1
    v_add_f32_dpp v88, v88, v88 row_ror:2 row_mask:0xf bank_mask:0xf
    s_nop 1
    v_add_f32_dpp v88, v88, v88 row_ror:4 row_mask:0xf bank_mask:0xf
    s_nop 1
    v_add_f32_dpp v88, v88, v88 row_ror:8 row_mask:0xf bank_mask:0xf
    buffer_store_dword v88, v10, s[40:43], s47 offen sc1
L_NOBIAS:
    s_mov_b64 exec, 0
    s_branch L_PAD9
L_BACKD:
    s_mov_b64 exec, -1
    s_waitcnt lgkmcnt(0)
L_CONVDONE:
L_PAD3:
    s_cbranch_execz L_PAD7
    s_barrier
    ds_read_b64_tr_b16 a[144:145], v30 offset:0
    ds_read_b64_tr_b16 a[146:147], v30 offset:1536
    ds_read_b128 a[0:3], v18 offset:0
    ds_read_b64_tr_b16 a[148:149], v30 offset:3072
    ds_read_b64_tr_b16 a[150:151], v30 offset:4608
    ds_read_b128 a[4:7], v18 offset:1024
    ds_read_b64_tr_b16 a[152:153], v30 offset:6144
    ds_read_b64_tr_b16 a[154:155], v30 offset:7680
    ds_read_b128 a[8:11], v18 offset:2048
    ds_read_b64_tr_b16 a[156:157], v30 offset:9216
    ds_read_b64_tr_b16 a[158:159], v30 offset:10752
    ds_read_b128 a[12:15], v18 offset:3072
    ds_read_b64_tr_b16 a[160:161], v30 offset:12288
    ds_read_b64_tr_b16 a[162:163], v30 offset:13824
    ds_read_b128 a[16:19], v18 offset:4096
    ds_read_b64_tr_b16 a[164:165], v30 offset:15360
    ds_read_b64_tr_b16 a[166:167], v30 offset:16896
    ds_read_b128 a[20:23], v18 offset:5120
    s_waitcnt lgkmcnt(15)
    v_mfma_f32_32x32x16_bf16 v[64:79], a[0:3], a[144:147], 0
    ds_read_b128 a[24:27], v18 offset:6144
    ds_read_b128 a[28:31], v18 offset:7168
    global_load_dwordx4 a[240:243], v17, s[66:67] offset:0
    s_waitcnt lgkmcnt(14)
    v_mfma_f32_32x32x16_bf16 v[64:79], a[4:7], a[148:151], v[64:79]
    ds_read_b128 a[32:35], v18 offset:8192
    ds_read_b128 a[36:39], v18 offset:9216
    global_load_dwordx4 a[244:247], v15, s[66:67] offset:-4096
    s_waitcnt lgkmcnt(13)
    v_mfma_f32_32x32x16_bf16 v[64:79], a[8:11], a[152:155], v[64:79]
    ds_read_b128 a[40:43], v18 offset:10240
    ds_read_b128 a[44:47], v18 offset:11264
    global_load_dwordx4 a[248:251], v15, s[66:67] offset:0
    s_waitcnt lgkmcnt(12)
    v_mfma_f32_32x32x16_bf16 v[64:79], a[12:15], a[156:159], v[64:79]
    ds_read_b128 a[48:51], v18 offset:12288
    ds_read_b128 a[52:55], v18 offset:13312
    global_load_dwordx4 a[252:255], v16, s[66:67] offset:-4096
    s_waitcnt lgkmcnt(11)
    v_mfma_f32_32x32x16_bf16 v[64:79], a[16:19], a[160:163], v[64:79]
    ds_read_b128 a[56:59], v18 offset:14336
    ds_read_b128 a[60:63], v18 offset:15360
    s_waitcnt lgkmcnt(10)
    v_mfma_f32_32x32x16_bf16 v[64:79], a[20:23], a[164:167], v[64:79]
    ds_read_b128 a[64:67], v18 offset:16384
    ds_read_b128 a[68:71], v18 offset:17408
    ds_read_b128 a[72:75], v18 offset:18432
    ds_read_b128 a[76:79], v18 offset:19456
    ds_read_b128 a[80:83], v18 offset:20480
    s_nop 0
    ds_read_b128 a[84:87], v18 offset:21504
    s_nop 5
    v_pk_fma_f32 v[96:97], v[64:65], v[64:65], s[60:61] neg_lo:[1,0,0] neg_hi:[1,0,0]
    v_pk_fma_f32 v[98:99], v[66:67], v[66:67], s[60:61] neg_lo:[1,0,0] neg_hi:[1,0,0]
    v_pk_fma_f32 v[100:101], v[68:69], v[68:69], s[60:61] neg_lo:[1,0,0] neg_hi:[1,0,0]
    v_pk_fma_f32 v[102:103], v[70:71], v[70:71], s[60:61] neg_lo:[1,0,0] neg_hi:[1,0,0]
    v_pk_fma_f32 v[104:105], v[72:73], v[72:73], s[60:61] neg_lo:[1,0,0] neg_hi:[1,0,0]
    v_pk_fma_f32 v[106:107], v[74:75], v[74:75], s[60:61] neg_lo:[1,0,0] neg_hi:[1,0,0]
    v_pk_fma_f32 v[108:109], v[76:77], v[76:77], s[60:61] neg_lo:[1,0,0] neg_hi:[1,0,0]
    v_pk_fma_f32 v[110:111], v[78:79], v[78:79], s[60:61] neg_lo:[1,0,0] neg_hi:[1,0,0]
    v_pk_mul_f32 v[96:97], v[64:65], v[96:97]
    v_pk_mul_f32 v[98:99], v[66:67], v[98:99]
    v_pk_mul_f32 v[100:101], v[68:69], v[100:101]
    v_pk_mul_f32 v[102:103], v[70:71], v[102:103]
    v_pk_mul_f32 v[104:105], v[72:73], v[104:105]
    v_pk_mul_f32 v[106:107], v[74:75], v[106:107]
    v_pk_mul_f32 v[108:109], v[76:77], v[108:109]
    v_pk_mul_f32 v[110:111], v[78:79], v[110:111]
    s_waitcnt lgkmcnt(6)
    v_mfma_f32_32x32x16_bf16 v[80:95], a[24:27], a[144:147], 0
    ds_read_b128 a[88:91], v18 offset:22528
    ds_read_b128 a[92:95], v18 offset:23552
    v_exp_f32 v96, v96
    v_exp_f32 v97, v97
    v_exp_f32 v98, v98
    v_mfma_f32_32x32x16_bf16 v[80:95], a[28:31], a[148:151], v[80:95]
    ds_read_b128 a[96:99], v19 offset:0
    ds_read_b128 a[100:103], v19 offset:1024
    v_exp_f32 v99, v99
    v_exp_f32 v100, v100
    v_exp_f32_e64 v101, v101
    v_mfma_f32_32x32x16_bf16 v[80:95], a[32:35], a[152:155], v[80:95]
    ds_read_b128 a[104:107], v19 offset:2048
    ds_read_b128 a[108:111], v19 offset:3072
    v_exp_f32 v102, v102
    v_exp_f32 v103, v103
    v_exp_f32 v104, v104
    v_exp_f32 v105, v105
    v_exp_f32 v106, v106
    v_exp_f32 v107, v107
    v_exp_f32 v108, v108
    v_exp_f32 v109, v109
    v_exp_f32 v110, v110
    v_exp_f32 v111, v111
    v_pk_add_f32 v[96:97], v[96:97], 1.0 op_sel_hi:[1,0]
    v_pk_add_f32 v[98:99], v[98:99], 1.0 op_sel_hi:[1,0]
    v_pk_add_f32 v[100:101], v[100:101], 1.0 op_sel_hi:[1,0]
    v_pk_add_f32 v[102:103], v[102:103], 1.0 op_sel_hi:[1,0]
    v_pk_add_f32 v[104:105], v[104:105], 1.0 op_sel_hi:[1,0]
    v_pk_add_f32 v[106:107], v[106:107], 1.0 op_sel_hi:[1,0]
    v_pk_add_f32 v[108:109], v[108:109], 1.0 op_sel_hi:[1,0]
    v_pk_add_f32 v[110:111], v[110:111], 1.0 op_sel_hi:[1,0]
    v_mfma_f32_32x32x16_bf16 v[80:95], a[36:39], a[156:159], v[80:95]
    ds_read_b128 a[112:115], v19 offset:4096
    ds_read_b128 a[116:119], v19 offset:5120
    v_rcp_f32 v96, v96
    v_rcp_f32 v97, v97
    v_rcp_f32 v98, v98
    v_mfma_f32_32x32x16_bf16 v[80:95], a[40:43], a[160:163], v[80:95]
    v_rcp_f32 v99, v99
    v_rcp_f32 v100, v100
    v_rcp_f32 v101, v101
    v_mfma_f32_32x32x16_bf16 v[80:95], a[44:47], a[164:167], v[80:95]
    v_rcp_f32 v102, v102
    v_rcp_f32 v103, v103
    v_rcp_f32 v104, v104
    v_rcp_f32 v105, v105
    v_rcp_f32 v106, v106
    v_rcp_f32 v107, v107
    v_rcp_f32 v108, v108
    v_rcp_f32 v109, v109
    v_rcp_f32 v110, v110
    v_rcp_f32 v111, v111
    v_pk_mul_f32 v[96:97], v[64:65], v[96:97]
    v_pk_mul_f32 v[98:99], v[66:67], v[98:99]
    v_pk_mul_f32 v[100:101], v[68:69], v[100:101]
    v_pk_mul_f32 v[102:103], v[70:71], v[102:103]
    v_pk_mul_f32 v[104:105], v[72:73], v[104:105]
    v_pk_mul_f32 v[106:107], v[74:75], v[106:107]
    v_pk_mul_f32 v[108:109], v[76:77], v[108:109]
    v_pk_mul_f32 v[110:111], v[78:79], v[110:111]
    v_pk_mul_f32 v[48:49], v[96:97], v[96:97]
    v_pk_mul_f32 v[50:51], v[98:99], v[98:99]
    v_pk_mul_f32 v[52:53], v[100:101], v[100:101]
    v_pk_mul_f32 v[54:55], v[102:103], v[102:103]
    v_pk_fma_f32 v[48:49], v[104:105], v[104:105], v[48:49]
    v_pk_fma_f32 v[50:51], v[106:107], v[106:107], v[50:51]
    v_pk_fma_f32 v[52:53], v[108:109], v[108:109], v[52:53]
    v_pk_fma_f32 v[54:55], v[110:111], v[110:111], v[54:55]
    v_cvt_pk_bf16_f32 v112, v96, v97
    v_cvt_pk_bf16_f32 v113, v98, v99
    v_cvt_pk_bf16_f32 v114, v100, v101
    v_cvt_pk_bf16_f32 v115, v102, v103
    v_cvt_pk_bf16_f32 v116, v104, v105
    v_cvt_pk_bf16_f32 v117, v106, v107
    v_cvt_pk_bf16_f32 v118, v108, v109
    v_cvt_pk_bf16_f32 v119, v110, v111
    v_pk_fma_f32 v[96:97], v[80:81], v[80:81], s[60:61] neg_lo:[1,0,0] neg_hi:[1,0,0]
    v_pk_fma_f32 v[98:99], v[82:83], v[82:83], s[60:61] neg_lo:[1,0,0] neg_hi:[1,0,0]
    v_pk_fma_f32 v[100:101], v[84:85], v[84:85], s[60:61] neg_lo:[1,0,0] neg_hi:[1,0,0]
    v_pk_fma_f32 v[102:103], v[86:87], v[86:87], s[60:61] neg_lo:[1,0,0] neg_hi:[1,0,0]
    v_pk_fma_f32 v[104:105], v[88:89], v[88:89], s[60:61] neg_lo:[1,0,0] neg_hi:[1,0,0]
    v_pk_fma_f32 v[106:107], v[90:91], v[90:91], s[60:61] neg_lo:[1,0,0] neg_hi:[1,0,0]
    v_pk_fma_f32 v[108:109], v[92:93], v[92:93], s[60:61] neg_lo:[1,0,0] neg_hi:[1,0,0]
    v_pk_fma_f32 v[110:111], v[94:95], v[94:95], s[60:61] neg_lo:[1,0,0] neg_hi:[1,0,0]
    v_pk_mul_f32 v[96:97], v[80:81], v[96:97]
    v_pk_mul_f32 v[98:99], v[82:83], v[98:99]
    v_pk_mul_f32 v[100:101], v[84:85], v[100:101]
    v_pk_mul_f32 v[102:103], v[86:87], v[102:103]
    v_pk_mul_f32 v[104:105], v[88:89], v[104:105]
    v_pk_mul_f32 v[106:107], v[90:91], v[106:107]
    v_pk_mul_f32 v[108:109], v[92:93], v[108:109]
    v_pk_mul_f32 v[110:111], v[94:95], v[110:111]
    v_mfma_f32_32x32x16_bf16 v[64:79], a[48:51], a[144:147], 0
    ds_read_b128 a[120:123], v19 offset:6144
    ds_read_b128 a[124:127], v19 offset:7168
    v_exp_f32 v96, v96
    v_exp_f32 v97, v97
    v_exp_f32_e64 v98, v98
    v_mfma_f32_32x32x16_bf16 v[64:79], a[52:55], a[148:151], v[64:79]
    ds_read_b128 a[128:131], v19 offset:8192
    ds_read_b128 a[132:135], v19 offset:9216
    v_exp_f32 v99, v99
    v_exp_f32 v100, v100
    v_exp_f32 v101, v101
    v_mfma_f32_32x32x16_bf16 v[64:79], a[56:59], a[152:155], v[64:79]
    ds_read_b128 a[136:139], v19 offset:10240
    ds_read_b128 a[140:143], v19 offset:11264
    v_exp_f32 v102, v102
    v_exp_f32 v103, v103
    v_exp_f32 v104, v104
    v_exp_f32 v105, v105
    v_exp_f32 v106, v106
    v_exp_f32 v107, v107
    v_exp_f32 v108, v108
    v_exp_f32 v109, v109
    v_exp_f32 v110, v110
    v_exp_f32_e64 v111, v111
    v_pk_add_f32 v[96:97], v[96:97], 1.0 op_sel_hi:[1,0]
    v_pk_add_f32 v[98:99], v[98:99], 1.0 op_sel_hi:[1,0]
    v_pk_add_f32 v[100:101], v[100:101], 1.0 op_sel_hi:[1,0]
    v_pk_add_f32 v[102:103], v[102:103], 1.0 op_sel_hi:[1,0]
    v_pk_add_f32 v[104:105], v[104:105], 1.0 op_sel_hi:[1,0]
    v_pk_add_f32 v[106:107], v[106:107], 1.0 op_sel_hi:[1,0]
    v_pk_add_f32 v[108:109], v[108:109], 1.0 op_sel_hi:[1,0]
    v_pk_add_f32 v[110:111], v[110:111], 1.0 op_sel_hi:[1,0]
    v_mfma_f32_32x32x16_bf16 v[64:79], a[60:63], a[156:159], v[64:79]
    ds_read_b128 a[216:219], v18 offset:34816
    ds_read_b128 a[220:223], v18 offset:35840
    v_rcp_f32 v96, v96
    v_rcp_f32 v97, v97
    v_rcp_f32 v98, v98
    s_waitcnt lgkmcnt(2)
    v_mfma_f32_32x32x16_bf16 v[64:79], a[64:67], a[160:163], v[64:79]
    ds_read_b128 a[224:227], v18 offset:36864
    ds_read_b128 a[228:231], v18 offset:37888
    v_rcp_f32 v99, v99
    v_rcp_f32 v100, v100
    v_rcp_f32_e64 v101, v101
    v_mfma_f32_32x32x16_bf16 v[64:79], a[68:71], a[164:167], v[64:79]
    ds_read_b128 a[232:235], v18 offset:38912
    ds_read_b128 a[236:239], v18 offset:39936
    v_rcp_f32 v102, v102
    v_rcp_f32 v103, v103
    v_rcp_f32 v104, v104
    v_rcp_f32 v105, v105
    v_rcp_f32 v106, v106
    v_rcp_f32 v107, v107
    v_rcp_f32 v108, v108
    v_rcp_f32 v109, v109
    v_rcp_f32 v110, v110
    v_rcp_f32 v111, v111
    v_pk_mul_f32 v[96:97], v[80:81], v[96:97]
    v_pk_mul_f32 v[98:99], v[82:83], v[98:99]
    v_pk_mul_f32 v[100:101], v[84:85], v[100:101]
    v_pk_mul_f32 v[102:103], v[86:87], v[102:103]
    v_pk_mul_f32 v[104:105], v[88:89], v[104:105]
    v_pk_mul_f32 v[106:107], v[90:91], v[106:107]
    v_pk_mul_f32 v[108:109], v[92:93], v[108:109]
    v_pk_mul_f32 v[110:111], v[94:95], v[110:111]
    v_pk_fma_f32 v[48:49], v[96:97], v[96:97], v[48:49]
    v_pk_fma_f32 v[50:51], v[98:99], v[98:99], v[50:51]
    v_pk_fma_f32 v[52:53], v[100:101], v[100:101], v[52:53]
    v_pk_fma_f32 v[54:55], v[102:103], v[102:103], v[54:55]
    v_pk_fma_f32 v[48:49], v[104:105], v[104:105], v[48:49]
    v_pk_fma_f32 v[50:51], v[106:107], v[106:107], v[50:51]
    v_pk_fma_f32 v[52:53], v[108:109], v[108:109], v[52:53]
    v_pk_fma_f32 v[54:55], v[110:111], v[110:111], v[54:55]
    v_cvt_pk_bf16_f32 v120, v96, v97
    v_cvt_pk_bf16_f32 v121, v98, v99
    v_cvt_pk_bf16_f32 v122, v100, v101
    v_cvt_pk_bf16_f32 v123, v102, v103
    v_cvt_pk_bf16_f32 v124, v104, v105
    v_cvt_pk_bf16_f32 v125, v106, v107
    v_cvt_pk_bf16_f32 v126, v108, v109
    v_cvt_pk_bf16_f32 v127, v110, v111
    v_pk_fma_f32 v[96:97], v[64:65], v[64:65], s[60:61] neg_lo:[1,0,0] neg_hi:[1,0,0]
    v_pk_fma_f32 v[98:99], v[66:67], v[66:67], s[60:61] neg_lo:[1,0,0] neg_hi:[1,0,0]
    v_pk_fma_f32 v[100:101], v[68:69], v[68:69], s[60:61] neg_lo:[1,0,0] neg_hi:[1,0,0]
    v_pk_fma_f32 v[102:103], v[70:71], v[70:71], s[60:61] neg_lo:[1,0,0] neg_hi:[1,0,0]
    v_pk_fma_f32 v[104:105], v[72:73], v[72:73], s[60:61] neg_lo:[1,0,0] neg_hi:[1,0,0]
    v_pk_fma_f32 v[106:107], v[74:75], v[74:75], s[60:61] neg_lo:[1,0,0] neg_hi:[1,0,0]
    v_pk_fma_f32 v[108:109], v[76:77], v[76:77], s[60:61] neg_lo:[1,0,0] neg_hi:[1,0,0]
    v_pk_fma_f32 v[110:111], v[78:79], v[78:79], s[60:61] neg_lo:[1,0,0] neg_hi:[1,0,0]
    v_pk_mul_f32 v[96:97], v[64:65], v[96:97]
    v_pk_mul_f32 v[98:99], v[66:67], v[98:99]
    v_pk_mul_f32 v[100:101], v[68:69], v[100:101]
    v_pk_mul_f32 v[102:103], v[70:71], v[102:103]
    v_pk_mul_f32 v[104:105], v[72:73], v[104:105]
    v_pk_mul_f32 v[106:107], v[74:75], v[106:107]
    v_pk_mul_f32 v[108:109], v[76:77], v[108:109]
    v_pk_mul_f32 v[110:111], v[78:79], v[110:111]
    v_mfma_f32_32x32x16_bf16 v[80:95], a[72:75], a[144:147], 0
    ds_read_b64_tr_b16 a[168:169], v30 offset:64
    ds_read_b64_tr_b16 a[170:171], v30 offset:1600
    s_lshl_b32 s47, s3, 2
    s_waitcnt vmcnt(0)
    buffer_store_dword v13, v38, s[12:15], s47 offen sc1
    v_exp_f32 v96, v96
    v_exp_f32 v97, v97
    v_exp_f32 v98, v98
    s_waitcnt lgkmcnt(2)
    v_mfma_f32_32x32x16_bf16 v[208:223], a[216:219], a[144:147], 0
    ds_read_b64_tr_b16 a[172:173], v30 offset:3136
    ds_read_b64_tr_b16 a[174:175], v30 offset:4672
    v_exp_f32 v99, v99
    v_exp_f32 v100, v100
    v_exp_f32_e64 v101, v101
    v_mfma_f32_32x32x16_bf16 v[80:95], a[76:79], a[148:151], v[80:95]
    ds_read_b64_tr_b16 a[176:177], v30 offset:6208
    ds_read_b64_tr_b16 a[178:179], v30 offset:7744
    v_exp_f32 v102, v102
    v_exp_f32 v103, v103
    v_exp_f32_e64 v104, v104
    v_mfma_f32_32x32x16_bf16 v[80:95], a[80:83], a[152:155], v[80:95]
    ds_read_b64_tr_b16 a[180:181], v30 offset:9280
    ds_read_b64_tr_b16 a[182:183], v30 offset:10816
    v_exp_f32 v105, v105
    v_exp_f32 v106, v106
    v_exp_f32 v107, v107
    v_exp_f32 v108, v108
    v_exp_f32 v109, v109
    v_exp_f32 v110, v110
    v_exp_f32_e64 v111, v111
    v_pk_add_f32 v[96:97], v[96:97], 1.0 op_sel_hi:[1,0]
    v_pk_add_f32 v[98:99], v[98:99], 1.0 op_sel_hi:[1,0]
    v_pk_add_f32 v[100:101], v[100:101], 1.0 op_sel_hi:[1,0]
    v_pk_add_f32 v[102:103], v[102:103], 1.0 op_sel_hi:[1,0]
    v_pk_add_f32 v[104:105], v[104:105], 1.0 op_sel_hi:[1,0]
    v_pk_add_f32 v[106:107], v[106:107], 1.0 op_sel_hi:[1,0]
    v_pk_add_f32 v[108:109], v[108:109], 1.0 op_sel_hi:[1,0]
    v_pk_add_f32 v[110:111], v[110:111], 1.0 op_sel_hi:[1,0]
    v_mfma_f32_32x32x16_bf16 v[80:95], a[84:87], a[156:159], v[80:95]
    ds_read_b64_tr_b16 a[184:185], v30 offset:12352
    ds_read_b64_tr_b16 a[186:187], v30 offset:13888
    v_rcp_f32 v96, v96
    v_rcp_f32 v97, v97
    v_rcp_f32_e64 v98, v98
    v_mfma_f32_32x32x16_bf16 v[208:223], a[220:223], a[148:151], v[208:223]
    ds_read_b64_tr_b16 a[188:189], v30 offset:15424
    ds_read_b64_tr_b16 a[190:191], v30 offset:16960
    v_rcp_f32 v99, v99
    v_rcp_f32 v100, v100
    v_rcp_f32 v101, v101
    v_mfma_f32_32x32x16_bf16 v[80:95], a[88:91], a[160:163], v[80:95]
    v_rcp_f32 v102, v102
    v_rcp_f32 v103, v103
    v_rcp_f32 v104, v104
    v_mfma_f32_32x32x16_bf16 v[80:95], a[92:95], a[164:167], v[80:95]
    v_rcp_f32 v105, v105
    v_rcp_f32 v106, v106
    v_rcp_f32 v107, v107
    v_rcp_f32 v108, v108
    v_rcp_f32 v109, v109
    v_rcp_f32 v110, v110
    v_rcp_f32_e64 v111, v111
    v_pk_mul_f32 v[96:97], v[64:65], v[96:97]
    v_pk_mul_f32 v[98:99], v[66:67], v[98:99]
    v_pk_mul_f32 v[100:101], v[68:69], v[100:101]
    v_pk_mul_f32 v[102:103], v[70:71], v[102:103]
L_PAD4:
    s_cbranch_execz L_BACKA
    v_pk_mul_f32 v[104:105], v[72:73], v[104:105]
    v_pk_mul_f32 v[106:107], v[74:75], v[106:107]
    s_nop 0
    v_pk_mul_f32 v[108:109], v[76:77], v[108:109]
    v_pk_mul_f32 v[110:111], v[78:79], v[110:111]
    v_pk_fma_f32 v[48:49], v[96:97], v[96:97], v[48:49]
    v_pk_fma_f32 v[50:51], v[98:99], v[98:99], v[50:51]
    v_pk_fma_f32 v[52:53], v[100:101], v[100:101], v[52:53]
    v_pk_fma_f32 v[54:55], v[102:103], v[102:103], v[54:55]
    v_pk_fma_f32 v[48:49], v[104:105], v[104:105], v[48:49]
    v_pk_fma_f32 v[50:51], v[106:107], v[106:107], v[50:51]
    v_pk_fma_f32 v[52:53], v[108:109], v[108:109], v[52:53]
    v_pk_fma_f32 v[54:55], v[110:111], v[110:111], v[54:55]
    v_cvt_pk_bf16_f32 v128, v96, v97
    v_cvt_pk_bf16_f32 v129, v98, v99
    v_cvt_pk_bf16_f32 v130, v100, v101
    v_cvt_pk_bf16_f32 v131, v102, v103
    v_cvt_pk_bf16_f32 v132, v104, v105
    v_cvt_pk_bf16_f32 v133, v106, v107
    v_cvt_pk_bf16_f32 v134, v108, v109
    v_cvt_pk_bf16_f32 v135, v110, v111
    v_pk_fma_f32 v[96:97], v[80:81], v[80:81], s[60:61] neg_lo:[1,0,0] neg_hi:[1,0,0]
    v_pk_fma_f32 v[98:99], v[82:83], v[82:83], s[60:61] neg_lo:[1,0,0] neg_hi:[1,0,0]
    v_pk_fma_f32 v[100:101], v[84:85], v[84:85], s[60:61] neg_lo:[1,0,0] neg_hi:[1,0,0]
    v_pk_fma_f32 v[102:103], v[86:87], v[86:87], s[60:61] neg_lo:[1,0,0] neg_hi:[1,0,0]
    v_pk_fma_f32 v[104:105], v[88:89], v[88:89], s[60:61] neg_lo:[1,0,0] neg_hi:[1,0,0]
    v_pk_fma_f32 v[106:107], v[90:91], v[90:91], s[60:61] neg_lo:[1,0,0] neg_hi:[1,0,0]
    v_pk_fma_f32 v[108:109], v[92:93], v[92:93], s[60:61] neg_lo:[1,0,0] neg_hi:[1,0,0]
    v_pk_fma_f32 v[110:111], v[94:95], v[94:95], s[60:61] neg_lo:[1,0,0] neg_hi:[1,0,0]
    v_pk_mul_f32 v[96:97], v[80:81], v[96:97]
    v_pk_mul_f32 v[98:99], v[82:83], v[98:99]
    v_pk_mul_f32 v[100:101], v[84:85], v[100:101]
    v_pk_mul_f32 v[102:103], v[86:87], v[102:103]
    v_pk_mul_f32 v[104:105], v[88:89], v[104:105]
    v_pk_mul_f32 v[106:107], v[90:91], v[106:107]
    v_pk_mul_f32 v[108:109], v[92:93], v[108:109]
    v_pk_mul_f32 v[110:111], v[94:95], v[110:111]
    v_mfma_f32_32x32x16_bf16 v[64:79], a[96:99], a[144:147], 0
    ds_read_b64_tr_b16 a[192:193], v30 offset:128
    ds_read_b64_tr_b16 a[194:195], v30 offset:1664
    v_exp_f32 v96, v96
    v_exp_f32 v97, v97
    v_exp_f32_e64 v98, v98
    v_mfma_f32_32x32x16_bf16 v[208:223], a[224:227], a[152:155], v[208:223]
    ds_read_b64_tr_b16 a[196:197], v30 offset:3200
    ds_read_b64_tr_b16 a[198:199], v30 offset:4736
    v_exp_f32 v99, v99
    v_exp_f32 v100, v100
    v_exp_f32_e64 v101, v101
    v_mfma_f32_32x32x16_bf16 v[64:79], a[100:103], a[148:151], v[64:79]
    ds_read_b64_tr_b16 a[200:201], v30 offset:6272
    ds_read_b64_tr_b16 a[202:203], v30 offset:7808
    v_exp_f32 v102, v102
    v_exp_f32 v103, v103
    v_exp_f32_e64 v104, v104
    v_mfma_f32_32x32x16_bf16 v[64:79], a[104:107], a[152:155], v[64:79]
    ds_read_b64_tr_b16 a[204:205], v30 offset:9344
    ds_read_b64_tr_b16 a[206:207], v30 offset:10880
    v_exp_f32 v105, v105
    v_exp_f32 v106, v106
    v_exp_f32 v107, v107
    v_exp_f32 v108, v108
    v_exp_f32 v109, v109
    v_exp_f32 v110, v110
    v_exp_f32_e64 v111, v111
    v_pk_add_f32 v[96:97], v[96:97], 1.0 op_sel_hi:[1,0]
    v_pk_add_f32 v[98:99], v[98:99], 1.0 op_sel_hi:[1,0]
    v_pk_add_f32 v[100:101], v[100:101], 1.0 op_sel_hi:[1,0]
    v_pk_add_f32 v[102:103], v[102:103], 1.0 op_sel_hi:[1,0]
    v_pk_add_f32 v[104:105], v[104:105], 1.0 op_sel_hi:[1,0]
    v_pk_add_f32 v[106:107], v[106:107], 1.0 op_sel_hi:[1,0]
    v_pk_add_f32 v[108:109], v[108:109], 1.0 op_sel_hi:[1,0]
    v_pk_add_f32 v[110:111], v[110:111], 1.0 op_sel_hi:[1,0]
    v_mfma_f32_32x32x16_bf16 v[64:79], a[108:111], a[156:159], v[64:79]
    ds_read_b64_tr_b16 a[208:209], v30 offset:12416
    ds_read_b64_tr_b16 a[210:211], v30 offset:13952
    v_rcp_f32 v96, v96
    v_rcp_f32 v97, v97
    v_rcp_f32_e64 v98, v98
    v_mfma_f32_32x32x16_bf16 v[208:223], a[228:231], a[156:159], v[208:223]
    ds_read_b64_tr_b16 a[212:213], v30 offset:15488
    ds_read_b64_tr_b16 a[214:215], v30 offset:17024
    v_rcp_f32 v99, v99
    v_rcp_f32 v100, v100
    v_rcp_f32 v101, v101
    v_mfma_f32_32x32x16_bf16 v[64:79], a[112:115], a[160:163], v[64:79]
    v_rcp_f32 v102, v102
    v_rcp_f32 v103, v103
    v_rcp_f32 v104, v104
    v_mfma_f32_32x32x16_bf16 v[64:79], a[116:119], a[164:167], v[64:79]
    v_rcp_f32 v105, v105
    v_rcp_f32 v106, v106
    v_rcp_f32 v107, v107
    v_rcp_f32 v108, v108
    v_rcp_f32 v109, v109
    v_rcp_f32 v110, v110
    v_rcp_f32_e64 v111, v111
    v_pk_mul_f32 v[96:97], v[80:81], v[96:97]
    v_pk_mul_f32 v[98:99], v[82:83], v[98:99]
    v_pk_mul_f32 v[100:101], v[84:85], v[100:101]
    v_pk_mul_f32 v[102:103], v[86:87], v[102:103]
    v_pk_mul_f32 v[104:105], v[88:89], v[104:105]
    v_pk_mul_f32 v[106:107], v[90:91], v[106:107]
    v_pk_mul_f32 v[108:109], v[92:93], v[108:109]
    v_pk_mul_f32 v[110:111], v[94:95], v[110:111]
    v_pk_fma_f32 v[48:49], v[96:97], v[96:97], v[48:49]
    v_pk_fma_f32 v[50:51], v[98:99], v[98:99], v[50:51]
    v_pk_fma_f32 v[52:53], v[100:101], v[100:101], v[52:53]
    v_pk_fma_f32 v[54:55], v[102:103], v[102:103], v[54:55]
    v_pk_fma_f32 v[48:49], v[104:105], v[104:105], v[48:49]
    v_pk_fma_f32 v[50:51], v[106:107], v[106:107], v[50:51]
    v_pk_fma_f32 v[52:53], v[108:109], v[108:109], v[52:53]
    v_pk_fma_f32 v[54:55], v[110:111], v[110:111], v[54:55]
    v_cvt_pk_bf16_f32 v136, v96, v97
    v_cvt_pk_bf16_f32 v137, v98, v99
    v_cvt_pk_bf16_f32 v138, v100, v101
    v_cvt_pk_bf16_f32 v139, v102, v103
    v_cvt_pk_bf16_f32 v140, v104, v105
    v_cvt_pk_bf16_f32 v141, v106, v107
    v_cvt_pk_bf16_f32 v142, v108, v109
    v_cvt_pk_bf16_f32 v143, v110, v111
    s_waitcnt lgkmcnt(0)
    v_pk_fma_f32 v[96:97], v[64:65], v[64:65], s[60:61] neg_lo:[1,0,0] neg_hi:[1,0,0]
    v_pk_fma_f32 v[98:99], v[66:67], v[66:67], s[60:61] neg_lo:[1,0,0] neg_hi:[1,0,0]
    s_nop 0
    v_pk_fma_f32 v[100:101], v[68:69], v[68:69], s[60:61] neg_lo:[1,0,0] neg_hi:[1,0,0]
    v_pk_fma_f32 v[102:103], v[70:71], v[70:71], s[60:61] neg_lo:[1,0,0] neg_hi:[1,0,0]
    v_pk_fma_f32 v[104:105], v[72:73], v[72:73], s[60:61] neg_lo:[1,0,0] neg_hi:[1,0,0]
    v_pk_fma_f32 v[106:107], v[74:75], v[74:75], s[60:61] neg_lo:[1,0,0] neg_hi:[1,0,0]
    v_pk_fma_f32 v[108:109], v[76:77], v[76:77], s[60:61] neg_lo:[1,0,0] neg_hi:[1,0,0]
    v_pk_fma_f32 v[110:111], v[78:79], v[78:79], s[60:61] neg_lo:[1,0,0] neg_hi:[1,0,0]
    v_pk_mul_f32 v[96:97], v[64:65], v[96:97]
    v_pk_mul_f32 v[98:99], v[66:67], v[98:99]
    v_pk_mul_f32 v[100:101], v[68:69], v[100:101]
    v_pk_mul_f32 v[102:103], v[70:71], v[102:103]
    v_pk_mul_f32 v[104:105], v[72:73], v[104:105]
    v_pk_mul_f32 v[106:107], v[74:75], v[106:107]
    v_pk_mul_f32 v[108:109], v[76:77], v[108:109]
    v_pk_mul_f32 v[110:111], v[78:79], v[110:111]
    s_add_u32 m0, s50, 0
    s_movk_i32 s48, 0
    v_mfma_f32_32x32x16_bf16 v[80:95], a[120:123], a[144:147], 0
    buffer_load_dwordx4 v14, s[20:23], s48 offen offset:0 lds
    v_exp_f32 v96, v96
    v_exp_f32 v97, v97
    v_exp_f32 v98, v98
    v_mfma_f32_32x32x16_bf16 v[208:223], a[232:235], a[160:163], v[208:223]
    v_exp_f32 v99, v99
    v_exp_f32 v100, v100
    v_exp_f32 v101, v101
    v_mfma_f32_32x32x16_bf16 v[80:95], a[124:127], a[148:151], v[80:95]
    buffer_load_dwordx4 v14, s[20:23], s48 offen offset:1024 lds
    v_exp_f32 v102, v102
    v_exp_f32 v103, v103
    v_exp_f32_e64 v104, v104
    v_mfma_f32_32x32x16_bf16 v[80:95], a[128:131], a[152:155], v[80:95]
    v_exp_f32 v105, v105
    v_exp_f32 v106, v106
    v_exp_f32 v107, v107
    v_exp_f32 v108, v108
    v_exp_f32 v109, v109
    v_exp_f32 v110, v110
    v_exp_f32_e64 v111, v111
    v_pk_add_f32 v[96:97], v[96:97], 1.0 op_sel_hi:[1,0]
    v_pk_add_f32 v[98:99], v[98:99], 1.0 op_sel_hi:[1,0]
    v_pk_add_f32 v[100:101], v[100:101], 1.0 op_sel_hi:[1,0]
    v_pk_add_f32 v[102:103], v[102:103], 1.0 op_sel_hi:[1,0]
    v_pk_add_f32 v[104:105], v[104:105], 1.0 op_sel_hi:[1,0]
    v_pk_add_f32 v[106:107], v[106:107], 1.0 op_sel_hi:[1,0]
    v_pk_add_f32 v[108:109], v[108:109], 1.0 op_sel_hi:[1,0]
    v_pk_add_f32 v[110:111], v[110:111], 1.0 op_sel_hi:[1,0]
    v_mfma_f32_32x32x16_bf16 v[80:95], a[132:135], a[156:159], v[80:95]
    buffer_load_dwordx4 v14, s[20:23], s48 offen offset:2048 lds
    v_rcp_f32 v96, v96
    v_rcp_f32 v97, v97
    v_rcp_f32 v98, v98
    v_mfma_f32_32x32x16_bf16 v[208:223], a[236:239], a[164:167], v[208:223]
    v_rcp_f32 v99, v99
    v_rcp_f32 v100, v100
    v_rcp_f32 v101, v101
    v_mfma_f32_32x32x16_bf16 v[80:95], a[136:139], a[160:163], v[80:95]
    buffer_load_dwordx4 v14, s[20:23], s48 offen offset:3072 lds
    v_rcp_f32 v102, v102
    v_rcp_f32 v103, v103
    v_rcp_f32 v104, v104
    v_mfma_f32_32x32x16_bf16 v[80:95], a[140:143], a[164:167], v[80:95]
    v_rcp_f32 v105, v105
    v_rcp_f32 v106, v106
    v_rcp_f32 v107, v107
    v_rcp_f32 v108, v108
    v_rcp_f32 v109, v109
    v_rcp_f32 v110, v110
    v_rcp_f32 v111, v111
    v_pk_mul_f32 v[96:97], v[64:65], v[96:97]
    v_pk_mul_f32 v[98:99], v[66:67], v[98:99]
    v_pk_mul_f32 v[100:101], v[68:69], v[100:101]
    v_pk_mul_f32 v[102:103], v[70:71], v[102:103]
    v_pk_mul_f32 v[104:105], v[72:73], v[104:105]
    v_pk_mul_f32 v[106:107], v[74:75], v[106:107]
    v_pk_mul_f32 v[108:109], v[76:77], v[108:109]
    v_pk_mul_f32 v[110:111], v[78:79], v[110:111]
    v_pk_fma_f32 v[48:49], v[96:97], v[96:97], v[48:49]
    v_pk_fma_f32 v[50:51], v[98:99], v[98:99], v[50:51]
    v_pk_fma_f32 v[52:53], v[100:101], v[100:101], v[52:53]
    v_pk_fma_f32 v[54:55], v[102:103], v[102:103], v[54:55]
    v_pk_fma_f32 v[48:49], v[104:105], v[104:105], v[48:49]
    v_pk_fma_f32 v[50:51], v[106:107], v[106:107], v[50:51]
    v_pk_fma_f32 v[52:53], v[108:109], v[108:109], v[52:53]
    v_pk_fma_f32 v[54:55], v[110:111], v[110:111], v[54:55]
    v_cvt_pk_bf16_f32 v144, v96, v97
    v_cvt_pk_bf16_f32 v145, v98, v99
    v_cvt_pk_bf16_f32 v146, v100, v101
    v_cvt_pk_bf16_f32 v147, v102, v103
    v_cvt_pk_bf16_f32 v148, v104, v105
    v_cvt_pk_bf16_f32 v149, v106, v107
    v_cvt_pk_bf16_f32 v150, v108, v109
    v_cvt_pk_bf16_f32 v151, v110, v111
    v_pk_fma_f32 v[96:97], v[80:81], v[80:81], s[60:61] neg_lo:[1,0,0] neg_hi:[1,0,0]
    v_pk_fma_f32 v[98:99], v[82:83], v[82:83], s[60:61] neg_lo:[1,0,0] neg_hi:[1,0,0]
    v_pk_fma_f32 v[100:101], v[84:85], v[84:85], s[60:61] neg_lo:[1,0,0] neg_hi:[1,0,0]
    v_pk_fma_f32 v[102:103], v[86:87], v[86:87], s[60:61] neg_lo:[1,0,0] neg_hi:[1,0,0]
    v_pk_fma_f32 v[104:105], v[88:89], v[88:89], s[60:61] neg_lo:[1,0,0] neg_hi:[1,0,0]
    v_pk_fma_f32 v[106:107], v[90:91], v[90:91], s[60:61] neg_lo:[1,0,0] neg_hi:[1,0,0]
    v_pk_fma_f32 v[108:109], v[92:93], v[92:93], s[60:61] neg_lo:[1,0,0] neg_hi:[1,0,0]
    v_pk_fma_f32 v[110:111], v[94:95], v[94:95], s[60:61] neg_lo:[1,0,0] neg_hi:[1,0,0]
    v_pk_mul_f32 v[96:97], v[80:81], v[96:97]
    v_pk_mul_f32 v[98:99], v[82:83], v[98:99]
    v_pk_mul_f32 v[100:101], v[84:85], v[100:101]
    v_pk_mul_f32 v[102:103], v[86:87], v[102:103]
    v_pk_mul_f32 v[104:105], v[88:89], v[104:105]
    v_pk_mul_f32 v[106:107], v[90:91], v[106:107]
    v_pk_mul_f32 v[108:109], v[92:93], v[108:109]
    v_pk_mul_f32 v[110:111], v[94:95], v[110:111]
    s_add_u32 m0, s50, 4096
    s_movk_i32 s48, 4096
    v_mfma_f32_32x32x16_bf16 v[64:79], a[0:3], a[168:171], 0
    buffer_load_dwordx4 v14, s[20:23], s48 offen offset:0 lds
    v_exp_f32 v96, v96
    v_exp_f32 v97, v97
    v_exp_f32 v98, v98
    v_mfma_f32_32x32x16_bf16 v[224:239], a[216:219], a[168:171], 0
    v_exp_f32 v99, v99
    v_exp_f32 v100, v100
    v_exp_f32_e64 v101, v101
    v_mfma_f32_32x32x16_bf16 v[64:79], a[4:7], a[172:175], v[64:79]
    buffer_load_dwordx4 v14, s[20:23], s48 offen offset:1024 lds
    v_exp_f32 v102, v102
    v_exp_f32 v103, v103
    v_exp_f32 v104, v104
    v_mfma_f32_32x32x16_bf16 v[64:79], a[8:11], a[176:179], v[64:79]
    v_exp_f32 v105, v105
    v_exp_f32 v106, v106
    v_exp_f32 v107, v107
    v_exp_f32 v108, v108
    v_exp_f32 v109, v109
    v_exp_f32 v110, v110
    v_exp_f32 v111, v111
    v_pk_add_f32 v[96:97], v[96:97], 1.0 op_sel_hi:[1,0]
    v_pk_add_f32 v[98:99], v[98:99], 1.0 op_sel_hi:[1,0]
    v_pk_add_f32 v[100:101], v[100:101], 1.0 op_sel_hi:[1,0]
    v_pk_add_f32 v[102:103], v[102:103], 1.0 op_sel_hi:[1,0]
    v_pk_add_f32 v[104:105], v[104:105], 1.0 op_sel_hi:[1,0]
    v_pk_add_f32 v[106:107], v[106:107], 1.0 op_sel_hi:[1,0]
    v_pk_add_f32 v[108:109], v[108:109], 1.0 op_sel_hi:[1,0]
    v_pk_add_f32 v[110:111], v[110:111], 1.0 op_sel_hi:[1,0]
    v_mfma_f32_32x32x16_bf16 v[64:79], a[12:15], a[180:183], v[64:79]
    buffer_load_dwordx4 v14, s[20:23], s48 offen offset:2048 lds
    v_rcp_f32 v96, v96
    v_rcp_f32 v97, v97
    v_rcp_f32 v98, v98
    v_mfma_f32_32x32x16_bf16 v[224:239], a[220:223], a[172:175], v[224:239]
    v_rcp_f32 v99, v99
    v_rcp_f32 v100, v100
    v_rcp_f32 v101, v101
    v_mfma_f32_32x32x16_bf16 v[64:79], a[16:19], a[184:187], v[64:79]
    buffer_load_dwordx4 v14, s[20:23], s48 offen offset:3072 lds
    v_rcp_f32 v102, v102
    v_rcp_f32 v103, v103
    v_rcp_f32 v104, v104
    v_mfma_f32_32x32x16_bf16 v[64:79], a[20:23], a[188:191], v[64:79]
    v_rcp_f32 v105, v105
    v_rcp_f32 v106, v106
    v_rcp_f32 v107, v107
    v_rcp_f32 v108, v108
    v_rcp_f32 v109, v109
    v_rcp_f32 v110, v110
    v_rcp_f32 v111, v111
    v_pk_mul_f32 v[96:97], v[80:81], v[96:97]
    v_pk_mul_f32 v[98:99], v[82:83], v[98:99]
    v_pk_mul_f32 v[100:101], v[84:85], v[100:101]
    v_pk_mul_f32 v[102:103], v[86:87], v[102:103]
    v_pk_mul_f32 v[104:105], v[88:89], v[104:105]
    v_pk_mul_f32 v[106:107], v[90:91], v[106:107]
    v_pk_mul_f32 v[108:109], v[92:93], v[108:109]
    v_pk_mul_f32 v[110:111], v[94:95], v[110:111]
    v_pk_fma_f32 v[48:49], v[96:97], v[96:97], v[48:49]
    v_pk_fma_f32 v[50:51], v[98:99], v[98:99], v[50:51]
    v_pk_fma_f32 v[52:53], v[100:101], v[100:101], v[52:53]
    v_pk_fma_f32 v[54:55], v[102:103], v[102:103], v[54:55]
    v_pk_fma_f32 v[48:49], v[104:105], v[104:105], v[48:49]
    v_pk_fma_f32 v[50:51], v[106:107], v[106:107], v[50:51]
    v_pk_fma_f32 v[52:53], v[108:109], v[108:109], v[52:53]
    v_pk_fma_f32 v[54:55], v[110:111], v[110:111], v[54:55]
    v_cvt_pk_bf16_f32 v152, v96, v97
    v_cvt_pk_bf16_f32 v153, v98, v99
    v_cvt_pk_bf16_f32 v154, v100, v101
    v_cvt_pk_bf16_f32 v155, v102, v103
    v_cvt_pk_bf16_f32 v156, v104, v105
    v_cvt_pk_bf16_f32 v157, v106, v107
    v_cvt_pk_bf16_f32 v158, v108, v109
    v_cvt_pk_bf16_f32 v159, v110, v111
    v_pk_add_f32 v[48:49], v[48:49], v[50:51]
    v_pk_add_f32 v[52:53], v[52:53], v[54:55]
    v_pk_add_f32 v[40:41], v[48:49], v[52:53]
    v_pk_fma_f32 v[96:97], v[64:65], v[64:65], s[60:61] neg_lo:[1,0,0] neg_hi:[1,0,0]
    v_pk_fma_f32 v[98:99], v[66:67], v[66:67], s[60:61] neg_lo:[1,0,0] neg_hi:[1,0,0]
    v_pk_fma_f32 v[100:101], v[68:69], v[68:69], s[60:61] neg_lo:[1,0,0] neg_hi:[1,0,0]
    v_pk_fma_f32 v[102:103], v[70:71], v[70:71], s[60:61] neg_lo:[1,0,0] neg_hi:[1,0,0]
    v_pk_fma_f32 v[104:105], v[72:73], v[72:73], s[60:61] neg_lo:[1,0,0] neg_hi:[1,0,0]
    v_pk_fma_f32 v[106:107], v[74:75], v[74:75], s[60:61] neg_lo:[1,0,0] neg_hi:[1,0,0]
    v_pk_fma_f32 v[108:109], v[76:77], v[76:77], s[60:61] neg_lo:[1,0,0] neg_hi:[1,0,0]
    v_pk_fma_f32 v[110:111], v[78:79], v[78:79], s[60:61] neg_lo:[1,0,0] neg_hi:[1,0,0]
    v_pk_mul_f32 v[96:97], v[64:65], v[96:97]
    v_pk_mul_f32 v[98:99], v[66:67], v[98:99]
    v_pk_mul_f32 v[100:101], v[68:69], v[100:101]
    v_pk_mul_f32 v[102:103], v[70:71], v[102:103]
    v_pk_mul_f32 v[104:105], v[72:73], v[104:105]
    v_pk_mul_f32 v[106:107], v[74:75], v[106:107]
    v_pk_mul_f32 v[108:109], v[76:77], v[108:109]
    v_pk_mul_f32 v[110:111], v[78:79], v[110:111]
    s_add_u32 m0, s50, 8192
    s_movk_i32 s48, 8192
    v_mfma_f32_32x32x16_bf16 v[80:95], a[24:27], a[168:171], 0
    buffer_load_dwordx4 v14, s[20:23], s48 offen offset:0 lds
    v_exp_f32 v96, v96
    v_exp_f32 v97, v97
    v_exp_f32 v98, v98
    v_mfma_f32_32x32x16_bf16 v[224:239], a[224:227], a[176:179], v[224:239]
    v_exp_f32 v99, v99
    v_exp_f32 v100, v100
    v_exp_f32_e64 v101, v101
    v_mfma_f32_32x32x16_bf16 v[80:95], a[28:31], a[172:175], v[80:95]
    buffer_load_dwordx4 v14, s[20:23], s48 offen offset:1024 lds
    v_exp_f32 v102, v102
    v_exp_f32 v103, v103
    v_exp_f32_e64 v104, v104
    v_mfma_f32_32x32x16_bf16 v[80:95], a[32:35], a[176:179], v[80:95]
    v_exp_f32 v105, v105
    v_exp_f32 v106, v106
    v_exp_f32 v107, v107
    v_exp_f32 v108, v108
    v_exp_f32 v109, v109
    v_exp_f32 v110, v110
    v_exp_f32_e64 v111, v111
    v_pk_add_f32 v[96:97], v[96:97], 1.0 op_sel_hi:[1,0]
    v_pk_add_f32 v[98:99], v[98:99], 1.0 op_sel_hi:[1,0]
    v_pk_add_f32 v[100:101], v[100:101], 1.0 op_sel_hi:[1,0]
    v_pk_add_f32 v[102:103], v[102:103], 1.0 op_sel_hi:[1,0]
    v_pk_add_f32 v[104:105], v[104:105], 1.0 op_sel_hi:[1,0]
    v_pk_add_f32 v[106:107], v[106:107], 1.0 op_sel_hi:[1,0]
    v_pk_add_f32 v[108:109], v[108:109], 1.0 op_sel_hi:[1,0]
    v_pk_add_f32 v[110:111], v[110:111], 1.0 op_sel_hi:[1,0]
    v_mfma_f32_32x32x16_bf16 v[80:95], a[36:39], a[180:183], v[80:95]
    buffer_load_dwordx4 v14, s[20:23], s48 offen offset:2048 lds
    v_rcp_f32 v96, v96
    v_rcp_f32 v97, v97
    v_rcp_f32 v98, v98
    v_mfma_f32_32x32x16_bf16 v[224:239], a[228:231], a[180:183], v[224:239]
    v_rcp_f32 v99, v99
    v_rcp_f32 v100, v100
    v_rcp_f32 v101, v101
    v_mfma_f32_32x32x16_bf16 v[80:95], a[40:43], a[184:187], v[80:95]
    buffer_load_dwordx4 v14, s[20:23], s48 offen offset:3072 lds
    v_rcp_f32 v102, v102
    v_rcp_f32 v103, v103
    v_rcp_f32 v104, v104
    v_mfma_f32_32x32x16_bf16 v[80:95], a[44:47], a[188:191], v[80:95]
    v_rcp_f32 v105, v105
    v_rcp_f32 v106, v106
    v_rcp_f32 v107, v107
    v_rcp_f32 v108, v108
    v_rcp_f32 v109, v109
    v_rcp_f32 v110, v110
    v_rcp_f32 v111, v111
    v_pk_mul_f32 v[96:97], v[64:65], v[96:97]
    v_pk_mul_f32 v[98:99], v[66:67], v[98:99]
    v_pk_mul_f32 v[100:101], v[68:69], v[100:101]
    v_pk_mul_f32 v[102:103], v[70:71], v[102:103]
    v_pk_mul_f32 v[104:105], v[72:73], v[104:105]
    v_pk_mul_f32 v[106:107], v[74:75], v[106:107]
    v_pk_mul_f32 v[108:109], v[76:77], v[108:109]
    v_pk_mul_f32 v[110:111], v[78:79], v[110:111]
    v_pk_mul_f32 v[48:49], v[96:97], v[96:97]
    v_pk_mul_f32 v[50:51], v[98:99], v[98:99]
    v_pk_mul_f32 v[52:53], v[100:101], v[100:101]
    v_pk_mul_f32 v[54:55], v[102:103], v[102:103]
    v_pk_fma_f32 v[48:49], v[104:105], v[104:105], v[48:49]
    v_pk_fma_f32 v[50:51], v[106:107], v[106:107], v[50:51]
    v_pk_fma_f32 v[52:53], v[108:109], v[108:109], v[52:53]
    v_pk_fma_f32 v[54:55], v[110:111], v[110:111], v[54:55]
    v_cvt_pk_bf16_f32 v160, v96, v97
    v_cvt_pk_bf16_f32 v161, v98, v99
    v_cvt_pk_bf16_f32 v162, v100, v101
    v_cvt_pk_bf16_f32 v163, v102, v103
    v_cvt_pk_bf16_f32 v164, v104, v105
    v_cvt_pk_bf16_f32 v165, v106, v107
    v_cvt_pk_bf16_f32 v166, v108, v109
    v_cvt_pk_bf16_f32 v167, v110, v111
    v_pk_fma_f32 v[96:97], v[80:81], v[80:81], s[60:61] neg_lo:[1,0,0] neg_hi:[1,0,0]
    v_pk_fma_f32 v[98:99], v[82:83], v[82:83], s[60:61] neg_lo:[1,0,0] neg_hi:[1,0,0]
    v_pk_fma_f32 v[100:101], v[84:85], v[84:85], s[60:61] neg_lo:[1,0,0] neg_hi:[1,0,0]
    v_pk_fma_f32 v[102:103], v[86:87], v[86:87], s[60:61] neg_lo:[1,0,0] neg_hi:[1,0,0]
    v_pk_fma_f32 v[104:105], v[88:89], v[88:89], s[60:61] neg_lo:[1,0,0] neg_hi:[1,0,0]
    v_pk_fma_f32 v[106:107], v[90:91], v[90:91], s[60:61] neg_lo:[1,0,0] neg_hi:[1,0,0]
    v_pk_fma_f32 v[108:109], v[92:93], v[92:93], s[60:61] neg_lo:[1,0,0] neg_hi:[1,0,0]
    v_pk_fma_f32 v[110:111], v[94:95], v[94:95], s[60:61] neg_lo:[1,0,0] neg_hi:[1,0,0]
    v_pk_mul_f32 v[96:97], v[80:81], v[96:97]
    v_pk_mul_f32 v[98:99], v[82:83], v[98:99]
    v_pk_mul_f32 v[100:101], v[84:85], v[100:101]
    v_pk_mul_f32 v[102:103], v[86:87], v[102:103]
    v_pk_mul_f32 v[104:105], v[88:89], v[104:105]
    v_pk_mul_f32 v[106:107], v[90:91], v[106:107]
    v_pk_mul_f32 v[108:109], v[92:93], v[108:109]
    v_pk_mul_f32 v[110:111], v[94:95], v[110:111]
    s_add_u32 m0, s50, 12288
    s_movk_i32 s48, 12288
    v_mfma_f32_32x32x16_bf16 v[64:79], a[48:51], a[168:171], 0
    buffer_load_dwordx4 v14, s[20:23], s48 offen offset:0 lds
    v_exp_f32 v96, v96
    v_exp_f32 v97, v97
    v_exp_f32 v98, v98
    v_mfma_f32_32x32x16_bf16 v[224:239], a[232:235], a[184:187], v[224:239]
    v_exp_f32 v99, v99
    v_exp_f32 v100, v100
    v_exp_f32_e64 v101, v101
    v_mfma_f32_32x32x16_bf16 v[64:79], a[52:55], a[172:175], v[64:79]
    buffer_load_dwordx4 v14, s[20:23], s48 offen offset:1024 lds
    v_exp_f32 v102, v102
    v_exp_f32 v103, v103
    v_exp_f32 v104, v104
    v_mfma_f32_32x32x16_bf16 v[64:79], a[56:59], a[176:179], v[64:79]
    v_exp_f32 v105, v105
    v_exp_f32 v106, v106
    v_exp_f32 v107, v107
    v_exp_f32 v108, v108
    v_exp_f32 v109, v109
    v_exp_f32 v110, v110
    v_exp_f32 v111, v111
    v_pk_add_f32 v[96:97], v[96:97], 1.0 op_sel_hi:[1,0]
    v_pk_add_f32 v[98:99], v[98:99], 1.0 op_sel_hi:[1,0]
    v_pk_add_f32 v[100:101], v[100:101], 1.0 op_sel_hi:[1,0]
    v_pk_add_f32 v[102:103], v[102:103], 1.0 op_sel_hi:[1,0]
    v_pk_add_f32 v[104:105], v[104:105], 1.0 op_sel_hi:[1,0]
    v_pk_add_f32 v[106:107], v[106:107], 1.0 op_sel_hi:[1,0]
    v_pk_add_f32 v[108:109], v[108:109], 1.0 op_sel_hi:[1,0]
    v_pk_add_f32 v[110:111], v[110:111], 1.0 op_sel_hi:[1,0]
    v_mfma_f32_32x32x16_bf16 v[64:79], a[60:63], a[180:183], v[64:79]
    buffer_load_dwordx4 v14, s[20:23], s48 offen offset:2048 lds
    v_rcp_f32 v96, v96
    v_rcp_f32 v97, v97
    v_rcp_f32 v98, v98
    v_mfma_f32_32x32x16_bf16 v[224:239], a[236:239], a[188:191], v[224:239]
    v_rcp_f32 v99, v99
    v_rcp_f32 v100, v100
    v_rcp_f32 v101, v101
    v_mfma_f32_32x32x16_bf16 v[64:79], a[64:67], a[184:187], v[64:79]
    buffer_load_dwordx4 v14, s[20:23], s48 offen offset:3072 lds
    v_rcp_f32 v102, v102
    v_rcp_f32 v103, v103
    v_rcp_f32 v104, v104
    v_mfma_f32_32x32x16_bf16 v[64:79], a[68:71], a[188:191], v[64:79]
    v_rcp_f32 v105, v105
    v_rcp_f32 v106, v106
    v_rcp_f32 v107, v107
    v_rcp_f32_e64 v108, v108
    v_rcp_f32_e64 v109, v109
    v_rcp_f32_e64 v110, v110
    v_rcp_f32_e64 v111, v111
    v_pk_mul_f32 v[96:97], v[80:81], v[96:97]
    v_pk_mul_f32 v[98:99], v[82:83], v[98:99]
    v_pk_mul_f32 v[100:101], v[84:85], v[100:101]
    v_pk_mul_f32 v[102:103], v[86:87], v[102:103]
    v_pk_mul_f32 v[104:105], v[88:89], v[104:105]
    v_pk_mul_f32 v[106:107], v[90:91], v[106:107]
    v_pk_mul_f32 v[108:109], v[92:93], v[108:109]
    v_pk_mul_f32 v[110:111], v[94:95], v[110:111]
    v_pk_fma_f32 v[48:49], v[96:97], v[96:97], v[48:49]
    v_pk_fma_f32 v[50:51], v[98:99], v[98:99], v[50:51]
    v_pk_fma_f32 v[52:53], v[100:101], v[100:101], v[52:53]
    v_pk_fma_f32 v[54:55], v[102:103], v[102:103], v[54:55]
    v_pk_fma_f32 v[48:49], v[104:105], v[104:105], v[48:49]
    v_pk_fma_f32 v[50:51], v[106:107], v[106:107], v[50:51]
    v_pk_fma_f32 v[52:53], v[108:109], v[108:109], v[52:53]
    v_pk_fma_f32 v[54:55], v[110:111], v[110:111], v[54:55]
    v_cvt_pk_bf16_f32 v168, v96, v97
    v_cvt_pk_bf16_f32 v169, v98, v99
    v_cvt_pk_bf16_f32 v170, v100, v101
    v_cvt_pk_bf16_f32 v171, v102, v103
    v_cvt_pk_bf16_f32 v172, v104, v105
    v_cvt_pk_bf16_f32 v173, v106, v107
    v_cvt_pk_bf16_f32 v174, v108, v109
    v_cvt_pk_bf16_f32 v175, v110, v111
    v_pk_fma_f32 v[96:97], v[64:65], v[64:65], s[60:61] neg_lo:[1,0,0] neg_hi:[1,0,0]
    v_pk_fma_f32 v[98:99], v[66:67], v[66:67], s[60:61] neg_lo:[1,0,0] neg_hi:[1,0,0]
    v_pk_fma_f32 v[100:101], v[68:69], v[68:69], s[60:61] neg_lo:[1,0,0] neg_hi:[1,0,0]
    v_pk_fma_f32 v[102:103], v[70:71], v[70:71], s[60:61] neg_lo:[1,0,0] neg_hi:[1,0,0]
    v_pk_fma_f32 v[104:105], v[72:73], v[72:73], s[60:61] neg_lo:[1,0,0] neg_hi:[1,0,0]
    v_pk_fma_f32 v[106:107], v[74:75], v[74:75], s[60:61] neg_lo:[1,0,0] neg_hi:[1,0,0]
    v_pk_fma_f32 v[108:109], v[76:77], v[76:77], s[60:61] neg_lo:[1,0,0] neg_hi:[1,0,0]
    v_pk_fma_f32 v[110:111], v[78:79], v[78:79], s[60:61] neg_lo:[1,0,0] neg_hi:[1,0,0]
    v_pk_mul_f32 v[96:97], v[64:65], v[96:97]
    v_pk_mul_f32 v[98:99], v[66:67], v[98:99]
    v_pk_mul_f32 v[100:101], v[68:69], v[100:101]
    v_pk_mul_f32 v[102:103], v[70:71], v[102:103]
    v_pk_mul_f32 v[104:105], v[72:73], v[104:105]
    v_pk_mul_f32 v[106:107], v[74:75], v[106:107]
    v_pk_mul_f32 v[108:109], v[76:77], v[108:109]
    v_pk_mul_f32 v[110:111], v[78:79], v[110:111]
    s_add_u32 m0, s50, 16384
    s_movk_i32 s48, 16384
    v_mfma_f32_32x32x16_bf16 v[80:95], a[72:75], a[168:171], 0
    buffer_load_dwordx4 v14, s[20:23], s48 offen offset:0 lds
    v_exp_f32 v96, v96
    v_exp_f32 v97, v97
    v_exp_f32 v98, v98
    v_mfma_f32_32x32x16_bf16 v[240:255], a[216:219], a[192:195], 0
    v_exp_f32 v99, v99
    v_exp_f32 v100, v100
    v_exp_f32_e64 v101, v101
    v_mfma_f32_32x32x16_bf16 v[80:95], a[76:79], a[172:175], v[80:95]
    buffer_load_dwordx4 v14, s[20:23], s48 offen offset:1024 lds
    v_exp_f32 v102, v102
    v_exp_f32 v103, v103
    v_exp_f32 v104, v104
    v_mfma_f32_32x32x16_bf16 v[80:95], a[80:83], a[176:179], v[80:95]
    v_exp_f32 v105, v105
    v_exp_f32 v106, v106
    v_exp_f32 v107, v107
    v_exp_f32 v108, v108
    v_exp_f32 v109, v109
    v_exp_f32 v110, v110
    v_exp_f32 v111, v111
    v_pk_add_f32 v[96:97], v[96:97], 1.0 op_sel_hi:[1,0]
    v_pk_add_f32 v[98:99], v[98:99], 1.0 op_sel_hi:[1,0]
    v_pk_add_f32 v[100:101], v[100:101], 1.0 op_sel_hi:[1,0]
    v_pk_add_f32 v[102:103], v[102:103], 1.0 op_sel_hi:[1,0]
    v_pk_add_f32 v[104:105], v[104:105], 1.0 op_sel_hi:[1,0]
    v_pk_add_f32 v[106:107], v[106:107], 1.0 op_sel_hi:[1,0]
    v_pk_add_f32 v[108:109], v[108:109], 1.0 op_sel_hi:[1,0]
    v_pk_add_f32 v[110:111], v[110:111], 1.0 op_sel_hi:[1,0]
    v_mfma_f32_32x32x16_bf16 v[80:95], a[84:87], a[180:183], v[80:95]
    v_rcp_f32 v96, v96
    v_rcp_f32 v97, v97
    v_rcp_f32 v98, v98
    v_mfma_f32_32x32x16_bf16 v[240:255], a[220:223], a[196:199], v[240:255]
    v_rcp_f32 v99, v99
    v_rcp_f32 v100, v100
    v_rcp_f32 v101, v101
    v_mfma_f32_32x32x16_bf16 v[80:95], a[88:91], a[184:187], v[80:95]
    v_rcp_f32 v102, v102
    v_rcp_f32 v103, v103
    v_rcp_f32 v104, v104
    v_mfma_f32_32x32x16_bf16 v[80:95], a[92:95], a[188:191], v[80:95]
    v_rcp_f32 v105, v105
    v_rcp_f32 v106, v106
    v_rcp_f32 v107, v107
    v_rcp_f32 v108, v108
    v_rcp_f32 v109, v109
    v_rcp_f32 v110, v110
    v_rcp_f32 v111, v111
    v_pk_mul_f32 v[96:97], v[64:65], v[96:97]
    v_pk_mul_f32 v[98:99], v[66:67], v[98:99]
    v_pk_mul_f32 v[100:101], v[68:69], v[100:101]
    v_pk_mul_f32 v[102:103], v[70:71], v[102:103]
    v_pk_mul_f32 v[104:105], v[72:73], v[104:105]
    v_pk_mul_f32 v[106:107], v[74:75], v[106:107]
    v_pk_mul_f32 v[108:109], v[76:77], v[108:109]
    v_pk_mul_f32 v[110:111], v[78:79], v[110:111]
    v_pk_fma_f32 v[48:49], v[96:97], v[96:97], v[48:49]
    v_pk_fma_f32 v[50:51], v[98:99], v[98:99], v[50:51]
    v_pk_fma_f32 v[52:53], v[100:101], v[100:101], v[52:53]
    v_pk_fma_f32 v[54:55], v[102:103], v[102:103], v[54:55]
    v_pk_fma_f32 v[48:49], v[104:105], v[104:105], v[48:49]
    v_pk_fma_f32 v[50:51], v[106:107], v[106:107], v[50:51]
    v_pk_fma_f32 v[52:53], v[108:109], v[108:109], v[52:53]
    v_pk_fma_f32 v[54:55], v[110:111], v[110:111], v[54:55]
    v_cvt_pk_bf16_f32 v176, v96, v97
    v_cvt_pk_bf16_f32 v177, v98, v99
    v_cvt_pk_bf16_f32 v178, v100, v101
    v_cvt_pk_bf16_f32 v179, v102, v103
    v_cvt_pk_bf16_f32 v180, v104, v105
    v_cvt_pk_bf16_f32 v181, v106, v107
    v_cvt_pk_bf16_f32 v182, v108, v109
    v_cvt_pk_bf16_f32 v183, v110, v111
    v_pk_fma_f32 v[96:97], v[80:81], v[80:81], s[60:61] neg_lo:[1,0,0] neg_hi:[1,0,0]
    v_pk_fma_f32 v[98:99], v[82:83], v[82:83], s[60:61] neg_lo:[1,0,0] neg_hi:[1,0,0]
    v_pk_fma_f32 v[100:101], v[84:85], v[84:85], s[60:61] neg_lo:[1,0,0] neg_hi:[1,0,0]
    v_pk_fma_f32 v[102:103], v[86:87], v[86:87], s[60:61] neg_lo:[1,0,0] neg_hi:[1,0,0]
    v_pk_fma_f32 v[104:105], v[88:89], v[88:89], s[60:61] neg_lo:[1,0,0] neg_hi:[1,0,0]
    v_pk_fma_f32 v[106:107], v[90:91], v[90:91], s[60:61] neg_lo:[1,0,0] neg_hi:[1,0,0]
    v_pk_fma_f32 v[108:109], v[92:93], v[92:93], s[60:61] neg_lo:[1,0,0] neg_hi:[1,0,0]
    v_pk_fma_f32 v[110:111], v[94:95], v[94:95], s[60:61] neg_lo:[1,0,0] neg_hi:[1,0,0]
    v_pk_mul_f32 v[96:97], v[80:81], v[96:97]
L_PAD5:
    s_cbranch_execz L_BACKA
    v_pk_mul_f32 v[98:99], v[82:83], v[98:99]
    v_pk_mul_f32 v[100:101], v[84:85], v[100:101]
    s_nop 0
    v_pk_mul_f32 v[102:103], v[86:87], v[102:103]
    v_pk_mul_f32 v[104:105], v[88:89], v[104:105]
    v_pk_mul_f32 v[106:107], v[90:91], v[106:107]
    v_pk_mul_f32 v[108:109], v[92:93], v[108:109]
    v_pk_mul_f32 v[110:111], v[94:95], v[110:111]
    v_mfma_f32_32x32x16_bf16 v[64:79], a[96:99], a[168:171], 0
    v_exp_f32 v96, v96
    v_exp_f32 v97, v97
    v_exp_f32 v98, v98
    v_mfma_f32_32x32x16_bf16 v[240:255], a[224:227], a[200:203], v[240:255]
    v_exp_f32 v99, v99
    v_exp_f32 v100, v100
    v_exp_f32 v101, v101
    v_mfma_f32_32x32x16_bf16 v[64:79], a[100:103], a[172:175], v[64:79]
    v_exp_f32 v102, v102
    v_exp_f32 v103, v103
    v_exp_f32_e64 v104, v104
    v_mfma_f32_32x32x16_bf16 v[64:79], a[104:107], a[176:179], v[64:79]
    v_exp_f32 v105, v105
    v_exp_f32 v106, v106
    v_exp_f32 v107, v107
    v_exp_f32 v108, v108
    v_exp_f32 v109, v109
    v_exp_f32 v110, v110
    v_exp_f32_e64 v111, v111
    v_pk_add_f32 v[96:97], v[96:97], 1.0 op_sel_hi:[1,0]
    v_pk_add_f32 v[98:99], v[98:99], 1.0 op_sel_hi:[1,0]
    v_pk_add_f32 v[100:101], v[100:101], 1.0 op_sel_hi:[1,0]
    v_pk_add_f32 v[102:103], v[102:103], 1.0 op_sel_hi:[1,0]
    v_pk_add_f32 v[104:105], v[104:105], 1.0 op_sel_hi:[1,0]
    v_pk_add_f32 v[106:107], v[106:107], 1.0 op_sel_hi:[1,0]
    v_pk_add_f32 v[108:109], v[108:109], 1.0 op_sel_hi:[1,0]
    v_pk_add_f32 v[110:111], v[110:111], 1.0 op_sel_hi:[1,0]
    v_mfma_f32_32x32x16_bf16 v[64:79], a[108:111], a[180:183], v[64:79]
    v_rcp_f32 v96, v96
    v_rcp_f32 v97, v97
    v_rcp_f32_e64 v98, v98
    v_mfma_f32_32x32x16_bf16 v[240:255], a[228:231], a[204:207], v[240:255]
    v_rcp_f32 v99, v99
    v_rcp_f32 v100, v100
    v_rcp_f32 v101, v101
    v_mfma_f32_32x32x16_bf16 v[64:79], a[112:115], a[184:187], v[64:79]
    v_rcp_f32 v102, v102
    v_rcp_f32 v103, v103
    v_rcp_f32 v104, v104
    v_mfma_f32_32x32x16_bf16 v[64:79], a[116:119], a[188:191], v[64:79]
    v_rcp_f32 v105, v105
    v_rcp_f32 v106, v106
    v_rcp_f32 v107, v107
    v_rcp_f32 v108, v108
    v_rcp_f32 v109, v109
    v_rcp_f32 v110, v110
    v_rcp_f32_e64 v111, v111
    v_pk_mul_f32 v[96:97], v[80:81], v[96:97]
    v_pk_mul_f32 v[98:99], v[82:83], v[98:99]
    v_pk_mul_f32 v[100:101], v[84:85], v[100:101]
    v_pk_mul_f32 v[102:103], v[86:87], v[102:103]
    v_pk_mul_f32 v[104:105], v[88:89], v[104:105]
    v_pk_mul_f32 v[106:107], v[90:91], v[106:107]
    v_pk_mul_f32 v[108:109], v[92:93], v[108:109]
    v_pk_mul_f32 v[110:111], v[94:95], v[110:111]
    v_pk_fma_f32 v[48:49], v[96:97], v[96:97], v[48:49]
    v_pk_fma_f32 v[50:51], v[98:99], v[98:99], v[50:51]
    v_pk_fma_f32 v[52:53], v[100:101], v[100:101], v[52:53]
    v_pk_fma_f32 v[54:55], v[102:103], v[102:103], v[54:55]
    v_pk_fma_f32 v[48:49], v[104:105], v[104:105], v[48:49]
    v_pk_fma_f32 v[50:51], v[106:107], v[106:107], v[50:51]
    v_pk_fma_f32 v[52:53], v[108:109], v[108:109], v[52:53]
    v_pk_fma_f32 v[54:55], v[110:111], v[110:111], v[54:55]
    v_cvt_pk_bf16_f32 v184, v96, v97
    v_cvt_pk_bf16_f32 v185, v98, v99
    v_cvt_pk_bf16_f32 v186, v100, v101
    v_cvt_pk_bf16_f32 v187, v102, v103
    v_cvt_pk_bf16_f32 v188, v104, v105
    v_cvt_pk_bf16_f32 v189, v106, v107
    v_cvt_pk_bf16_f32 v190, v108, v109
    v_cvt_pk_bf16_f32 v191, v110, v111
    v_pk_fma_f32 v[96:97], v[64:65], v[64:65], s[60:61] neg_lo:[1,0,0] neg_hi:[1,0,0]
    v_pk_fma_f32 v[98:99], v[66:67], v[66:67], s[60:61] neg_lo:[1,0,0] neg_hi:[1,0,0]
    v_pk_fma_f32 v[100:101], v[68:69], v[68:69], s[60:61] neg_lo:[1,0,0] neg_hi:[1,0,0]
    v_pk_fma_f32 v[102:103], v[70:71], v[70:71], s[60:61] neg_lo:[1,0,0] neg_hi:[1,0,0]
    v_pk_fma_f32 v[104:105], v[72:73], v[72:73], s[60:61] neg_lo:[1,0,0] neg_hi:[1,0,0]
    v_pk_fma_f32 v[106:107], v[74:75], v[74:75], s[60:61] neg_lo:[1,0,0] neg_hi:[1,0,0]
    v_pk_fma_f32 v[108:109], v[76:77], v[76:77], s[60:61] neg_lo:[1,0,0] neg_hi:[1,0,0]
    v_pk_fma_f32 v[110:111], v[78:79], v[78:79], s[60:61] neg_lo:[1,0,0] neg_hi:[1,0,0]
    v_pk_mul_f32 v[96:97], v[64:65], v[96:97]
    v_pk_mul_f32 v[98:99], v[66:67], v[98:99]
    v_pk_mul_f32 v[100:101], v[68:69], v[100:101]
    v_pk_mul_f32 v[102:103], v[70:71], v[102:103]
    v_pk_mul_f32 v[104:105], v[72:73], v[104:105]
    v_pk_mul_f32 v[106:107], v[74:75], v[106:107]
    v_pk_mul_f32 v[108:109], v[76:77], v[108:109]
    v_pk_mul_f32 v[110:111], v[78:79], v[110:111]
    v_mfma_f32_32x32x16_bf16 v[80:95], a[120:123], a[168:171], 0
    buffer_load_dword v26, v39, s[36:39], 0 offen sc1
    v_exp_f32 v96, v96
    v_exp_f32 v97, v97
    v_exp_f32 v98, v98
    v_mfma_f32_32x32x16_bf16 v[240:255], a[232:235], a[208:211], v[240:255]
    v_exp_f32 v99, v99
    v_exp_f32 v100, v100
    v_exp_f32 v101, v101
    v_mfma_f32_32x32x16_bf16 v[80:95], a[124:127], a[172:175], v[80:95]
    v_exp_f32 v102, v102
    v_exp_f32 v103, v103
    v_exp_f32 v104, v104
    v_mfma_f32_32x32x16_bf16 v[80:95], a[128:131], a[176:179], v[80:95]
    v_exp_f32 v105, v105
    v_exp_f32 v106, v106
    v_exp_f32 v107, v107
    v_exp_f32 v108, v108
    v_exp_f32 v109, v109
    v_exp_f32 v110, v110
    v_exp_f32 v111, v111
    v_pk_add_f32 v[96:97], v[96:97], 1.0 op_sel_hi:[1,0]
    v_pk_add_f32 v[98:99], v[98:99], 1.0 op_sel_hi:[1,0]
    v_pk_add_f32 v[100:101], v[100:101], 1.0 op_sel_hi:[1,0]
    v_pk_add_f32 v[102:103], v[102:103], 1.0 op_sel_hi:[1,0]
    v_pk_add_f32 v[104:105], v[104:105], 1.0 op_sel_hi:[1,0]
    v_pk_add_f32 v[106:107], v[106:107], 1.0 op_sel_hi:[1,0]
    v_pk_add_f32 v[108:109], v[108:109], 1.0 op_sel_hi:[1,0]
    v_pk_add_f32 v[110:111], v[110:111], 1.0 op_sel_hi:[1,0]
    v_mfma_f32_32x32x16_bf16 v[80:95], a[132:135], a[180:183], v[80:95]
    v_rcp_f32 v96, v96
    v_rcp_f32 v97, v97
    v_rcp_f32 v98, v98
    v_mfma_f32_32x32x16_bf16 v[240:255], a[236:239], a[212:215], v[240:255]
    v_rcp_f32 v99, v99
    v_rcp_f32 v100, v100
    v_rcp_f32 v101, v101
    v_mfma_f32_32x32x16_bf16 v[80:95], a[136:139], a[184:187], v[80:95]
    v_rcp_f32 v102, v102
    v_rcp_f32 v103, v103
    v_rcp_f32 v104, v104
    v_mfma_f32_32x32x16_bf16 v[80:95], a[140:143], a[188:191], v[80:95]
    v_rcp_f32 v105, v105
    v_rcp_f32 v106, v106
    v_rcp_f32 v107, v107
    v_rcp_f32 v108, v108
    v_rcp_f32 v109, v109
    v_rcp_f32 v110, v110
    v_rcp_f32 v111, v111
    v_pk_mul_f32 v[96:97], v[64:65], v[96:97]
    v_pk_mul_f32 v[98:99], v[66:67], v[98:99]
    v_pk_mul_f32 v[100:101], v[68:69], v[100:101]
    v_pk_mul_f32 v[102:103], v[70:71], v[102:103]
    v_pk_mul_f32 v[104:105], v[72:73], v[104:105]
    v_pk_mul_f32 v[106:107], v[74:75], v[106:107]
    v_pk_mul_f32 v[108:109], v[76:77], v[108:109]
    v_pk_mul_f32 v[110:111], v[78:79], v[110:111]
    v_pk_fma_f32 v[48:49], v[96:97], v[96:97], v[48:49]
    v_pk_fma_f32 v[50:51], v[98:99], v[98:99], v[50:51]
    v_pk_fma_f32 v[52:53], v[100:101], v[100:101], v[52:53]
    v_pk_fma_f32 v[54:55], v[102:103], v[102:103], v[54:55]
    v_pk_fma_f32 v[48:49], v[104:105], v[104:105], v[48:49]
    v_pk_fma_f32 v[50:51], v[106:107], v[106:107], v[50:51]
    v_pk_fma_f32 v[52:53], v[108:109], v[108:109], v[52:53]
    v_pk_fma_f32 v[54:55], v[110:111], v[110:111], v[54:55]
    v_cvt_pk_bf16_f32 v192, v96, v97
    v_cvt_pk_bf16_f32 v193, v98, v99
    v_cvt_pk_bf16_f32 v194, v100, v101
    v_cvt_pk_bf16_f32 v195, v102, v103
    v_cvt_pk_bf16_f32 v196, v104, v105
    v_cvt_pk_bf16_f32 v197, v106, v107
    v_cvt_pk_bf16_f32 v198, v108, v109
    v_cvt_pk_bf16_f32 v199, v110, v111
    v_pk_fma_f32 v[96:97], v[80:81], v[80:81], s[60:61] neg_lo:[1,0,0] neg_hi:[1,0,0]
    v_pk_fma_f32 v[98:99], v[82:83], v[82:83], s[60:61] neg_lo:[1,0,0] neg_hi:[1,0,0]
    v_pk_fma_f32 v[100:101], v[84:85], v[84:85], s[60:61] neg_lo:[1,0,0] neg_hi:[1,0,0]
    v_pk_fma_f32 v[102:103], v[86:87], v[86:87], s[60:61] neg_lo:[1,0,0] neg_hi:[1,0,0]
    v_pk_fma_f32 v[104:105], v[88:89], v[88:89], s[60:61] neg_lo:[1,0,0] neg_hi:[1,0,0]
    v_pk_fma_f32 v[106:107], v[90:91], v[90:91], s[60:61] neg_lo:[1,0,0] neg_hi:[1,0,0]
    v_pk_fma_f32 v[108:109], v[92:93], v[92:93], s[60:61] neg_lo:[1,0,0] neg_hi:[1,0,0]
    v_pk_fma_f32 v[110:111], v[94:95], v[94:95], s[60:61] neg_lo:[1,0,0] neg_hi:[1,0,0]
    v_pk_fma_f32 v[2:3], v[208:209], v[208:209], s[60:61] neg_lo:[1,0,0] neg_hi:[1,0,0]
    v_pk_fma_f32 v[4:5], v[224:225], v[224:225], s[60:61] neg_lo:[1,0,0] neg_hi:[1,0,0]
    v_pk_fma_f32 v[6:7], v[240:241], v[240:241], s[60:61] neg_lo:[1,0,0] neg_hi:[1,0,0]
    v_pk_mul_f32 v[96:97], v[80:81], v[96:97]
    v_pk_mul_f32 v[98:99], v[82:83], v[98:99]
    v_pk_mul_f32 v[100:101], v[84:85], v[100:101]
    v_pk_mul_f32 v[102:103], v[86:87], v[102:103]
    v_pk_mul_f32 v[104:105], v[88:89], v[104:105]
    v_pk_mul_f32 v[106:107], v[90:91], v[106:107]
    v_pk_mul_f32 v[108:109], v[92:93], v[108:109]
    v_pk_mul_f32 v[110:111], v[94:95], v[110:111]
    v_pk_mul_f32 v[2:3], v[208:209], v[2:3]
    v_pk_mul_f32 v[4:5], v[224:225], v[4:5]
    v_pk_mul_f32 v[6:7], v[240:241], v[6:7]
    v_mfma_f32_32x32x16_bf16 v[64:79], a[0:3], a[192:195], 0
    v_exp_f32 v96, v96
    v_exp_f32 v97, v97
    v_exp_f32_e64 v98, v98
    v_mfma_f32_32x32x16_bf16 v[64:79], a[4:7], a[196:199], v[64:79]
    v_exp_f32 v99, v99
    v_exp_f32 v100, v100
    v_exp_f32 v101, v101
    v_mfma_f32_32x32x16_bf16 v[64:79], a[8:11], a[200:203], v[64:79]
    v_exp_f32 v102, v102
    v_exp_f32 v103, v103
    v_exp_f32 v104, v104
    v_exp_f32 v105, v105
    v_exp_f32 v106, v106
    v_exp_f32 v107, v107
    v_exp_f32 v108, v108
    v_exp_f32 v109, v109
    v_exp_f32 v110, v110
    v_exp_f32 v111, v111
    v_exp_f32 v2, v2
    v_exp_f32 v3, v3
    v_exp_f32 v4, v4
    v_exp_f32 v5, v5
    v_exp_f32 v6, v6
    v_exp_f32_e64 v7, v7
    v_pk_add_f32 v[96:97], v[96:97], 1.0 op_sel_hi:[1,0]
    v_pk_add_f32 v[98:99], v[98:99], 1.0 op_sel_hi:[1,0]
    v_pk_add_f32 v[100:101], v[100:101], 1.0 op_sel_hi:[1,0]
    v_pk_add_f32 v[102:103], v[102:103], 1.0 op_sel_hi:[1,0]
    v_pk_add_f32 v[104:105], v[104:105], 1.0 op_sel_hi:[1,0]
    v_pk_add_f32 v[106:107], v[106:107], 1.0 op_sel_hi:[1,0]
    v_pk_add_f32 v[108:109], v[108:109], 1.0 op_sel_hi:[1,0]
    v_pk_add_f32 v[110:111], v[110:111], 1.0 op_sel_hi:[1,0]
    v_pk_add_f32 v[2:3], v[2:3], 1.0 op_sel_hi:[1,0]
    v_pk_add_f32 v[4:5], v[4:5], 1.0 op_sel_hi:[1,0]
    v_pk_add_f32 v[6:7], v[6:7], 1.0 op_sel_hi:[1,0]
    v_mfma_f32_32x32x16_bf16 v[64:79], a[12:15], a[204:207], v[64:79]
    v_rcp_f32 v96, v96
    v_rcp_f32 v97, v97
    v_rcp_f32 v98, v98
    v_mfma_f32_32x32x16_bf16 v[64:79], a[16:19], a[208:211], v[64:79]
    v_rcp_f32 v99, v99
    v_rcp_f32 v100, v100
    v_rcp_f32 v101, v101
    v_mfma_f32_32x32x16_bf16 v[64:79], a[20:23], a[212:215], v[64:79]
    v_rcp_f32 v102, v102
    v_rcp_f32 v103, v103
    v_rcp_f32 v104, v104
    v_rcp_f32 v105, v105
    v_rcp_f32 v106, v106
    v_rcp_f32 v107, v107
    v_rcp_f32 v108, v108
    v_rcp_f32 v109, v109
    v_rcp_f32 v110, v110
    v_rcp_f32 v111, v111
    v_rcp_f32 v2, v2
    v_rcp_f32 v3, v3
    v_rcp_f32 v4, v4
    v_rcp_f32 v5, v5
    v_rcp_f32 v6, v6
    v_rcp_f32 v7, v7
    v_pk_mul_f32 v[96:97], v[80:81], v[96:97]
    v_pk_mul_f32 v[98:99], v[82:83], v[98:99]
    v_pk_mul_f32 v[100:101], v[84:85], v[100:101]
    v_pk_mul_f32 v[102:103], v[86:87], v[102:103]
    v_pk_mul_f32 v[104:105], v[88:89], v[104:105]
    v_pk_mul_f32 v[106:107], v[90:91], v[106:107]
    v_pk_mul_f32 v[108:109], v[92:93], v[108:109]
    v_pk_mul_f32 v[110:111], v[94:95], v[110:111]
    v_pk_mul_f32 v[2:3], v[208:209], v[2:3]
    v_pk_mul_f32 v[4:5], v[224:225], v[4:5]
    v_pk_mul_f32 v[6:7], v[240:241], v[6:7]
    v_pk_fma_f32 v[48:49], v[96:97], v[96:97], v[48:49]
    v_pk_fma_f32 v[50:51], v[98:99], v[98:99], v[50:51]
    v_pk_fma_f32 v[52:53], v[100:101], v[100:101], v[52:53]
    v_pk_fma_f32 v[54:55], v[102:103], v[102:103], v[54:55]
    v_pk_fma_f32 v[48:49], v[104:105], v[104:105], v[48:49]
    v_pk_fma_f32 v[50:51], v[106:107], v[106:107], v[50:51]
    v_pk_fma_f32 v[52:53], v[108:109], v[108:109], v[52:53]
    v_pk_fma_f32 v[54:55], v[110:111], v[110:111], v[54:55]
    v_cvt_pk_bf16_f32 v10, v2, v3
    v_cvt_pk_bf16_f32 v11, v4, v5
    v_cvt_pk_bf16_f32 v12, v6, v7
    v_pk_fma_f32 v[40:41], v[2:3], v[2:3], v[40:41]
    v_pk_fma_f32 v[48:49], v[4:5], v[4:5], v[48:49]
    v_pk_mul_f32 v[6:7], v[6:7], v[6:7]
    v_cvt_pk_bf16_f32 v200, v96, v97
    v_cvt_pk_bf16_f32 v201, v98, v99
    v_cvt_pk_bf16_f32 v202, v100, v101
    v_cvt_pk_bf16_f32 v203, v102, v103
    v_cvt_pk_bf16_f32 v204, v104, v105
    v_cvt_pk_bf16_f32 v205, v106, v107
    v_cvt_pk_bf16_f32 v206, v108, v109
    v_cvt_pk_bf16_f32 v207, v110, v111
    v_pk_add_f32 v[48:49], v[48:49], v[50:51]
    v_pk_add_f32 v[52:53], v[52:53], v[54:55]
    v_pk_add_f32 v[42:43], v[48:49], v[52:53]
    v_pk_fma_f32 v[96:97], v[64:65], v[64:65], s[60:61] neg_lo:[1,0,0] neg_hi:[1,0,0]
    v_pk_fma_f32 v[98:99], v[66:67], v[66:67], s[60:61] neg_lo:[1,0,0] neg_hi:[1,0,0]
    v_pk_fma_f32 v[100:101], v[68:69], v[68:69], s[60:61] neg_lo:[1,0,0] neg_hi:[1,0,0]
    v_pk_fma_f32 v[102:103], v[70:71], v[70:71], s[60:61] neg_lo:[1,0,0] neg_hi:[1,0,0]
    v_pk_fma_f32 v[104:105], v[72:73], v[72:73], s[60:61] neg_lo:[1,0,0] neg_hi:[1,0,0]
    v_pk_fma_f32 v[106:107], v[74:75], v[74:75], s[60:61] neg_lo:[1,0,0] neg_hi:[1,0,0]
    v_pk_fma_f32 v[108:109], v[76:77], v[76:77], s[60:61] neg_lo:[1,0,0] neg_hi:[1,0,0]
    v_pk_fma_f32 v[110:111], v[78:79], v[78:79], s[60:61] neg_lo:[1,0,0] neg_hi:[1,0,0]
    v_pk_mul_f32 v[96:97], v[64:65], v[96:97]
    v_pk_mul_f32 v[98:99], v[66:67], v[98:99]
    v_pk_mul_f32 v[100:101], v[68:69], v[100:101]
    v_pk_mul_f32 v[102:103], v[70:71], v[102:103]
    v_pk_mul_f32 v[104:105], v[72:73], v[104:105]
    v_pk_mul_f32 v[106:107], v[74:75], v[106:107]
    v_pk_mul_f32 v[108:109], v[76:77], v[108:109]
    v_pk_mul_f32 v[110:111], v[78:79], v[110:111]
    v_mfma_f32_32x32x16_bf16 v[80:95], a[24:27], a[192:195], 0
    ds_write_b32 v36, v10 offset:0
    v_exp_f32 v96, v96
    v_exp_f32 v97, v97
    v_exp_f32 v98, v98
    v_mfma_f32_32x32x16_bf16 v[80:95], a[28:31], a[196:199], v[80:95]
    ds_write_b32 v36, v11 offset:256
    v_exp_f32 v99, v99
    v_exp_f32 v100, v100
    v_exp_f32 v101, v101
    v_mfma_f32_32x32x16_bf16 v[80:95], a[32:35], a[200:203], v[80:95]
    ds_write_b32 v36, v12 offset:512
    v_exp_f32 v102, v102
    v_exp_f32 v103, v103
    v_exp_f32 v104, v104
    v_exp_f32 v105, v105
    v_exp_f32 v106, v106
    v_exp_f32 v107, v107
    v_exp_f32 v108, v108
    v_exp_f32 v109, v109
    v_exp_f32 v110, v110
    v_exp_f32 v111, v111
    v_pk_add_f32 v[96:97], v[96:97], 1.0 op_sel_hi:[1,0]
    v_pk_add_f32 v[98:99], v[98:99], 1.0 op_sel_hi:[1,0]
    v_pk_add_f32 v[100:101], v[100:101], 1.0 op_sel_hi:[1,0]
    v_pk_add_f32 v[102:103], v[102:103], 1.0 op_sel_hi:[1,0]
    v_pk_add_f32 v[104:105], v[104:105], 1.0 op_sel_hi:[1,0]
    v_pk_add_f32 v[106:107], v[106:107], 1.0 op_sel_hi:[1,0]
    v_pk_add_f32 v[108:109], v[108:109], 1.0 op_sel_hi:[1,0]
    v_pk_add_f32 v[110:111], v[110:111], 1.0 op_sel_hi:[1,0]
    v_mfma_f32_32x32x16_bf16 v[80:95], a[36:39], a[204:207], v[80:95]
    v_rcp_f32 v96, v96
    v_rcp_f32 v97, v97
    v_rcp_f32 v98, v98
    v_mfma_f32_32x32x16_bf16 v[80:95], a[40:43], a[208:211], v[80:95]
    v_rcp_f32 v99, v99
    v_rcp_f32 v100, v100
    v_rcp_f32 v101, v101
    v_mfma_f32_32x32x16_bf16 v[80:95], a[44:47], a[212:215], v[80:95]
    v_rcp_f32 v102, v102
    v_rcp_f32 v103, v103
    v_rcp_f32 v104, v104
    v_rcp_f32 v105, v105
    v_rcp_f32 v106, v106
    v_rcp_f32 v107, v107
    v_rcp_f32 v108, v108
    v_rcp_f32 v109, v109
    v_rcp_f32 v110, v110
    v_rcp_f32 v111, v111
    v_pk_mul_f32 v[96:97], v[64:65], v[96:97]
    v_pk_mul_f32 v[98:99], v[66:67], v[98:99]
    v_pk_mul_f32 v[100:101], v[68:69], v[100:101]
    v_pk_mul_f32 v[102:103], v[70:71], v[102:103]
    v_pk_mul_f32 v[104:105], v[72:73], v[104:105]
    v_pk_mul_f32 v[106:107], v[74:75], v[106:107]
    v_pk_mul_f32 v[108:109], v[76:77], v[108:109]
    v_pk_mul_f32 v[110:111], v[78:79], v[110:111]
    v_pk_fma_f32 v[48:49], v[96:97], v[96:97], v[6:7]
    v_pk_mul_f32 v[50:51], v[98:99], v[98:99]
    v_pk_mul_f32 v[52:53], v[100:101], v[100:101]
    v_pk_mul_f32 v[54:55], v[102:103], v[102:103]
    v_pk_fma_f32 v[48:49], v[104:105], v[104:105], v[48:49]
    v_pk_fma_f32 v[50:51], v[106:107], v[106:107], v[50:51]
    v_pk_fma_f32 v[52:53], v[108:109], v[108:109], v[52:53]
    v_pk_fma_f32 v[54:55], v[110:111], v[110:111], v[54:55]
    v_cvt_pk_bf16_f32 v208, v96, v97
    v_cvt_pk_bf16_f32 v209, v98, v99
    v_cvt_pk_bf16_f32 v210, v100, v101
    v_cvt_pk_bf16_f32 v211, v102, v103
    v_cvt_pk_bf16_f32 v212, v104, v105
    v_cvt_pk_bf16_f32 v213, v106, v107
    v_cvt_pk_bf16_f32 v214, v108, v109
    v_cvt_pk_bf16_f32 v215, v110, v111
    s_waitcnt vmcnt(0)
    v_cmp_ne_u32 vcc, 1, v26
    s_mov_b32 s54, 0
    s_cbranch_vccz L_CLEARED
L_CLRPOLL:
    buffer_load_dword v26, v39, s[36:39], 0 offen sc1
    s_waitcnt vmcnt(0)
    v_cmp_ne_u32 vcc, 1, v26
    s_add_u32 s54, s54, 1
    s_cmp_ge_u32 s54, 0x200000
    s_cbranch_scc1 L_CLEARED
    s_cbranch_vccnz L_CLRPOLL
L_CLEARED:
    v_add_f32 v40, v40, v41
    v_add_f32 v42, v42, v43
    s_add_u32 s47, s53, 0
    s_nop 0
    v_permlane32_swap_b32 v40, v42
    v_add_f32_e64 v40, v40, v42
    v_and_b32 v40, 0x7fffffff, v40
    buffer_store_dword v40, v31, s[40:43], s47 offen sc1
    v_accvgpr_read_b32 v14, a244
    v_pk_fma_f32 v[96:97], v[80:81], v[80:81], s[60:61] neg_lo:[1,0,0] neg_hi:[1,0,0]
    v_pk_fma_f32 v[98:99], v[82:83], v[82:83], s[60:61] neg_lo:[1,0,0] neg_hi:[1,0,0]
    v_pk_fma_f32 v[100:101], v[84:85], v[84:85], s[60:61] neg_lo:[1,0,0] neg_hi:[1,0,0]
    v_pk_fma_f32 v[102:103], v[86:87], v[86:87], s[60:61] neg_lo:[1,0,0] neg_hi:[1,0,0]
    v_pk_fma_f32 v[104:105], v[88:89], v[88:89], s[60:61] neg_lo:[1,0,0] neg_hi:[1,0,0]
    v_pk_fma_f32 v[106:107], v[90:91], v[90:91], s[60:61] neg_lo:[1,0,0] neg_hi:[1,0,0]
    v_pk_fma_f32 v[108:109], v[92:93], v[92:93], s[60:61] neg_lo:[1,0,0] neg_hi:[1,0,0]
    v_pk_fma_f32 v[110:111], v[94:95], v[94:95], s[60:61] neg_lo:[1,0,0] neg_hi:[1,0,0]
    v_pk_mul_f32 v[96:97], v[80:81], v[96:97]
    v_pk_mul_f32 v[98:99], v[82:83], v[98:99]
    v_pk_mul_f32 v[100:101], v[84:85], v[100:101]
    v_pk_mul_f32 v[102:103], v[86:87], v[102:103]
    v_pk_mul_f32 v[104:105], v[88:89], v[104:105]
    v_pk_mul_f32 v[106:107], v[90:91], v[106:107]
    v_pk_mul_f32 v[108:109], v[92:93], v[108:109]
    v_pk_mul_f32 v[110:111], v[94:95], v[110:111]
    v_mfma_f32_32x32x16_bf16 v[64:79], a[48:51], a[192:195], 0
    ds_read_b64_tr_b16 a[144:145], v14 offset:0
    ds_read_b64_tr_b16 a[146:147], v14 offset:3072
    v_exp_f32 v96, v96
    v_exp_f32 v97, v97
    v_exp_f32_e64 v98, v98
    v_mfma_f32_32x32x16_bf16 v[64:79], a[52:55], a[196:199], v[64:79]
    ds_read_b64_tr_b16 a[148:149], v14 offset:8
    ds_read_b64_tr_b16 a[150:151], v14 offset:3080
    v_exp_f32 v99, v99
    v_exp_f32 v100, v100
    v_exp_f32 v101, v101
    v_mfma_f32_32x32x16_bf16 v[64:79], a[56:59], a[200:203], v[64:79]
    ds_read_b64_tr_b16 a[152:153], v14 offset:6144
    ds_read_b64_tr_b16 a[154:155], v14 offset:9216
    v_exp_f32 v102, v102
    v_exp_f32 v103, v103
    v_exp_f32 v104, v104
    v_exp_f32 v105, v105
    v_exp_f32 v106, v106
    v_exp_f32 v107, v107
    v_exp_f32 v108, v108
    v_exp_f32 v109, v109
    v_exp_f32 v110, v110
    v_exp_f32_e64 v111, v111
    v_pk_add_f32 v[96:97], v[96:97], 1.0 op_sel_hi:[1,0]
    v_pk_add_f32 v[98:99], v[98:99], 1.0 op_sel_hi:[1,0]
    v_pk_add_f32 v[100:101], v[100:101], 1.0 op_sel_hi:[1,0]
    v_pk_add_f32 v[102:103], v[102:103], 1.0 op_sel_hi:[1,0]
    v_pk_add_f32 v[104:105], v[104:105], 1.0 op_sel_hi:[1,0]
    v_pk_add_f32 v[106:107], v[106:107], 1.0 op_sel_hi:[1,0]
    v_pk_add_f32 v[108:109], v[108:109], 1.0 op_sel_hi:[1,0]
    v_pk_add_f32 v[110:111], v[110:111], 1.0 op_sel_hi:[1,0]
    v_mfma_f32_32x32x16_bf16 v[64:79], a[60:63], a[204:207], v[64:79]
    ds_read_b64_tr_b16 a[156:157], v14 offset:6152
    ds_read_b64_tr_b16 a[158:159], v14 offset:9224
    v_rcp_f32 v96, v96
    v_rcp_f32 v97, v97
    v_rcp_f32_e64 v98, v98
    v_mfma_f32_32x32x16_bf16 v[64:79], a[64:67], a[208:211], v[64:79]
    ds_read_b64_tr_b16 a[160:161], v14 offset:12288
    ds_read_b64_tr_b16 a[162:163], v14 offset:15360
    v_rcp_f32 v99, v99
    v_rcp_f32 v100, v100
    v_rcp_f32_e64 v101, v101
    v_mfma_f32_32x32x16_bf16 v[64:79], a[68:71], a[212:215], v[64:79]
    ds_read_b64_tr_b16 a[164:165], v14 offset:12296
    ds_read_b64_tr_b16 a[166:167], v14 offset:15368
    v_rcp_f32 v102, v102
    v_rcp_f32 v103, v103
    v_rcp_f32 v104, v104
    v_rcp_f32 v105, v105
    v_rcp_f32 v106, v106
    v_rcp_f32 v107, v107
    v_rcp_f32 v108, v108
    v_rcp_f32 v109, v109
    v_rcp_f32 v110, v110
    v_rcp_f32 v111, v111
    v_pk_mul_f32 v[96:97], v[80:81], v[96:97]
    v_pk_mul_f32 v[98:99], v[82:83], v[98:99]
    v_pk_mul_f32 v[100:101], v[84:85], v[100:101]
    v_pk_mul_f32 v[102:103], v[86:87], v[102:103]
    v_pk_mul_f32 v[104:105], v[88:89], v[104:105]
    v_pk_mul_f32 v[106:107], v[90:91], v[106:107]
    v_pk_mul_f32 v[108:109], v[92:93], v[108:109]
    v_pk_mul_f32 v[110:111], v[94:95], v[110:111]
    v_pk_fma_f32 v[48:49], v[96:97], v[96:97], v[48:49]
    v_pk_fma_f32 v[50:51], v[98:99], v[98:99], v[50:51]
    v_pk_fma_f32 v[52:53], v[100:101], v[100:101], v[52:53]
    v_pk_fma_f32 v[54:55], v[102:103], v[102:103], v[54:55]
    v_pk_fma_f32 v[48:49], v[104:105], v[104:105], v[48:49]
    v_pk_fma_f32 v[50:51], v[106:107], v[106:107], v[50:51]
    v_pk_fma_f32 v[52:53], v[108:109], v[108:109], v[52:53]
    v_pk_fma_f32 v[54:55], v[110:111], v[110:111], v[54:55]
    v_cvt_pk_bf16_f32 v216, v96, v97
    v_cvt_pk_bf16_f32 v217, v98, v99
    v_cvt_pk_bf16_f32 v218, v100, v101
    v_cvt_pk_bf16_f32 v219, v102, v103
    v_cvt_pk_bf16_f32 v220, v104, v105
    v_cvt_pk_bf16_f32 v221, v106, v107
    v_cvt_pk_bf16_f32 v222, v108, v109
    v_cvt_pk_bf16_f32 v223, v110, v111
    v_pk_fma_f32 v[96:97], v[64:65], v[64:65], s[60:61] neg_lo:[1,0,0] neg_hi:[1,0,0]
    v_pk_fma_f32 v[98:99], v[66:67], v[66:67], s[60:61] neg_lo:[1,0,0] neg_hi:[1,0,0]
    v_pk_fma_f32 v[100:101], v[68:69], v[68:69], s[60:61] neg_lo:[1,0,0] neg_hi:[1,0,0]
    v_pk_fma_f32 v[102:103], v[70:71], v[70:71], s[60:61] neg_lo:[1,0,0] neg_hi:[1,0,0]
    v_pk_fma_f32 v[104:105], v[72:73], v[72:73], s[60:61] neg_lo:[1,0,0] neg_hi:[1,0,0]
    v_pk_fma_f32 v[106:107], v[74:75], v[74:75], s[60:61] neg_lo:[1,0,0] neg_hi:[1,0,0]
    v_pk_fma_f32 v[108:109], v[76:77], v[76:77], s[60:61] neg_lo:[1,0,0] neg_hi:[1,0,0]
    v_pk_fma_f32 v[110:111], v[78:79], v[78:79], s[60:61] neg_lo:[1,0,0] neg_hi:[1,0,0]
    v_pk_mul_f32 v[96:97], v[64:65], v[96:97]
    v_pk_mul_f32 v[98:99], v[66:67], v[98:99]
    v_pk_mul_f32 v[100:101], v[68:69], v[100:101]
    v_pk_mul_f32 v[102:103], v[70:71], v[102:103]
    v_pk_mul_f32 v[104:105], v[72:73], v[104:105]
    v_pk_mul_f32 v[106:107], v[74:75], v[106:107]
    v_pk_mul_f32 v[108:109], v[76:77], v[108:109]
    v_pk_mul_f32 v[110:111], v[78:79], v[110:111]
    v_mfma_f32_32x32x16_bf16 v[80:95], a[72:75], a[192:195], 0
    ds_read_b64_tr_b16 a[168:169], v14 offset:64
    ds_read_b64_tr_b16 a[170:171], v14 offset:3136
    v_exp_f32 v96, v96
    v_exp_f32 v97, v97
    v_exp_f32_e64 v98, v98
    v_mfma_f32_32x32x16_bf16 v[80:95], a[76:79], a[196:199], v[80:95]
    ds_read_b64_tr_b16 a[172:173], v14 offset:72
    ds_read_b64_tr_b16 a[174:175], v14 offset:3144
    v_exp_f32 v99, v99
    v_exp_f32 v100, v100
    v_exp_f32 v101, v101
    v_mfma_f32_32x32x16_bf16 v[80:95], a[80:83], a[200:203], v[80:95]
    ds_read_b64_tr_b16 a[176:177], v14 offset:6208
    ds_read_b64_tr_b16 a[178:179], v14 offset:9280
    v_exp_f32 v102, v102
    v_exp_f32 v103, v103
    v_exp_f32 v104, v104
    v_exp_f32 v105, v105
    v_exp_f32 v106, v106
    v_exp_f32 v107, v107
    v_exp_f32 v108, v108
    v_exp_f32 v109, v109
    v_exp_f32 v110, v110
    v_exp_f32_e64 v111, v111
    v_pk_add_f32 v[96:97], v[96:97], 1.0 op_sel_hi:[1,0]
    v_pk_add_f32 v[98:99], v[98:99], 1.0 op_sel_hi:[1,0]
    v_pk_add_f32 v[100:101], v[100:101], 1.0 op_sel_hi:[1,0]
    v_pk_add_f32 v[102:103], v[102:103], 1.0 op_sel_hi:[1,0]
    v_pk_add_f32 v[104:105], v[104:105], 1.0 op_sel_hi:[1,0]
    v_pk_add_f32 v[106:107], v[106:107], 1.0 op_sel_hi:[1,0]
    v_pk_add_f32 v[108:109], v[108:109], 1.0 op_sel_hi:[1,0]
    v_pk_add_f32 v[110:111], v[110:111], 1.0 op_sel_hi:[1,0]
    v_mfma_f32_32x32x16_bf16 v[80:95], a[84:87], a[204:207], v[80:95]
    ds_read_b64_tr_b16 a[180:181], v14 offset:6216
    ds_read_b64_tr_b16 a[182:183], v14 offset:9288
    v_rcp_f32 v96, v96
    v_rcp_f32 v97, v97
    v_rcp_f32_e64 v98, v98
    v_mfma_f32_32x32x16_bf16 v[80:95], a[88:91], a[208:211], v[80:95]
    ds_read_b64_tr_b16 a[184:185], v14 offset:12352
    ds_read_b64_tr_b16 a[186:187], v14 offset:15424
    v_rcp_f32 v99, v99
    v_rcp_f32 v100, v100
    v_rcp_f32_e64 v101, v101
    v_mfma_f32_32x32x16_bf16 v[80:95], a[92:95], a[212:215], v[80:95]
    ds_read_b64_tr_b16 a[188:189], v14 offset:12360
    ds_read_b64_tr_b16 a[190:191], v14 offset:15432
    v_rcp_f32 v102, v102
    v_rcp_f32 v103, v103
    v_rcp_f32 v104, v104
    v_rcp_f32 v105, v105
    v_rcp_f32 v106, v106
    v_rcp_f32 v107, v107
    v_rcp_f32 v108, v108
    v_rcp_f32 v109, v109
    v_rcp_f32 v110, v110
    v_rcp_f32 v111, v111
    v_pk_mul_f32 v[96:97], v[64:65], v[96:97]
    v_pk_mul_f32 v[98:99], v[66:67], v[98:99]
    v_pk_mul_f32 v[100:101], v[68:69], v[100:101]
    v_pk_mul_f32 v[102:103], v[70:71], v[102:103]
    v_pk_mul_f32 v[104:105], v[72:73], v[104:105]
    v_pk_mul_f32 v[106:107], v[74:75], v[106:107]
    v_pk_mul_f32 v[108:109], v[76:77], v[108:109]
    v_pk_mul_f32 v[110:111], v[78:79], v[110:111]
    v_pk_fma_f32 v[48:49], v[96:97], v[96:97], v[48:49]
    v_pk_fma_f32 v[50:51], v[98:99], v[98:99], v[50:51]
    v_pk_fma_f32 v[52:53], v[100:101], v[100:101], v[52:53]
    v_pk_fma_f32 v[54:55], v[102:103], v[102:103], v[54:55]
    v_pk_fma_f32 v[48:49], v[104:105], v[104:105], v[48:49]
    v_pk_fma_f32 v[50:51], v[106:107], v[106:107], v[50:51]
    v_pk_fma_f32 v[52:53], v[108:109], v[108:109], v[52:53]
    v_pk_fma_f32 v[54:55], v[110:111], v[110:111], v[54:55]
    v_cvt_pk_bf16_f32 v224, v96, v97
    v_cvt_pk_bf16_f32 v225, v98, v99
    v_cvt_pk_bf16_f32 v226, v100, v101
    v_cvt_pk_bf16_f32 v227, v102, v103
    v_cvt_pk_bf16_f32 v228, v104, v105
    v_cvt_pk_bf16_f32 v229, v106, v107
    v_cvt_pk_bf16_f32 v230, v108, v109
    v_cvt_pk_bf16_f32 v231, v110, v111
    v_pk_fma_f32 v[96:97], v[80:81], v[80:81], s[60:61] neg_lo:[1,0,0] neg_hi:[1,0,0]
    v_pk_fma_f32 v[98:99], v[82:83], v[82:83], s[60:61] neg_lo:[1,0,0] neg_hi:[1,0,0]
    v_pk_fma_f32 v[100:101], v[84:85], v[84:85], s[60:61] neg_lo:[1,0,0] neg_hi:[1,0,0]
    v_pk_fma_f32 v[102:103], v[86:87], v[86:87], s[60:61] neg_lo:[1,0,0] neg_hi:[1,0,0]
    v_pk_fma_f32 v[104:105], v[88:89], v[88:89], s[60:61] neg_lo:[1,0,0] neg_hi:[1,0,0]
    v_pk_fma_f32 v[106:107], v[90:91], v[90:91], s[60:61] neg_lo:[1,0,0] neg_hi:[1,0,0]
    v_pk_fma_f32 v[108:109], v[92:93], v[92:93], s[60:61] neg_lo:[1,0,0] neg_hi:[1,0,0]
    v_pk_fma_f32 v[110:111], v[94:95], v[94:95], s[60:61] neg_lo:[1,0,0] neg_hi:[1,0,0]
    v_pk_mul_f32 v[96:97], v[80:81], v[96:97]
    v_pk_mul_f32 v[98:99], v[82:83], v[98:99]
    v_pk_mul_f32 v[100:101], v[84:85], v[100:101]
    v_pk_mul_f32 v[102:103], v[86:87], v[102:103]
    v_pk_mul_f32 v[104:105], v[88:89], v[104:105]
    v_pk_mul_f32 v[106:107], v[90:91], v[106:107]
    v_pk_mul_f32 v[108:109], v[92:93], v[108:109]
    v_pk_mul_f32 v[110:111], v[94:95], v[110:111]
    v_mfma_f32_32x32x16_bf16 v[64:79], a[96:99], a[192:195], 0
    ds_read_b64_tr_b16 a[216:217], v14 offset:128
    ds_read_b64_tr_b16 a[218:219], v14 offset:3200
    v_exp_f32 v96, v96
    v_exp_f32 v97, v97
    v_exp_f32_e64 v98, v98
L_PAD6:
    s_cbranch_execz L_BACKA
    v_mfma_f32_32x32x16_bf16 v[64:79], a[100:103], a[196:199], v[64:79]
    ds_read_b64_tr_b16 a[220:221], v14 offset:136
    ds_read_b64_tr_b16 a[222:223], v14 offset:3208
    v_exp_f32 v99, v99
    v_exp_f32 v100, v100
    v_exp_f32 v101, v101
    v_mfma_f32_32x32x16_bf16 v[64:79], a[104:107], a[200:203], v[64:79]
    ds_read_b64_tr_b16 a[224:225], v14 offset:6272
    ds_read_b64_tr_b16 a[226:227], v14 offset:9344
    v_exp_f32 v102, v102
    v_exp_f32 v103, v103
    v_exp_f32 v104, v104
    v_exp_f32 v105, v105
    v_exp_f32 v106, v106
    v_exp_f32 v107, v107
    v_exp_f32 v108, v108
    v_exp_f32 v109, v109
    v_exp_f32 v110, v110
    v_exp_f32 v111, v111
    v_pk_add_f32 v[96:97], v[96:97], 1.0 op_sel_hi:[1,0]
    v_pk_add_f32 v[98:99], v[98:99], 1.0 op_sel_hi:[1,0]
    v_pk_add_f32 v[100:101], v[100:101], 1.0 op_sel_hi:[1,0]
    v_pk_add_f32 v[102:103], v[102:103], 1.0 op_sel_hi:[1,0]
    v_pk_add_f32 v[104:105], v[104:105], 1.0 op_sel_hi:[1,0]
    v_pk_add_f32 v[106:107], v[106:107], 1.0 op_sel_hi:[1,0]
    v_pk_add_f32 v[108:109], v[108:109], 1.0 op_sel_hi:[1,0]
    v_pk_add_f32 v[110:111], v[110:111], 1.0 op_sel_hi:[1,0]
    v_mfma_f32_32x32x16_bf16 v[64:79], a[108:111], a[204:207], v[64:79]
    ds_read_b64_tr_b16 a[228:229], v14 offset:6280
    ds_read_b64_tr_b16 a[230:231], v14 offset:9352
    v_rcp_f32 v96, v96
    v_rcp_f32 v97, v97
    v_rcp_f32_e64 v98, v98
    v_mfma_f32_32x32x16_bf16 v[64:79], a[112:115], a[208:211], v[64:79]
    ds_read_b64_tr_b16 a[232:233], v14 offset:12416
    ds_read_b64_tr_b16 a[234:235], v14 offset:15488
    v_rcp_f32 v99, v99
    v_rcp_f32 v100, v100
    v_rcp_f32_e64 v101, v101
    v_mfma_f32_32x32x16_bf16 v[64:79], a[116:119], a[212:215], v[64:79]
    ds_read_b64_tr_b16 a[236:237], v14 offset:12424
    ds_read_b64_tr_b16 a[238:239], v14 offset:15496
    v_rcp_f32 v102, v102
    v_rcp_f32 v103, v103
    v_rcp_f32 v104, v104
    v_rcp_f32 v105, v105
    v_rcp_f32 v106, v106
    v_rcp_f32 v107, v107
    v_rcp_f32 v108, v108
    v_rcp_f32 v109, v109
    v_rcp_f32 v110, v110
    v_rcp_f32 v111, v111
    v_pk_mul_f32 v[96:97], v[80:81], v[96:97]
    v_pk_mul_f32 v[98:99], v[82:83], v[98:99]
    v_pk_mul_f32 v[100:101], v[84:85], v[100:101]
    v_pk_mul_f32 v[102:103], v[86:87], v[102:103]
    v_pk_mul_f32 v[104:105], v[88:89], v[104:105]
    v_pk_mul_f32 v[106:107], v[90:91], v[106:107]
    v_pk_mul_f32 v[108:109], v[92:93], v[108:109]
    v_pk_mul_f32 v[110:111], v[94:95], v[110:111]
    v_pk_fma_f32 v[48:49], v[96:97], v[96:97], v[48:49]
    v_pk_fma_f32 v[50:51], v[98:99], v[98:99], v[50:51]
    v_pk_fma_f32 v[52:53], v[100:101], v[100:101], v[52:53]
    v_pk_fma_f32 v[54:55], v[102:103], v[102:103], v[54:55]
    v_pk_fma_f32 v[48:49], v[104:105], v[104:105], v[48:49]
    v_pk_fma_f32 v[50:51], v[106:107], v[106:107], v[50:51]
    v_pk_fma_f32 v[52:53], v[108:109], v[108:109], v[52:53]
    v_pk_fma_f32 v[54:55], v[110:111], v[110:111], v[54:55]
    v_cvt_pk_bf16_f32 v232, v96, v97
    v_cvt_pk_bf16_f32 v233, v98, v99
    v_cvt_pk_bf16_f32 v234, v100, v101
    v_cvt_pk_bf16_f32 v235, v102, v103
    v_cvt_pk_bf16_f32 v236, v104, v105
    v_cvt_pk_bf16_f32 v237, v106, v107
    v_cvt_pk_bf16_f32 v238, v108, v109
    v_cvt_pk_bf16_f32 v239, v110, v111
    v_pk_fma_f32 v[96:97], v[64:65], v[64:65], s[60:61] neg_lo:[1,0,0] neg_hi:[1,0,0]
    v_pk_fma_f32 v[98:99], v[66:67], v[66:67], s[60:61] neg_lo:[1,0,0] neg_hi:[1,0,0]
    v_pk_fma_f32 v[100:101], v[68:69], v[68:69], s[60:61] neg_lo:[1,0,0] neg_hi:[1,0,0]
    v_pk_fma_f32 v[102:103], v[70:71], v[70:71], s[60:61] neg_lo:[1,0,0] neg_hi:[1,0,0]
    v_pk_fma_f32 v[104:105], v[72:73], v[72:73], s[60:61] neg_lo:[1,0,0] neg_hi:[1,0,0]
    v_pk_fma_f32 v[106:107], v[74:75], v[74:75], s[60:61] neg_lo:[1,0,0] neg_hi:[1,0,0]
    v_pk_fma_f32 v[108:109], v[76:77], v[76:77], s[60:61] neg_lo:[1,0,0] neg_hi:[1,0,0]
    v_pk_fma_f32 v[110:111], v[78:79], v[78:79], s[60:61] neg_lo:[1,0,0] neg_hi:[1,0,0]
    v_pk_mul_f32 v[96:97], v[64:65], v[96:97]
    v_pk_mul_f32 v[98:99], v[66:67], v[98:99]
    v_pk_mul_f32 v[100:101], v[68:69], v[100:101]
    v_pk_mul_f32 v[102:103], v[70:71], v[102:103]
    v_pk_mul_f32 v[104:105], v[72:73], v[104:105]
    v_pk_mul_f32 v[106:107], v[74:75], v[106:107]
    v_pk_mul_f32 v[108:109], v[76:77], v[108:109]
    v_pk_mul_f32 v[110:111], v[78:79], v[110:111]
    v_mfma_f32_32x32x16_bf16 v[80:95], a[120:123], a[192:195], 0
    v_exp_f32 v96, v96
    v_exp_f32 v97, v97
    v_exp_f32 v98, v98
    v_mfma_f32_32x32x16_bf16 v[80:95], a[124:127], a[196:199], v[80:95]
    v_exp_f32 v99, v99
    v_exp_f32 v100, v100
    v_exp_f32 v101, v101
    v_mfma_f32_32x32x16_bf16 v[80:95], a[128:131], a[200:203], v[80:95]
    v_exp_f32 v102, v102
    v_exp_f32 v103, v103
    v_exp_f32 v104, v104
    v_exp_f32 v105, v105
    v_exp_f32 v106, v106
    v_exp_f32 v107, v107
    v_exp_f32 v108, v108
    v_exp_f32 v109, v109
    v_exp_f32 v110, v110
    v_exp_f32 v111, v111
    v_pk_add_f32 v[96:97], v[96:97], 1.0 op_sel_hi:[1,0]
    v_pk_add_f32 v[98:99], v[98:99], 1.0 op_sel_hi:[1,0]
    v_pk_add_f32 v[100:101], v[100:101], 1.0 op_sel_hi:[1,0]
    v_pk_add_f32 v[102:103], v[102:103], 1.0 op_sel_hi:[1,0]
    v_pk_add_f32 v[104:105], v[104:105], 1.0 op_sel_hi:[1,0]
    v_pk_add_f32 v[106:107], v[106:107], 1.0 op_sel_hi:[1,0]
    v_pk_add_f32 v[108:109], v[108:109], 1.0 op_sel_hi:[1,0]
    v_pk_add_f32 v[110:111], v[110:111], 1.0 op_sel_hi:[1,0]
    v_mfma_f32_32x32x16_bf16 v[80:95], a[132:135], a[204:207], v[80:95]
    v_rcp_f32 v96, v96
    v_rcp_f32 v97, v97
    v_rcp_f32 v98, v98
    v_mfma_f32_32x32x16_bf16 v[80:95], a[136:139], a[208:211], v[80:95]
    v_rcp_f32 v99, v99
    v_rcp_f32 v100, v100
    v_rcp_f32 v101, v101
    v_mfma_f32_32x32x16_bf16 v[80:95], a[140:143], a[212:215], v[80:95]
    v_rcp_f32 v102, v102
    v_rcp_f32 v103, v103
    v_rcp_f32 v104, v104
    v_rcp_f32 v105, v105
    v_rcp_f32 v106, v106
    v_rcp_f32 v107, v107
    v_rcp_f32 v108, v108
    v_rcp_f32 v109, v109
    v_rcp_f32 v110, v110
    v_rcp_f32 v111, v111
    v_pk_mul_f32 v[96:97], v[64:65], v[96:97]
    v_pk_mul_f32 v[98:99], v[66:67], v[98:99]
    v_pk_mul_f32 v[100:101], v[68:69], v[100:101]
    v_pk_mul_f32 v[102:103], v[70:71], v[102:103]
    v_pk_mul_f32 v[104:105], v[72:73], v[104:105]
    v_pk_mul_f32 v[106:107], v[74:75], v[106:107]
    v_pk_mul_f32 v[108:109], v[76:77], v[108:109]
    v_pk_mul_f32 v[110:111], v[78:79], v[110:111]
    v_pk_fma_f32 v[48:49], v[96:97], v[96:97], v[48:49]
    v_pk_fma_f32 v[50:51], v[98:99], v[98:99], v[50:51]
    v_pk_fma_f32 v[52:53], v[100:101], v[100:101], v[52:53]
    v_pk_fma_f32 v[54:55], v[102:103], v[102:103], v[54:55]
    v_pk_fma_f32 v[48:49], v[104:105], v[104:105], v[48:49]
    v_pk_fma_f32 v[50:51], v[106:107], v[106:107], v[50:51]
    v_pk_fma_f32 v[52:53], v[108:109], v[108:109], v[52:53]
    v_pk_fma_f32 v[54:55], v[110:111], v[110:111], v[54:55]
    v_cvt_pk_bf16_f32 v240, v96, v97
    v_cvt_pk_bf16_f32 v241, v98, v99
    v_cvt_pk_bf16_f32 v242, v100, v101
    v_cvt_pk_bf16_f32 v243, v102, v103
    v_cvt_pk_bf16_f32 v244, v104, v105
    v_cvt_pk_bf16_f32 v245, v106, v107
    v_cvt_pk_bf16_f32 v246, v108, v109
    v_cvt_pk_bf16_f32 v247, v110, v111
    v_pk_fma_f32 v[96:97], v[80:81], v[80:81], s[60:61] neg_lo:[1,0,0] neg_hi:[1,0,0]
    v_pk_fma_f32 v[98:99], v[82:83], v[82:83], s[60:61] neg_lo:[1,0,0] neg_hi:[1,0,0]
    v_pk_fma_f32 v[100:101], v[84:85], v[84:85], s[60:61] neg_lo:[1,0,0] neg_hi:[1,0,0]
    v_pk_fma_f32 v[102:103], v[86:87], v[86:87], s[60:61] neg_lo:[1,0,0] neg_hi:[1,0,0]
    v_pk_fma_f32 v[104:105], v[88:89], v[88:89], s[60:61] neg_lo:[1,0,0] neg_hi:[1,0,0]
    v_pk_fma_f32 v[106:107], v[90:91], v[90:91], s[60:61] neg_lo:[1,0,0] neg_hi:[1,0,0]
    v_pk_fma_f32 v[108:109], v[92:93], v[92:93], s[60:61] neg_lo:[1,0,0] neg_hi:[1,0,0]
    v_pk_fma_f32 v[110:111], v[94:95], v[94:95], s[60:61] neg_lo:[1,0,0] neg_hi:[1,0,0]
    v_pk_mul_f32 v[96:97], v[80:81], v[96:97]
    v_pk_mul_f32 v[98:99], v[82:83], v[98:99]
    v_pk_mul_f32 v[100:101], v[84:85], v[100:101]
    v_pk_mul_f32 v[102:103], v[86:87], v[102:103]
    v_pk_mul_f32 v[104:105], v[88:89], v[104:105]
    v_pk_mul_f32 v[106:107], v[90:91], v[106:107]
    v_pk_mul_f32 v[108:109], v[92:93], v[108:109]
    v_pk_mul_f32 v[110:111], v[94:95], v[110:111]
    v_exp_f32 v96, v96
    v_exp_f32 v97, v97
    v_exp_f32 v98, v98
    v_exp_f32 v99, v99
    v_exp_f32 v100, v100
    v_exp_f32 v101, v101
    v_exp_f32 v102, v102
    v_exp_f32 v103, v103
    v_exp_f32 v104, v104
    v_exp_f32 v105, v105
    v_exp_f32 v106, v106
    v_exp_f32 v107, v107
    v_exp_f32 v108, v108
    v_exp_f32 v109, v109
    v_exp_f32 v110, v110
    v_exp_f32 v111, v111
    v_pk_add_f32 v[96:97], v[96:97], 1.0 op_sel_hi:[1,0]
    v_pk_add_f32 v[98:99], v[98:99], 1.0 op_sel_hi:[1,0]
    v_pk_add_f32 v[100:101], v[100:101], 1.0 op_sel_hi:[1,0]
    v_pk_add_f32 v[102:103], v[102:103], 1.0 op_sel_hi:[1,0]
    v_pk_add_f32 v[104:105], v[104:105], 1.0 op_sel_hi:[1,0]
    v_pk_add_f32 v[106:107], v[106:107], 1.0 op_sel_hi:[1,0]
    v_pk_add_f32 v[108:109], v[108:109], 1.0 op_sel_hi:[1,0]
    v_pk_add_f32 v[110:111], v[110:111], 1.0 op_sel_hi:[1,0]
    v_rcp_f32 v96, v96
    v_rcp_f32 v97, v97
    v_rcp_f32 v98, v98
    v_rcp_f32 v99, v99
    v_rcp_f32 v100, v100
    v_rcp_f32 v101, v101
    v_rcp_f32 v102, v102
    v_rcp_f32 v103, v103
    v_rcp_f32 v104, v104
    v_rcp_f32 v105, v105
    v_rcp_f32 v106, v106
    v_rcp_f32 v107, v107
    v_rcp_f32 v108, v108
    v_rcp_f32 v109, v109
    v_rcp_f32 v110, v110
    v_rcp_f32 v111, v111
    v_pk_mul_f32 v[96:97], v[80:81], v[96:97]
    v_pk_mul_f32 v[98:99], v[82:83], v[98:99]
    v_pk_mul_f32 v[100:101], v[84:85], v[100:101]
    v_pk_mul_f32 v[102:103], v[86:87], v[102:103]
    v_pk_mul_f32 v[104:105], v[88:89], v[104:105]
    v_pk_mul_f32 v[106:107], v[90:91], v[106:107]
    v_pk_mul_f32 v[108:109], v[92:93], v[108:109]
    v_pk_mul_f32 v[110:111], v[94:95], v[110:111]
    v_pk_fma_f32 v[48:49], v[96:97], v[96:97], v[48:49]
    v_pk_fma_f32 v[50:51], v[98:99], v[98:99], v[50:51]
    v_pk_fma_f32 v[52:53], v[100:101], v[100:101], v[52:53]
    v_pk_fma_f32 v[54:55], v[102:103], v[102:103], v[54:55]
    v_pk_fma_f32 v[48:49], v[104:105], v[104:105], v[48:49]
    v_pk_fma_f32 v[50:51], v[106:107], v[106:107], v[50:51]
    v_pk_fma_f32 v[52:53], v[108:109], v[108:109], v[52:53]
    v_pk_fma_f32 v[54:55], v[110:111], v[110:111], v[54:55]
    v_pk_add_f32 v[48:49], v[48:49], v[50:51]
    v_pk_add_f32 v[52:53], v[52:53], v[54:55]
    v_pk_add_f32 v[44:45], v[48:49], v[52:53]
    v_add_f32_e64 v44, v44, v45
    v_mov_b32_e64 v45, v44
    s_add_u32 s47, s53, 65536
    s_nop 0
    v_permlane32_swap_b32 v44, v45
    v_add_f32 v44, v44, v45
    s_mov_b64 exec, 0xffffffff
    v_and_b32 v44, 0x7fffffff, v44
    buffer_store_dword v44, v31, s[40:43], s47 offen sc1
    s_mov_b64 exec, -1
    v_cvt_pk_bf16_f32 v248, v96, v97
    v_cvt_pk_bf16_f32 v249, v98, v99
    v_cvt_pk_bf16_f32 v250, v100, v101
    v_cvt_pk_bf16_f32 v251, v102, v103
    v_cvt_pk_bf16_f32 v252, v104, v105
    v_cvt_pk_bf16_f32 v253, v106, v107
    v_cvt_pk_bf16_f32 v254, v108, v109
    v_cvt_pk_bf16_f32 v255, v110, v111
    s_waitcnt lgkmcnt(0)
    s_barrier
    v_accvgpr_read_b32 v15, a247
    v_accvgpr_read_b32 v13, a248
    v_accvgpr_read_b32 v1, a240
    v_mov_b32_e64 v96, v37
    ds_write_b128 v15, v[112:115] offset:0
    buffer_load_dwordx4 v[92:95], v1, s[4:7], s51 offen offset:640
    v_accvgpr_read_b32 v6, a245
    v_accvgpr_read_b32 v7, a246
    v_mov_b32 v4, 0
    v_mov_b32 v5, 0
    v_mov_b32 v8, 0
    v_mov_b32 v9, 0
    ds_write_b128 v15, v[116:119] offset:1024
    v_accvgpr_read_b32 v2, a241
    v_accvgpr_read_b32 v3, a242
    v_accvgpr_read_b32 v12, a243
    v_accvgpr_read_b32 v14, a255
    ds_write_b128 v15, v[120:123] offset:2048
    v_and_b32_e64 v73, 15, v0
    s_lshl_b32 s47, s3, 5
    v_lshl_add_u32 v73, v73, 1, s47
    s_lshl_b32 s47, s44, 10
    v_lshl_add_u32 v72, v0, 4, s47
    v_mfma_f32_16x16x32_bf16 v[112:115], v[6:9], a[144:147], 0
    ds_write_b128 v15, v[124:127] offset:3072
    buffer_load_dwordx4 v[100:103], v2, s[4:7], s51 offen offset:640
    v_mfma_f32_16x16x32_bf16 v[116:119], v[4:7], a[144:147], 0
    ds_write_b128 v15, v[128:131] offset:4096
    buffer_load_ushort v73, v73, s[24:27], 0 offen
    ds_write_b64 v14, v[4:5]
    v_add_u32 v10, 49152, v15
    v_add_u32 v11, 98304, v15
    s_mul_i32 s48, s44, 3072
    v_mfma_f32_16x16x32_bf16 v[120:123], v[6:9], a[148:151], 0
    ds_write_b128 v15, v[132:135] offset:5120
    buffer_load_dwordx4 v[36:39], v13, s[40:43], 0 offen offset:272 sc1
    v_mfma_f32_16x16x32_bf16 v[124:127], v[4:7], a[148:151], 0
    ds_write_b128 v15, v[136:139] offset:6144
    buffer_load_dwordx4 v[108:111], v3, s[4:7], s51 offen offset:640
    v_mfma_f32_16x16x32_bf16 v[128:131], v[6:9], a[152:155], 0
    ds_write_b128 v15, v[140:143] offset:7168
    buffer_load_dwordx4 v[32:35], v13, s[40:43], 0 offen offset:256 sc1
    v_mfma_f32_16x16x32_bf16 v[132:135], v[4:7], a[152:155], 0
    ds_write_b128 v15, v[144:147] offset:8192
    buffer_load_dwordx4 v[28:31], v13, s[40:43], 0 offen offset:144 sc1
    v_mfma_f32_16x16x32_bf16 v[136:139], v[6:9], a[156:159], 0
    ds_write_b128 v15, v[148:151] offset:9216
    buffer_load_dwordx4 a[36:39], v12, s[4:7], s51 offen offset:512
    v_mfma_f32_16x16x32_bf16 v[140:143], v[4:7], a[156:159], 0
    ds_write_b128 v15, v[152:155] offset:10240
    buffer_load_dwordx4 v[24:27], v13, s[40:43], 0 offen offset:128 sc1
    buffer_load_dwordx4 v[40:43], v72, s[8:11], s52 offen sc1
    buffer_load_dwordx4 v[48:51], v72, s[8:11], s55 offen sc1
    buffer_load_dwordx4 v[56:59], v72, s[8:11], s56 offen sc1
    buffer_load_dwordx4 v[64:67], v72, s[8:11], s57 offen sc1
    v_mfma_f32_16x16x32_bf16 v[144:147], v[6:9], a[160:163], 0
    ds_write_b128 v15, v[156:159] offset:11264
    buffer_load_dwordx4 a[40:43], v12, s[4:7], s51 offen offset:576
    v_mfma_f32_16x16x32_bf16 v[148:151], v[4:7], a[160:163], 0
    ds_write_b128 v10, v[160:163] offset:0
    buffer_load_dwordx4 v[20:23], v13, s[40:43], 0 offen offset:16 sc1
    v_mfma_f32_16x16x32_bf16 v[152:155], v[6:9], a[164:167], 0
    ds_write_b128 v10, v[164:167] offset:1024
    buffer_load_dwordx4 v[16:19], v13, s[40:43], 0 offen offset:0 sc1
    v_mfma_f32_16x16x32_bf16 v[156:159], v[4:7], a[164:167], 0
    ds_write_b128 v10, v[168:171] offset:2048
    buffer_load_dwordx4 a[44:47], v12, s[4:7], s51 offen offset:640
    v_mfma_f32_16x16x32_bf16 v[160:163], v[6:9], a[168:171], 0
    ds_write_b128 v10, v[172:175] offset:3072
    v_mfma_f32_16x16x32_bf16 v[164:167], v[4:7], a[168:171], 0
    ds_write_b128 v10, v[176:179] offset:4096
    buffer_load_dwordx4 v[68:71], v1, s[4:7], s51 offen offset:576
    v_mfma_f32_16x16x32_bf16 v[168:171], v[6:9], a[172:175], 0
    ds_write_b128 v10, v[180:183] offset:5120
    v_mfma_f32_16x16x32_bf16 v[172:175], v[4:7], a[172:175], 0
    ds_write_b128 v10, v[184:187] offset:6144
    v_mfma_f32_16x16x32_bf16 v[176:179], v[6:9], a[176:179], 0
    ds_write_b128 v10, v[188:191] offset:7168
    buffer_load_dwordx4 v[76:79], v2, s[4:7], s51 offen offset:576
    v_mfma_f32_16x16x32_bf16 v[180:183], v[4:7], a[176:179], 0
    ds_write_b128 v10, v[192:195] offset:8192
    v_mfma_f32_16x16x32_bf16 v[184:187], v[6:9], a[180:183], 0
    ds_write_b128 v10, v[196:199] offset:9216
    buffer_load_dwordx4 v[84:87], v3, s[4:7], s51 offen offset:576
    v_mfma_f32_16x16x32_bf16 v[188:191], v[4:7], a[180:183], 0
    s_cmp_lt_u32 s3, 24
    s_cbranch_scc1 L_RED
L_NORED:
    ds_write_b128 v10, v[200:203] offset:10240
    v_mfma_f32_16x16x32_bf16 v[192:195], v[6:9], a[184:187], 0
    ds_write_b128 v10, v[204:207] offset:11264
    v_mfma_f32_16x16x32_bf16 v[196:199], v[4:7], a[184:187], 0
    ds_write_b128 v11, v[208:211] offset:0
    buffer_load_dwordx4 v[44:47], v1, s[4:7], s51 offen offset:512
    v_mfma_f32_16x16x32_bf16 v[200:203], v[6:9], a[188:191], 0
    ds_write_b128 v11, v[212:215] offset:1024
    s_add_u32 s47, s44, 1
    s_and_b32 s47, s47, 3
    s_mul_i32 s47, s47, 12288
    s_add_u32 s47, s47, s48
    v_add_u32 v12, s47, v96
    v_add_u32 v13, 65536, v12
    v_mfma_f32_16x16x32_bf16 v[204:207], v[4:7], a[188:191], 0
    ds_write_b128 v11, v[216:219] offset:2048
    buffer_load_dwordx4 v[52:55], v2, s[4:7], s51 offen offset:512
    v_mfma_f32_16x16x32_bf16 v[208:211], v[6:9], a[216:219], 0
    ds_write_b128 v11, v[220:223] offset:3072
    s_add_u32 s47, s44, 2
    s_and_b32 s47, s47, 3
    s_mul_i32 s47, s47, 12288
    s_add_u32 s47, s47, s48
    v_add_u32 v14, s47, v96
    v_add_u32 v15, 65536, v14
    v_mfma_f32_16x16x32_bf16 v[212:215], v[4:7], a[216:219], 0
    ds_write_b128 v11, v[224:227] offset:4096
    v_mfma_f32_16x16x32_bf16 v[216:219], v[6:9], a[220:223], 0
    ds_write_b128 v11, v[228:231] offset:5120
    buffer_load_dwordx4 v[60:63], v3, s[4:7], s51 offen offset:512
    v_mfma_f32_16x16x32_bf16 v[220:223], v[4:7], a[220:223], 0
    ds_write_b128 v11, v[232:235] offset:6144
    v_mfma_f32_16x16x32_bf16 v[224:227], v[6:9], a[224:227], 0
    s_waitcnt vmcnt(15)
    v_mfma_f32_16x16x32_bf16 a[192:195], v[6:9], a[36:39], 0
    ds_write_b128 v11, v[236:239] offset:7168
    v_mfma_f32_16x16x32_bf16 v[228:231], v[4:7], a[224:227], 0
    v_mfma_f32_16x16x32_bf16 a[196:199], v[4:7], a[36:39], 0
    ds_write_b128 v11, v[240:243] offset:8192
    v_mfma_f32_16x16x32_bf16 v[232:235], v[6:9], a[228:231], 0
    s_waitcnt vmcnt(9)
    v_mfma_f32_16x16x32_bf16 a[200:203], v[6:9], a[40:43], 0
    ds_write_b128 v11, v[244:247] offset:9216
    v_mfma_f32_16x16x32_bf16 v[236:239], v[4:7], a[228:231], 0
    v_mfma_f32_16x16x32_bf16 a[204:207], v[4:7], a[40:43], 0
    ds_write_b128 v11, v[248:251] offset:10240
    v_mfma_f32_16x16x32_bf16 v[240:243], v[6:9], a[232:235], 0
    s_waitcnt vmcnt(6)
    s_nop 0
    v_mfma_f32_16x16x32_bf16 a[208:211], v[6:9], a[44:47], 0
    ds_write_b128 v11, v[252:255] offset:11264
    v_mfma_f32_16x16x32_bf16 v[244:247], v[4:7], a[232:235], 0
    v_mfma_f32_16x16x32_bf16 a[212:215], v[4:7], a[44:47], 0
    v_mfma_f32_16x16x32_bf16 v[248:251], v[6:9], a[236:239], 0
    v_mfma_f32_16x16x32_bf16 v[252:255], v[4:7], a[236:239], 0
    s_add_u32 s47, s44, 0
    s_and_b32 s47, s47, 3
    s_mul_i32 s47, s47, 12288
    s_add_u32 s47, s47, s48
    v_add_u32 v10, s47, v96
    v_add_u32 v11, 65536, v10
    s_waitcnt lgkmcnt(0)
    s_barrier
    v_mfma_f32_16x16x32_bf16 v[88:91], v[6:9], v[92:95], v[32:35]
    ds_read_b64_tr_b16 a[36:37], v12 offset:0
    ds_read_b64_tr_b16 a[38:39], v12 offset:256
    v_mfma_f32_16x16x32_bf16 v[92:95], v[4:7], v[92:95], v[36:39]
    ds_read_b64_tr_b16 a[40:41], v12 offset:1024
    ds_read_b64_tr_b16 a[42:43], v12 offset:1280
    v_mfma_f32_16x16x32_bf16 v[96:99], v[6:9], v[100:103], v[32:35]
    ds_read_b64_tr_b16 a[44:45], v12 offset:2048
    ds_read_b64_tr_b16 a[46:47], v12 offset:2304
    v_mfma_f32_16x16x32_bf16 v[100:103], v[4:7], v[100:103], v[36:39]
    ds_read_b64_tr_b16 a[48:49], v12 offset:49152
    ds_read_b64_tr_b16 a[50:51], v12 offset:49408
    v_mfma_f32_16x16x32_bf16 v[104:107], v[6:9], v[108:111], v[32:35]
    ds_read_b64_tr_b16 a[52:53], v12 offset:50176
    ds_read_b64_tr_b16 a[54:55], v12 offset:50432
    v_mfma_f32_16x16x32_bf16 v[108:111], v[4:7], v[108:111], v[36:39]
    ds_read_b64_tr_b16 a[56:57], v12 offset:51200
    ds_read_b64_tr_b16 a[58:59], v12 offset:51456
    s_waitcnt vmcnt(5)
    v_mfma_f32_16x16x32_bf16 v[64:67], v[6:9], v[68:71], v[24:27]
    ds_read_b64_tr_b16 a[60:61], v13 offset:32768
    ds_read_b64_tr_b16 a[62:63], v13 offset:33024
    v_mfma_f32_16x16x32_bf16 v[68:71], v[4:7], v[68:71], v[28:31]
    ds_read_b64_tr_b16 a[64:65], v13 offset:33792
    ds_read_b64_tr_b16 a[66:67], v13 offset:34048
    s_waitcnt vmcnt(4)
    v_mfma_f32_16x16x32_bf16 v[72:75], v[6:9], v[76:79], v[24:27]
    ds_read_b64_tr_b16 a[68:69], v13 offset:34816
    ds_read_b64_tr_b16 a[70:71], v13 offset:35072
    v_mfma_f32_16x16x32_bf16 v[76:79], v[4:7], v[76:79], v[28:31]
    ds_read_b64_tr_b16 a[72:73], v14 offset:0
    ds_read_b64_tr_b16 a[74:75], v14 offset:256
    s_waitcnt vmcnt(3)
    v_mfma_f32_16x16x32_bf16 v[80:83], v[6:9], v[84:87], v[24:27]
    ds_read_b64_tr_b16 a[76:77], v14 offset:1024
    ds_read_b64_tr_b16 a[78:79], v14 offset:1280
    v_mfma_f32_16x16x32_bf16 v[84:87], v[4:7], v[84:87], v[28:31]
    ds_read_b64_tr_b16 a[80:81], v14 offset:2048
    ds_read_b64_tr_b16 a[82:83], v14 offset:2304
    s_waitcnt vmcnt(2)
    v_mfma_f32_16x16x32_bf16 v[40:43], v[6:9], v[44:47], v[16:19]
    ds_read_b64_tr_b16 a[84:85], v14 offset:49152
    ds_read_b64_tr_b16 a[86:87], v14 offset:49408
    v_mfma_f32_16x16x32_bf16 v[44:47], v[4:7], v[44:47], v[20:23]
    ds_read_b64_tr_b16 a[88:89], v14 offset:50176
    ds_read_b64_tr_b16 a[90:91], v14 offset:50432
    s_waitcnt vmcnt(1)
    s_nop 0
    v_mfma_f32_16x16x32_bf16 v[48:51], v[6:9], v[52:55], v[16:19]
    ds_read_b64_tr_b16 a[92:93], v14 offset:51200
    ds_read_b64_tr_b16 a[94:95], v14 offset:51456
    v_mfma_f32_16x16x32_bf16 v[52:55], v[4:7], v[52:55], v[20:23]
    ds_read_b64_tr_b16 a[96:97], v15 offset:32768
    ds_read_b64_tr_b16 a[98:99], v15 offset:33024
    s_waitcnt vmcnt(0)
    v_mfma_f32_16x16x32_bf16 v[56:59], v[6:9], v[60:63], v[16:19]
    ds_read_b64_tr_b16 a[100:101], v15 offset:33792
    ds_read_b64_tr_b16 a[102:103], v15 offset:34048
    v_mfma_f32_16x16x32_bf16 v[60:63], v[4:7], v[60:63], v[20:23]
    ds_read_b64_tr_b16 a[104:105], v15 offset:34816
    ds_read_b64_tr_b16 a[106:107], v15 offset:35072
    s_add_u32 s47, s44, 1
    s_bitcmp1_b32 s47, 1
    s_cselect_b32 s47, -1, 1
    s_mul_i32 s47, s47, 24576
    v_add_u32_e64 v12, s47, v12
    v_add_u32_e64 v13, s47, v13
    v_accvgpr_read_b32 v14, a250
    v_accvgpr_read_b32 v15, a249
    v_accvgpr_read_b32 v8, a251
    s_mov_b32 s62, 0x40088e99
    s_mov_b32 s63, 0x40088e99
    s_cmp_ge_u32 s3, 24
    s_cbranch_scc1 L_NOTEARLY
    buffer_load_dword v4, v14, s[40:43], s58 offen offset:0 sc1
    buffer_load_dword v5, v14, s[40:43], s58 offen offset:1536 sc1
    buffer_load_dwordx4 v[16:19], v15, s[40:43], s58 offen offset:0 sc1
    buffer_load_dwordx4 v[20:23], v15, s[40:43], s58 offen offset:128 sc1
    buffer_load_dwordx4 v[24:27], v15, s[40:43], s58 offen offset:256 sc1
    buffer_load_dwordx4 v[28:31], v15, s[40:43], s58 offen offset:384 sc1
    buffer_load_dwordx4 v[32:35], v15, s[40:43], s58 offen offset:512 sc1
    buffer_load_dwordx4 v[36:39], v15, s[40:43], s58 offen offset:640 sc1
L_NOTEARLY:
    ds_read_b64_tr_b16 a[0:1], v10 offset:0
    ds_read_b64_tr_b16 a[2:3], v10 offset:256
    ds_read_b64_tr_b16 a[4:5], v10 offset:1024
    ds_read_b64_tr_b16 a[6:7], v10 offset:1280
    ds_read_b64_tr_b16 a[8:9], v10 offset:2048
    ds_read_b64_tr_b16 a[10:11], v10 offset:2304
    ds_read_b64_tr_b16 a[12:13], v10 offset:49152
    ds_read_b64_tr_b16 a[14:15], v10 offset:49408
    ds_read_b64_tr_b16 a[16:17], v10 offset:50176
    ds_read_b64_tr_b16 a[18:19], v10 offset:50432
    ds_read_b64_tr_b16 a[20:21], v10 offset:51200
    ds_read_b64_tr_b16 a[22:23], v10 offset:51456
    ds_read_b64_tr_b16 a[24:25], v11 offset:32768
    ds_read_b64_tr_b16 a[26:27], v11 offset:33024
    ds_read_b64_tr_b16 a[28:29], v11 offset:33792
    ds_read_b64_tr_b16 a[30:31], v11 offset:34048
    ds_read_b64_tr_b16 a[32:33], v11 offset:34816
    ds_read_b64_tr_b16 a[34:35], v11 offset:35072
    ds_read_b64_tr_b16 a[108:109], v12 offset:0
    ds_read_b64_tr_b16 a[110:111], v12 offset:256
    ds_read_b64_tr_b16 a[112:113], v12 offset:1024
    ds_read_b64_tr_b16 a[114:115], v12 offset:1280
    ds_read_b64_tr_b16 a[116:117], v12 offset:2048
    ds_read_b64_tr_b16 a[118:119], v12 offset:2304
    ds_read_b64_tr_b16 a[120:121], v12 offset:49152
    ds_read_b64_tr_b16 a[122:123], v12 offset:49408
    ds_read_b64_tr_b16 a[124:125], v12 offset:50176
    ds_read_b64_tr_b16 a[126:127], v12 offset:50432
    ds_read_b64_tr_b16 a[128:129], v12 offset:51200
    ds_read_b64_tr_b16 a[130:131], v12 offset:51456
    ds_read_b64_tr_b16 a[132:133], v13 offset:32768
    ds_read_b64_tr_b16 a[134:135], v13 offset:33024
    ds_read_b64_tr_b16 a[136:137], v13 offset:33792
    ds_read_b64_tr_b16 a[138:139], v13 offset:34048
    ds_read_b64_tr_b16 a[140:141], v13 offset:34816
    ds_read_b64_tr_b16 a[142:143], v13 offset:35072
    ds_read_b64_tr_b16 a[240:241], v8 offset:0
    ds_read_b64_tr_b16 a[242:243], v8 offset:128
    ds_read_b64_tr_b16 a[244:245], v8 offset:256
    ds_read_b64_tr_b16 a[246:247], v8 offset:384
    ds_read_b64_tr_b16 a[248:249], v8 offset:512
    ds_read_b64_tr_b16 a[250:251], v8 offset:640
    s_cmp_lt_u32 s3, 24
    s_cbranch_scc1 L_NOTLATE
    buffer_load_dword v4, v14, s[40:43], s58 offen offset:0 sc1
    buffer_load_dword v5, v14, s[40:43], s58 offen offset:1536 sc1
    buffer_load_dwordx4 v[16:19], v15, s[40:43], s58 offen offset:0 sc1
    buffer_load_dwordx4 v[20:23], v15, s[40:43], s58 offen offset:128 sc1
    buffer_load_dwordx4 v[24:27], v15, s[40:43], s58 offen offset:256 sc1
    buffer_load_dwordx4 v[28:31], v15, s[40:43], s58 offen offset:384 sc1
    buffer_load_dwordx4 v[32:35], v15, s[40:43], s58 offen offset:512 sc1
    buffer_load_dwordx4 v[36:39], v15, s[40:43], s58 offen offset:640 sc1
L_NOTLATE:
    s_mul_i32 s47, s44, 6144
    v_lshl_add_u32 v12, v0, 4, s47
    s_waitcnt vmcnt(0)
    s_branch L_H2CHECK
L_H2POLL:
    buffer_load_dword v4, v14, s[40:43], s58 offen offset:0 sc1
    buffer_load_dword v5, v14, s[40:43], s58 offen offset:1536 sc1
    buffer_load_dwordx4 v[16:19], v15, s[40:43], s58 offen offset:0 sc1
    buffer_load_dwordx4 v[20:23], v15, s[40:43], s58 offen offset:128 sc1
    buffer_load_dwordx4 v[24:27], v15, s[40:43], s58 offen offset:256 sc1
    buffer_load_dwordx4 v[28:31], v15, s[40:43], s58 offen offset:384 sc1
    buffer_load_dwordx4 v[32:35], v15, s[40:43], s58 offen offset:512 sc1
    buffer_load_dwordx4 v[36:39], v15, s[40:43], s58 offen offset:640 sc1
    s_waitcnt vmcnt(0)
L_H2CHECK:
    v_mov_b32 v10, 0x358637bd
    v_add_f32 v9, v4, v5
    v_max3_u32 v6, v4, v5, v16
    v_max3_u32 v7, v17, v18, v19
    v_add_f32_dpp v9, v9, v9 row_ror:1 row_mask:0xf bank_mask:0xf
    v_max3_u32 v6, v6, v20, v21
    v_max3_u32 v7, v7, v22, v23
    v_add_f32_dpp v9, v9, v9 row_ror:2 row_mask:0xf bank_mask:0xf
    v_max3_u32 v6, v6, v24, v25
    v_max3_u32 v7, v7, v26, v27
    v_add_f32_dpp v9, v9, v9 row_ror:4 row_mask:0xf bank_mask:0xf
    v_max3_u32 v6, v6, v28, v29
    v_max3_u32 v7, v7, v30, v31
    v_add_f32_dpp v9, v9, v9 row_ror:8 row_mask:0xf bank_mask:0xf
    v_max3_u32 v6, v6, v32, v33
    v_max3_u32 v7, v7, v34, v35
    v_fmac_f32 v10, 0x3b2aaaab, v9
    v_rcp_f32 v10, v10
    v_max3_u32 v6, v6, v36, v37
    v_max3_u32 v7, v7, v38, v39
    v_max_u32 v6, v6, v7
    v_cmp_eq_u32 vcc, -1, v6
    s_add_u32 s54, s54, 1
    s_cmp_ge_u32 s54, 0x200000
    s_cbranch_scc1 L_H2DONE
    s_cbranch_vccnz L_H2POLL
L_H2DONE:
    v_mul_f32 v6, 0x40088e99, v10
    v_pk_fma_f32 v[16:17], v[16:17], v[6:7], s[62:63] op_sel_hi:[1,0,1]
    v_pk_fma_f32 v[18:19], v[18:19], v[6:7], s[62:63] op_sel_hi:[1,0,1]
    v_pk_fma_f32 v[20:21], v[20:21], v[6:7], s[62:63] op_sel_hi:[1,0,1]
    v_pk_fma_f32 v[22:23], v[22:23], v[6:7], s[62:63] op_sel_hi:[1,0,1]
L_PAD7:
    s_cbranch_execz L_BACKA
    v_pk_fma_f32 v[24:25], v[24:25], v[6:7], s[62:63] op_sel_hi:[1,0,1]
    v_pk_fma_f32 v[26:27], v[26:27], v[6:7], s[62:63] op_sel_hi:[1,0,1]
    s_nop 0
    v_pk_fma_f32 v[28:29], v[28:29], v[6:7], s[62:63] op_sel_hi:[1,0,1]
    v_pk_fma_f32 v[30:31], v[30:31], v[6:7], s[62:63] op_sel_hi:[1,0,1]
    v_pk_fma_f32 v[32:33], v[32:33], v[6:7], s[62:63] op_sel_hi:[1,0,1]
    v_pk_fma_f32 v[34:35], v[34:35], v[6:7], s[62:63] op_sel_hi:[1,0,1]
    v_pk_fma_f32 v[36:37], v[36:37], v[6:7], s[62:63] op_sel_hi:[1,0,1]
    v_pk_fma_f32 v[38:39], v[38:39], v[6:7], s[62:63] op_sel_hi:[1,0,1]
    v_pk_mul_f32 v[112:113], v[112:113], v[16:17]
    v_pk_mul_f32 v[114:115], v[114:115], v[18:19]
    v_pk_mul_f32 v[116:117], v[116:117], v[20:21]
    v_pk_mul_f32 v[118:119], v[118:119], v[22:23]
    v_cvt_pk_bf16_f32 v112, v112, v113
    v_cvt_pk_bf16_f32 v113, v114, v115
    v_cvt_pk_bf16_f32 v114, v116, v117
    v_cvt_pk_bf16_f32 v115, v118, v119
    s_waitcnt lgkmcnt(0)
    s_barrier
    ds_write_b128 v12, v[112:115] offset:0
    v_pk_mul_f32 v[120:121], v[120:121], v[16:17]
    v_pk_mul_f32 v[122:123], v[122:123], v[18:19]
    v_pk_mul_f32 v[124:125], v[124:125], v[20:21]
    v_pk_mul_f32 v[126:127], v[126:127], v[22:23]
    v_cvt_pk_bf16_f32 v120, v120, v121
    v_cvt_pk_bf16_f32 v121, v122, v123
    v_cvt_pk_bf16_f32 v122, v124, v125
    v_cvt_pk_bf16_f32 v123, v126, v127
    ds_write_b128 v12, v[120:123] offset:1024
    v_pk_mul_f32 v[128:129], v[128:129], v[24:25]
    v_pk_mul_f32 v[130:131], v[130:131], v[26:27]
    v_pk_mul_f32 v[132:133], v[132:133], v[28:29]
    v_pk_mul_f32 v[134:135], v[134:135], v[30:31]
    v_cvt_pk_bf16_f32 v128, v128, v129
    v_cvt_pk_bf16_f32 v129, v130, v131
    v_cvt_pk_bf16_f32 v130, v132, v133
    v_cvt_pk_bf16_f32 v131, v134, v135
    ds_write_b128 v12, v[128:131] offset:2048
    v_pk_mul_f32 v[136:137], v[136:137], v[24:25]
    v_pk_mul_f32 v[138:139], v[138:139], v[26:27]
    v_pk_mul_f32 v[140:141], v[140:141], v[28:29]
    v_pk_mul_f32 v[142:143], v[142:143], v[30:31]
    v_cvt_pk_bf16_f32 v136, v136, v137
    v_cvt_pk_bf16_f32 v137, v138, v139
    v_cvt_pk_bf16_f32 v138, v140, v141
    v_cvt_pk_bf16_f32 v139, v142, v143
    v_pk_mul_f32 v[144:145], v[144:145], v[32:33]
    v_pk_mul_f32 v[146:147], v[146:147], v[34:35]
    v_pk_mul_f32 v[148:149], v[148:149], v[36:37]
    v_pk_mul_f32 v[150:151], v[150:151], v[38:39]
    v_cvt_pk_bf16_f32 v144, v144, v145
    v_cvt_pk_bf16_f32 v145, v146, v147
    v_cvt_pk_bf16_f32 v146, v148, v149
    v_cvt_pk_bf16_f32 v147, v150, v151
    v_pk_mul_f32 v[152:153], v[152:153], v[32:33]
    v_pk_mul_f32 v[154:155], v[154:155], v[34:35]
    v_pk_mul_f32 v[156:157], v[156:157], v[36:37]
    v_pk_mul_f32 v[158:159], v[158:159], v[38:39]
    v_cvt_pk_bf16_f32 v152, v152, v153
    v_cvt_pk_bf16_f32 v153, v154, v155
    v_cvt_pk_bf16_f32 v154, v156, v157
    v_cvt_pk_bf16_f32 v155, v158, v159
    v_mfma_f32_16x16x32_bf16 v[40:43], v[112:115], a[0:3], v[40:43]
    ds_write_b128 v12, v[136:139] offset:3072
    v_mfma_f32_16x16x32_bf16 v[48:51], v[112:115], a[4:7], v[48:51]
    s_add_u32 s47, s44, 1
    s_and_b32 s47, s47, 3
    v_mfma_f32_16x16x32_bf16 v[56:59], v[112:115], a[8:11], v[56:59]
    s_mul_i32 s47, s47, 6144
    v_lshl_add_u32 v13, v0, 4, s47
    v_mfma_f32_16x16x32_bf16 a[192:195], v[112:115], a[240:243], a[192:195]
    s_add_u32 s47, s44, 2
    s_and_b32 s47, s47, 3
    v_mfma_f32_16x16x32_bf16 v[44:47], v[120:123], a[0:3], v[44:47]
    ds_write_b128 v12, v[144:147] offset:4096
    v_mfma_f32_16x16x32_bf16 v[52:55], v[120:123], a[4:7], v[52:55]
    s_mul_i32 s47, s47, 6144
    v_lshl_add_u32 v14, v0, 4, s47
    v_mfma_f32_16x16x32_bf16 v[60:63], v[120:123], a[8:11], v[60:63]
    s_add_u32 s47, s44, 3
    s_and_b32 s47, s47, 3
    v_mfma_f32_16x16x32_bf16 a[196:199], v[120:123], a[240:243], a[196:199]
    s_mul_i32 s47, s47, 6144
    v_lshl_add_u32 v15, v0, 4, s47
    v_mfma_f32_16x16x32_bf16 v[40:43], v[128:131], a[12:15], v[40:43]
    ds_write_b128 v12, v[152:155] offset:5120
    v_mfma_f32_16x16x32_bf16 v[48:51], v[128:131], a[16:19], v[48:51]
    v_accvgpr_read_b32 v8, a252
    v_mfma_f32_16x16x32_bf16 v[56:59], v[128:131], a[20:23], v[56:59]
    buffer_load_dwordx4 v[116:119], v8, s[40:43], 0 offen offset:0 sc1
    v_mfma_f32_16x16x32_bf16 a[192:195], v[128:131], a[244:247], a[192:195]
    v_mfma_f32_16x16x32_bf16 v[44:47], v[136:139], a[12:15], v[44:47]
    s_waitcnt lgkmcnt(0)
    s_barrier
    v_mul_f32 v160, v160, v16
    v_mfma_f32_16x16x32_bf16 v[52:55], v[136:139], a[16:19], v[52:55]
    ds_read_b128 a[144:147], v13 offset:0
    v_mul_f32 v161, v161, v17
    v_mfma_f32_16x16x32_bf16 v[60:63], v[136:139], a[20:23], v[60:63]
    ds_read_b128 a[148:151], v13 offset:1024
    v_mul_f32_e64 v162, v162, v18
    v_mfma_f32_16x16x32_bf16 a[196:199], v[136:139], a[244:247], a[196:199]
    ds_read_b128 a[152:155], v13 offset:2048
    v_mul_f32 v163, v163, v19
    v_mfma_f32_16x16x32_bf16 v[40:43], v[144:147], a[24:27], v[40:43]
    ds_read_b128 a[156:159], v13 offset:3072
    v_mul_f32 v164, v164, v20
    v_mfma_f32_16x16x32_bf16 v[48:51], v[144:147], a[28:31], v[48:51]
    ds_read_b128 a[160:163], v13 offset:4096
    v_mul_f32_e64 v165, v165, v21
    v_mfma_f32_16x16x32_bf16 v[56:59], v[144:147], a[32:35], v[56:59]
    ds_read_b128 a[164:167], v13 offset:5120
    v_mul_f32 v166, v166, v22
    v_mfma_f32_16x16x32_bf16 a[192:195], v[144:147], a[248:251], a[192:195]
    ds_read_b128 a[168:171], v14 offset:0
    v_mul_f32 v167, v167, v23
    v_mfma_f32_16x16x32_bf16 v[44:47], v[152:155], a[24:27], v[44:47]
    ds_read_b128 a[172:175], v14 offset:1024
    v_cvt_pk_bf16_f32 v160, v160, v161
    v_mfma_f32_16x16x32_bf16 v[52:55], v[152:155], a[28:31], v[52:55]
    ds_read_b128 a[176:179], v14 offset:2048
    v_cvt_pk_bf16_f32 v161, v162, v163
    v_mfma_f32_16x16x32_bf16 v[60:63], v[152:155], a[32:35], v[60:63]
    ds_read_b128 a[180:183], v14 offset:3072
    v_cvt_pk_bf16_f32 v162, v164, v165
    v_mfma_f32_16x16x32_bf16 a[196:199], v[152:155], a[248:251], a[196:199]
    ds_read_b128 a[184:187], v14 offset:4096
    v_cvt_pk_bf16_f32 v163, v166, v167
    s_waitcnt lgkmcnt(8)
    v_mfma_f32_16x16x32_bf16 v[40:43], a[144:147], a[36:39], v[40:43]
    ds_read_b128 a[188:191], v14 offset:5120
    v_mfma_f32_16x16x32_bf16 v[44:47], a[148:151], a[36:39], v[44:47]
    ds_read_b128 a[216:219], v15 offset:0
    v_mfma_f32_16x16x32_bf16 v[40:43], a[152:155], a[48:51], v[40:43]
    ds_read_b128 a[220:223], v15 offset:1024
    s_waitcnt lgkmcnt(8)
    v_mfma_f32_16x16x32_bf16 v[44:47], a[156:159], a[48:51], v[44:47]
    ds_read_b128 a[224:227], v15 offset:2048
    v_mfma_f32_16x16x32_bf16 v[40:43], a[160:163], a[60:63], v[40:43]
    ds_read_b128 a[228:231], v15 offset:3072
    v_mfma_f32_16x16x32_bf16 v[44:47], a[164:167], a[60:63], v[44:47]
    ds_read_b128 a[232:235], v15 offset:4096
    s_waitcnt lgkmcnt(9)
    v_mfma_f32_16x16x32_bf16 v[40:43], a[168:171], a[72:75], v[40:43]
    ds_read_b128 a[236:239], v15 offset:5120
    v_mfma_f32_16x16x32_bf16 v[44:47], a[172:175], a[72:75], v[44:47]
    buffer_load_dwordx4 v[124:127], v8, s[40:43], 0 offen offset:16 sc1
    s_waitcnt lgkmcnt(8)
    v_mfma_f32_16x16x32_bf16 v[40:43], a[176:179], a[84:87], v[40:43]
    ds_write_b128 v12, v[160:163] offset:24576
    v_mfma_f32_16x16x32_bf16 v[44:47], a[180:183], a[84:87], v[44:47]
    v_mul_f32 v168, v168, v16
    v_mul_f32 v169, v169, v17
    s_waitcnt lgkmcnt(8)
    v_mfma_f32_16x16x32_bf16 v[40:43], a[184:187], a[96:99], v[40:43]
    v_mul_f32 v170, v170, v18
    v_mul_f32 v171, v171, v19
    s_waitcnt lgkmcnt(6)
    v_mfma_f32_16x16x32_bf16 v[44:47], a[188:191], a[96:99], v[44:47]
    v_mul_f32 v172, v172, v20
    v_mul_f32 v173, v173, v21
    v_mfma_f32_16x16x32_bf16 v[40:43], a[216:219], a[108:111], v[40:43]
    v_mul_f32 v174, v174, v22
    v_mul_f32_e64 v175, v175, v23
    s_waitcnt lgkmcnt(3)
    v_mfma_f32_16x16x32_bf16 v[44:47], a[220:223], a[108:111], v[44:47]
    v_cvt_pk_bf16_f32 v168, v168, v169
    v_cvt_pk_bf16_f32 v169, v170, v171
    v_mfma_f32_16x16x32_bf16 v[40:43], a[224:227], a[120:123], v[40:43]
    v_cvt_pk_bf16_f32 v170, v172, v173
    v_cvt_pk_bf16_f32 v171, v174, v175
    v_mfma_f32_16x16x32_bf16 v[44:47], a[228:231], a[120:123], v[44:47]
    ds_write_b128 v12, v[168:171] offset:25600
    s_waitcnt lgkmcnt(1)
    v_mfma_f32_16x16x32_bf16 v[40:43], a[232:235], a[132:135], v[40:43]
    v_mul_f32 v176, v176, v24
    v_mul_f32 v177, v177, v25
    v_mfma_f32_16x16x32_bf16 v[44:47], a[236:239], a[132:135], v[44:47]
    v_mul_f32 v178, v178, v26
    v_mul_f32_e64 v179, v179, v27
    v_mfma_f32_16x16x32_bf16 v[48:51], a[144:147], a[40:43], v[48:51]
    v_mul_f32_e64 v180, v180, v28
    v_mul_f32_e64 v181, v181, v29
    v_mfma_f32_16x16x32_bf16 v[52:55], a[148:151], a[40:43], v[52:55]
    v_mul_f32_e64 v182, v182, v30
    v_mul_f32_e64 v183, v183, v31
    v_mfma_f32_16x16x32_bf16 v[48:51], a[152:155], a[52:55], v[48:51]
    v_cvt_pk_bf16_f32 v176, v176, v177
    v_cvt_pk_bf16_f32 v177, v178, v179
    v_mfma_f32_16x16x32_bf16 v[52:55], a[156:159], a[52:55], v[52:55]
    v_cvt_pk_bf16_f32 v178, v180, v181
    v_cvt_pk_bf16_f32 v179, v182, v183
    v_mfma_f32_16x16x32_bf16 v[48:51], a[160:163], a[64:67], v[48:51]
    ds_write_b128 v12, v[176:179] offset:26624
    v_mfma_f32_16x16x32_bf16 v[52:55], a[164:167], a[64:67], v[52:55]
    v_cvt_pk_bf16_f32 v40, v40, v41
    v_cvt_pk_bf16_f32 v41, v42, v43
    v_mfma_f32_16x16x32_bf16 v[48:51], a[168:171], a[76:79], v[48:51]
    v_cvt_pk_bf16_f32 v42, v44, v45
    v_cvt_pk_bf16_f32 v43, v46, v47
    v_mfma_f32_16x16x32_bf16 v[52:55], a[172:175], a[76:79], v[52:55]
    s_waitcnt vmcnt(0)
    buffer_store_dwordx4 v[40:43], v1, s[32:35], s51 offen offset:0 sc1 nt
    v_mfma_f32_16x16x32_bf16 v[48:51], a[176:179], a[88:91], v[48:51]
    v_mul_f32 v184, v184, v24
    v_mul_f32_e64 v185, v185, v25
    v_mfma_f32_16x16x32_bf16 v[52:55], a[180:183], a[88:91], v[52:55]
    v_mul_f32 v186, v186, v26
    v_mul_f32 v187, v187, v27
    v_mfma_f32_16x16x32_bf16 v[48:51], a[184:187], a[100:103], v[48:51]
    v_mul_f32 v188, v188, v28
    v_mul_f32 v189, v189, v29
    v_mfma_f32_16x16x32_bf16 v[52:55], a[188:191], a[100:103], v[52:55]
    v_mul_f32 v190, v190, v30
    v_mul_f32 v191, v191, v31
    v_mfma_f32_16x16x32_bf16 v[48:51], a[216:219], a[112:115], v[48:51]
    v_cvt_pk_bf16_f32 v184, v184, v185
    v_cvt_pk_bf16_f32 v185, v186, v187
    v_mfma_f32_16x16x32_bf16 v[52:55], a[220:223], a[112:115], v[52:55]
    v_cvt_pk_bf16_f32 v186, v188, v189
    v_cvt_pk_bf16_f32 v187, v190, v191
    v_mfma_f32_16x16x32_bf16 v[48:51], a[224:227], a[124:127], v[48:51]
    ds_write_b128 v12, v[184:187] offset:27648
    v_mfma_f32_16x16x32_bf16 v[52:55], a[228:231], a[124:127], v[52:55]
    v_mul_f32 v192, v192, v32
    v_mul_f32 v193, v193, v33
    v_mfma_f32_16x16x32_bf16 v[48:51], a[232:235], a[136:139], v[48:51]
    v_mul_f32 v194, v194, v34
    v_mul_f32 v195, v195, v35
    v_mfma_f32_16x16x32_bf16 v[52:55], a[236:239], a[136:139], v[52:55]
    v_mul_f32 v196, v196, v36
    v_mul_f32 v197, v197, v37
    v_mfma_f32_16x16x32_bf16 v[56:59], a[144:147], a[44:47], v[56:59]
    v_mul_f32 v198, v198, v38
    v_mul_f32 v199, v199, v39
    v_mfma_f32_16x16x32_bf16 v[60:63], a[148:151], a[44:47], v[60:63]
    v_cvt_pk_bf16_f32 v192, v192, v193
    v_cvt_pk_bf16_f32 v193, v194, v195
    v_mfma_f32_16x16x32_bf16 v[56:59], a[152:155], a[56:59], v[56:59]
    v_cvt_pk_bf16_f32 v194, v196, v197
    v_cvt_pk_bf16_f32 v195, v198, v199
    v_mfma_f32_16x16x32_bf16 v[60:63], a[156:159], a[56:59], v[60:63]
    ds_write_b128 v12, v[192:195] offset:28672
    v_mfma_f32_16x16x32_bf16 v[56:59], a[160:163], a[68:71], v[56:59]
    v_cvt_pk_bf16_f32 v48, v48, v49
    v_cvt_pk_bf16_f32 v49, v50, v51
    v_mfma_f32_16x16x32_bf16 v[60:63], a[164:167], a[68:71], v[60:63]
    v_cvt_pk_bf16_f32 v50, v52, v53
    v_cvt_pk_bf16_f32 v51, v54, v55
    v_mfma_f32_16x16x32_bf16 v[56:59], a[168:171], a[80:83], v[56:59]
    buffer_store_dwordx4 v[48:51], v2, s[32:35], s51 offen offset:0 sc1 nt
    v_mfma_f32_16x16x32_bf16 v[60:63], a[172:175], a[80:83], v[60:63]
    v_mul_f32 v200, v200, v32
    v_mul_f32 v201, v201, v33
    v_mfma_f32_16x16x32_bf16 v[56:59], a[176:179], a[92:95], v[56:59]
    v_mul_f32 v202, v202, v34
    v_mul_f32 v203, v203, v35
    v_mfma_f32_16x16x32_bf16 v[60:63], a[180:183], a[92:95], v[60:63]
    v_mul_f32 v204, v204, v36
    v_mul_f32 v205, v205, v37
    v_mfma_f32_16x16x32_bf16 v[56:59], a[184:187], a[104:107], v[56:59]
    v_mul_f32 v206, v206, v38
    v_mul_f32 v207, v207, v39
    v_mfma_f32_16x16x32_bf16 v[60:63], a[188:191], a[104:107], v[60:63]
    v_cvt_pk_bf16_f32 v200, v200, v201
    v_cvt_pk_bf16_f32 v201, v202, v203
    v_mfma_f32_16x16x32_bf16 v[56:59], a[216:219], a[116:119], v[56:59]
    v_cvt_pk_bf16_f32 v202, v204, v205
    v_cvt_pk_bf16_f32 v203, v206, v207
    v_mfma_f32_16x16x32_bf16 v[60:63], a[220:223], a[116:119], v[60:63]
    ds_write_b128 v12, v[200:203] offset:29696
    v_mfma_f32_16x16x32_bf16 v[56:59], a[224:227], a[128:131], v[56:59]
    v_mfma_f32_16x16x32_bf16 v[60:63], a[228:231], a[128:131], v[60:63]
    v_mfma_f32_16x16x32_bf16 v[56:59], a[232:235], a[140:143], v[56:59]
    v_mfma_f32_16x16x32_bf16 v[60:63], a[236:239], a[140:143], v[60:63]
    v_mfma_f32_16x16x32_bf16 v[64:67], v[160:163], a[0:3], v[64:67]
    v_mfma_f32_16x16x32_bf16 v[72:75], v[160:163], a[4:7], v[72:75]
    v_mfma_f32_16x16x32_bf16 v[80:83], v[160:163], a[8:11], v[80:83]
    s_waitcnt lgkmcnt(0)
    s_barrier
    v_mul_f32_e64 v208, v208, v16
    v_mfma_f32_16x16x32_bf16 a[200:203], v[160:163], a[240:243], a[200:203]
    ds_read_b128 a[144:147], v13 offset:24576
    v_mul_f32 v209, v209, v17
    v_mfma_f32_16x16x32_bf16 v[68:71], v[168:171], a[0:3], v[68:71]
    ds_read_b128 a[148:151], v13 offset:25600
    v_mul_f32 v210, v210, v18
    v_mfma_f32_16x16x32_bf16 v[76:79], v[168:171], a[4:7], v[76:79]
    ds_read_b128 a[152:155], v13 offset:26624
    v_mul_f32_e64 v211, v211, v19
    v_mfma_f32_16x16x32_bf16 v[84:87], v[168:171], a[8:11], v[84:87]
    ds_read_b128 a[156:159], v13 offset:27648
    v_mul_f32 v212, v212, v20
    v_mfma_f32_16x16x32_bf16 a[204:207], v[168:171], a[240:243], a[204:207]
    ds_read_b128 a[160:163], v13 offset:28672
    v_mul_f32 v213, v213, v21
    v_mfma_f32_16x16x32_bf16 v[64:67], v[176:179], a[12:15], v[64:67]
    ds_read_b128 a[164:167], v13 offset:29696
    v_mul_f32_e64 v214, v214, v22
    v_mfma_f32_16x16x32_bf16 v[72:75], v[176:179], a[16:19], v[72:75]
    ds_read_b128 a[168:171], v14 offset:24576
    v_mul_f32_e64 v215, v215, v23
    v_mfma_f32_16x16x32_bf16 v[80:83], v[176:179], a[20:23], v[80:83]
    ds_read_b128 a[172:175], v14 offset:25600
    v_cvt_pk_bf16_f32 v208, v208, v209
    v_mfma_f32_16x16x32_bf16 a[200:203], v[176:179], a[244:247], a[200:203]
    ds_read_b128 a[176:179], v14 offset:26624
    v_cvt_pk_bf16_f32 v209, v210, v211
    v_mfma_f32_16x16x32_bf16 v[68:71], v[184:187], a[12:15], v[68:71]
    ds_read_b128 a[180:183], v14 offset:27648
    v_cvt_pk_bf16_f32 v210, v212, v213
    v_mfma_f32_16x16x32_bf16 v[76:79], v[184:187], a[16:19], v[76:79]
    ds_read_b128 a[184:187], v14 offset:28672
    v_cvt_pk_bf16_f32 v211, v214, v215
    v_mfma_f32_16x16x32_bf16 v[84:87], v[184:187], a[20:23], v[84:87]
    ds_read_b128 a[188:191], v14 offset:29696
    v_cvt_pk_bf16_f32 v56, v56, v57
    v_mfma_f32_16x16x32_bf16 a[204:207], v[184:187], a[244:247], a[204:207]
    ds_read_b128 a[216:219], v15 offset:24576
    v_cvt_pk_bf16_f32 v57, v58, v59
    v_mfma_f32_16x16x32_bf16 v[64:67], v[192:195], a[24:27], v[64:67]
    ds_read_b128 a[220:223], v15 offset:25600
    v_cvt_pk_bf16_f32 v58, v60, v61
    v_mfma_f32_16x16x32_bf16 v[72:75], v[192:195], a[28:31], v[72:75]
    ds_read_b128 a[224:227], v15 offset:26624
    v_cvt_pk_bf16_f32 v59, v62, v63
    v_mfma_f32_16x16x32_bf16 v[80:83], v[192:195], a[32:35], v[80:83]
    ds_read_b128 a[228:231], v15 offset:27648
    v_mfma_f32_16x16x32_bf16 a[200:203], v[192:195], a[248:251], a[200:203]
    ds_read_b128 a[232:235], v15 offset:28672
    v_mfma_f32_16x16x32_bf16 v[68:71], v[200:203], a[24:27], v[68:71]
    ds_read_b128 a[236:239], v15 offset:29696
    v_mfma_f32_16x16x32_bf16 v[76:79], v[200:203], a[28:31], v[76:79]
    ds_write_b128 v12, v[208:211] offset:49152
    v_mfma_f32_16x16x32_bf16 v[84:87], v[200:203], a[32:35], v[84:87]
    buffer_store_dwordx4 v[56:59], v3, s[32:35], s51 offen offset:0 sc1 nt
    v_mfma_f32_16x16x32_bf16 a[204:207], v[200:203], a[248:251], a[204:207]
    v_mul_f32 v216, v216, v16
    v_mul_f32 v217, v217, v17
    s_waitcnt lgkmcnt(7)
    v_mfma_f32_16x16x32_bf16 v[64:67], a[144:147], a[36:39], v[64:67]
    v_mul_f32 v218, v218, v18
    v_mul_f32 v219, v219, v19
    v_mfma_f32_16x16x32_bf16 v[68:71], a[148:151], a[36:39], v[68:71]
    v_mul_f32 v220, v220, v20
    v_mul_f32 v221, v221, v21
    v_mfma_f32_16x16x32_bf16 v[64:67], a[152:155], a[48:51], v[64:67]
    v_mul_f32 v222, v222, v22
    v_mul_f32_e64 v223, v223, v23
    v_mfma_f32_16x16x32_bf16 v[68:71], a[156:159], a[48:51], v[68:71]
    v_cvt_pk_bf16_f32 v216, v216, v217
    v_cvt_pk_bf16_f32 v217, v218, v219
    v_mfma_f32_16x16x32_bf16 v[64:67], a[160:163], a[60:63], v[64:67]
    v_cvt_pk_bf16_f32 v218, v220, v221
    v_cvt_pk_bf16_f32 v219, v222, v223
    v_mfma_f32_16x16x32_bf16 v[68:71], a[164:167], a[60:63], v[68:71]
    ds_write_b128 v12, v[216:219] offset:50176
    v_mfma_f32_16x16x32_bf16 v[64:67], a[168:171], a[72:75], v[64:67]
    v_mul_f32 v224, v224, v24
    v_mul_f32 v225, v225, v25
    v_mfma_f32_16x16x32_bf16 v[68:71], a[172:175], a[72:75], v[68:71]
    v_mul_f32 v226, v226, v26
    v_mul_f32 v227, v227, v27
    v_mfma_f32_16x16x32_bf16 v[64:67], a[176:179], a[84:87], v[64:67]
    v_mul_f32 v228, v228, v28
    v_mul_f32 v229, v229, v29
    v_mfma_f32_16x16x32_bf16 v[68:71], a[180:183], a[84:87], v[68:71]
    v_mul_f32_e64 v230, v230, v30
    v_mul_f32_e64 v231, v231, v31
    v_mfma_f32_16x16x32_bf16 v[64:67], a[184:187], a[96:99], v[64:67]
    v_cvt_pk_bf16_f32 v224, v224, v225
    v_cvt_pk_bf16_f32 v225, v226, v227
    v_mfma_f32_16x16x32_bf16 v[68:71], a[188:191], a[96:99], v[68:71]
    v_cvt_pk_bf16_f32 v226, v228, v229
    v_cvt_pk_bf16_f32 v227, v230, v231
    s_waitcnt lgkmcnt(1)
    v_mfma_f32_16x16x32_bf16 v[64:67], a[216:219], a[108:111], v[64:67]
    ds_write_b128 v12, v[224:227] offset:51200
    v_mfma_f32_16x16x32_bf16 v[68:71], a[220:223], a[108:111], v[68:71]
    v_mul_f32 v232, v232, v24
    v_mul_f32 v233, v233, v25
    v_mfma_f32_16x16x32_bf16 v[64:67], a[224:227], a[120:123], v[64:67]
    v_mul_f32 v234, v234, v26
    v_mul_f32 v235, v235, v27
    v_mfma_f32_16x16x32_bf16 v[68:71], a[228:231], a[120:123], v[68:71]
    v_mul_f32 v236, v236, v28
    v_mul_f32 v237, v237, v29
    v_mfma_f32_16x16x32_bf16 v[64:67], a[232:235], a[132:135], v[64:67]
    v_mul_f32 v238, v238, v30
    v_mul_f32_e64 v239, v239, v31
    v_mfma_f32_16x16x32_bf16 v[68:71], a[236:239], a[132:135], v[68:71]
    v_cvt_pk_bf16_f32 v232, v232, v233
    v_cvt_pk_bf16_f32 v233, v234, v235
    v_mfma_f32_16x16x32_bf16 v[72:75], a[144:147], a[40:43], v[72:75]
    v_cvt_pk_bf16_f32 v234, v236, v237
    v_cvt_pk_bf16_f32 v235, v238, v239
    v_mfma_f32_16x16x32_bf16 v[76:79], a[148:151], a[40:43], v[76:79]
    ds_write_b128 v12, v[232:235] offset:52224
    v_mfma_f32_16x16x32_bf16 v[72:75], a[152:155], a[52:55], v[72:75]
    v_mul_f32 v240, v240, v32
    v_mul_f32 v241, v241, v33
    v_mfma_f32_16x16x32_bf16 v[76:79], a[156:159], a[52:55], v[76:79]
    v_mul_f32 v242, v242, v34
    v_mul_f32 v243, v243, v35
    v_mfma_f32_16x16x32_bf16 v[72:75], a[160:163], a[64:67], v[72:75]
    v_mul_f32 v244, v244, v36
    v_mul_f32 v245, v245, v37
    v_mfma_f32_16x16x32_bf16 v[76:79], a[164:167], a[64:67], v[76:79]
    v_mul_f32 v246, v246, v38
    v_mul_f32 v247, v247, v39
    v_mfma_f32_16x16x32_bf16 v[72:75], a[168:171], a[76:79], v[72:75]
    v_cvt_pk_bf16_f32 v240, v240, v241
    v_cvt_pk_bf16_f32 v241, v242, v243
    v_mfma_f32_16x16x32_bf16 v[76:79], a[172:175], a[76:79], v[76:79]
    v_cvt_pk_bf16_f32 v242, v244, v245
    v_cvt_pk_bf16_f32 v243, v246, v247
    v_mfma_f32_16x16x32_bf16 v[72:75], a[176:179], a[88:91], v[72:75]
    ds_write_b128 v12, v[240:243] offset:53248
    v_mfma_f32_16x16x32_bf16 v[76:79], a[180:183], a[88:91], v[76:79]
    v_mul_f32 v248, v248, v32
    v_mul_f32 v249, v249, v33
    v_mfma_f32_16x16x32_bf16 v[72:75], a[184:187], a[100:103], v[72:75]
    v_mul_f32 v250, v250, v34
    v_mul_f32 v251, v251, v35
    v_mfma_f32_16x16x32_bf16 v[76:79], a[188:191], a[100:103], v[76:79]
    v_mul_f32 v252, v252, v36
    v_mul_f32 v253, v253, v37
    v_mfma_f32_16x16x32_bf16 v[72:75], a[216:219], a[112:115], v[72:75]
    v_mul_f32_e64 v254, v254, v38
    v_mul_f32_e64 v255, v255, v39
    v_mfma_f32_16x16x32_bf16 v[76:79], a[220:223], a[112:115], v[76:79]
    v_cvt_pk_bf16_f32 v248, v248, v249
    v_cvt_pk_bf16_f32 v249, v250, v251
    v_mfma_f32_16x16x32_bf16 v[72:75], a[224:227], a[124:127], v[72:75]
    v_cvt_pk_bf16_f32 v250, v252, v253
    v_cvt_pk_bf16_f32 v251, v254, v255
    v_mfma_f32_16x16x32_bf16 v[76:79], a[228:231], a[124:127], v[76:79]
    ds_write_b128 v12, v[248:251] offset:54272
    v_mfma_f32_16x16x32_bf16 v[72:75], a[232:235], a[136:139], v[72:75]
    v_cvt_pk_bf16_f32 v64, v64, v65
    v_cvt_pk_bf16_f32 v65, v66, v67
    v_mfma_f32_16x16x32_bf16 v[76:79], a[236:239], a[136:139], v[76:79]
    v_cvt_pk_bf16_f32 v66, v68, v69
    v_cvt_pk_bf16_f32 v67, v70, v71
    v_mfma_f32_16x16x32_bf16 v[80:83], a[144:147], a[44:47], v[80:83]
    buffer_store_dwordx4 v[64:67], v1, s[32:35], s51 offen offset:64 sc1 nt
    v_mfma_f32_16x16x32_bf16 v[84:87], a[148:151], a[44:47], v[84:87]
    v_accvgpr_read_b32 v10, a254
    v_mfma_f32_16x16x32_bf16 v[80:83], a[152:155], a[56:59], v[80:83]
    ds_write_b128 v10, a[192:195] offset:0
    v_mfma_f32_16x16x32_bf16 v[84:87], a[156:159], a[56:59], v[84:87]
    v_mfma_f32_16x16x32_bf16 v[80:83], a[160:163], a[68:71], v[80:83]
    v_cvt_pk_bf16_f32 v72, v72, v73
    v_cvt_pk_bf16_f32 v73, v74, v75
    v_mfma_f32_16x16x32_bf16 v[84:87], a[164:167], a[68:71], v[84:87]
    v_cvt_pk_bf16_f32 v74, v76, v77
    v_cvt_pk_bf16_f32 v75, v78, v79
    v_mfma_f32_16x16x32_bf16 v[80:83], a[168:171], a[80:83], v[80:83]
    ds_write_b128 v10, a[196:199] offset:768
    v_mfma_f32_16x16x32_bf16 v[84:87], a[172:175], a[80:83], v[84:87]
    v_mfma_f32_16x16x32_bf16 v[80:83], a[176:179], a[92:95], v[80:83]
    v_mfma_f32_16x16x32_bf16 v[84:87], a[180:183], a[92:95], v[84:87]
    v_mfma_f32_16x16x32_bf16 v[80:83], a[184:187], a[104:107], v[80:83]
    ds_write_b128 v10, a[200:203] offset:64
    v_mfma_f32_16x16x32_bf16 v[84:87], a[188:191], a[104:107], v[84:87]
    v_mfma_f32_16x16x32_bf16 v[80:83], a[216:219], a[116:119], v[80:83]
    buffer_store_dwordx4 v[72:75], v2, s[32:35], s51 offen offset:64 sc1 nt
    v_mfma_f32_16x16x32_bf16 v[84:87], a[220:223], a[116:119], v[84:87]
    v_mfma_f32_16x16x32_bf16 v[80:83], a[224:227], a[128:131], v[80:83]
    ds_write_b128 v10, a[204:207] offset:832
    v_mfma_f32_16x16x32_bf16 v[84:87], a[228:231], a[128:131], v[84:87]
    v_mfma_f32_16x16x32_bf16 v[80:83], a[232:235], a[140:143], v[80:83]
    v_mfma_f32_16x16x32_bf16 v[84:87], a[236:239], a[140:143], v[84:87]
    v_mfma_f32_16x16x32_bf16 a[208:211], v[208:211], a[240:243], a[208:211]
    v_mfma_f32_16x16x32_bf16 a[212:215], v[216:219], a[240:243], a[212:215]
    v_mfma_f32_16x16x32_bf16 a[208:211], v[224:227], a[244:247], a[208:211]
    v_mfma_f32_16x16x32_bf16 a[212:215], v[232:235], a[244:247], a[212:215]
    v_mfma_f32_16x16x32_bf16 a[208:211], v[240:243], a[248:251], a[208:211]
    v_mfma_f32_16x16x32_bf16 a[212:215], v[248:251], a[248:251], a[212:215]
    v_mfma_f32_16x16x32_bf16 v[88:91], v[208:211], a[0:3], v[88:91]
    s_nop 5
    s_nop 0
    ds_write_b128 v10, a[208:211] offset:128
    v_mfma_f32_16x16x32_bf16 v[96:99], v[208:211], a[4:7], v[96:99]
    v_mfma_f32_16x16x32_bf16 v[104:107], v[208:211], a[8:11], v[104:107]
    v_mfma_f32_16x16x32_bf16 v[92:95], v[216:219], a[0:3], v[92:95]
    v_cvt_pk_bf16_f32 v80, v80, v81
    v_cvt_pk_bf16_f32 v81, v82, v83
    v_mfma_f32_16x16x32_bf16 v[100:103], v[216:219], a[4:7], v[100:103]
    ds_write_b128 v10, a[212:215] offset:896
    v_mfma_f32_16x16x32_bf16 v[108:111], v[216:219], a[8:11], v[108:111]
    v_cvt_pk_bf16_f32 v82, v84, v85
    v_cvt_pk_bf16_f32 v83, v86, v87
    v_mfma_f32_16x16x32_bf16 v[88:91], v[224:227], a[12:15], v[88:91]
    buffer_store_dwordx4 v[80:83], v3, s[32:35], s51 offen offset:64 sc1 nt
    v_mfma_f32_16x16x32_bf16 v[96:99], v[224:227], a[16:19], v[96:99]
    v_mfma_f32_16x16x32_bf16 v[104:107], v[224:227], a[20:23], v[104:107]
    v_mfma_f32_16x16x32_bf16 v[92:95], v[232:235], a[12:15], v[92:95]
    s_waitcnt lgkmcnt(0)
    s_barrier
    v_mfma_f32_16x16x32_bf16 v[100:103], v[232:235], a[16:19], v[100:103]
    ds_read_b128 a[144:147], v13 offset:49152
    v_mfma_f32_16x16x32_bf16 v[108:111], v[232:235], a[20:23], v[108:111]
    ds_read_b128 a[148:151], v13 offset:50176
    v_mfma_f32_16x16x32_bf16 v[88:91], v[240:243], a[24:27], v[88:91]
    ds_read_b128 a[152:155], v13 offset:51200
    v_mfma_f32_16x16x32_bf16 v[96:99], v[240:243], a[28:31], v[96:99]
    ds_read_b128 a[156:159], v13 offset:52224
    v_mfma_f32_16x16x32_bf16 v[104:107], v[240:243], a[32:35], v[104:107]
    ds_read_b128 a[160:163], v13 offset:53248
    v_mfma_f32_16x16x32_bf16 v[92:95], v[248:251], a[24:27], v[92:95]
    ds_read_b128 a[164:167], v13 offset:54272
    v_mfma_f32_16x16x32_bf16 v[100:103], v[248:251], a[28:31], v[100:103]
    ds_read_b128 a[168:171], v14 offset:49152
    v_mfma_f32_16x16x32_bf16 v[108:111], v[248:251], a[32:35], v[108:111]
    ds_read_b128 a[172:175], v14 offset:50176
    s_waitcnt lgkmcnt(7)
    v_mfma_f32_16x16x32_bf16 v[88:91], a[144:147], a[36:39], v[88:91]
    ds_read_b128 a[176:179], v14 offset:51200
    s_waitcnt lgkmcnt(7)
    v_mfma_f32_16x16x32_bf16 v[92:95], a[148:151], a[36:39], v[92:95]
    ds_read_b128 a[180:183], v14 offset:52224
    s_waitcnt lgkmcnt(7)
    v_mfma_f32_16x16x32_bf16 v[88:91], a[152:155], a[48:51], v[88:91]
    ds_read_b128 a[184:187], v14 offset:53248
    s_waitcnt lgkmcnt(7)
    v_mfma_f32_16x16x32_bf16 v[92:95], a[156:159], a[48:51], v[92:95]
    ds_read_b128 a[188:191], v14 offset:54272
    s_waitcnt lgkmcnt(7)
    v_mfma_f32_16x16x32_bf16 v[88:91], a[160:163], a[60:63], v[88:91]
    ds_read_b128 a[216:219], v15 offset:49152
    s_waitcnt lgkmcnt(7)
    v_mfma_f32_16x16x32_bf16 v[92:95], a[164:167], a[60:63], v[92:95]
    ds_read_b128 a[220:223], v15 offset:50176
    s_waitcnt lgkmcnt(7)
    v_mfma_f32_16x16x32_bf16 v[88:91], a[168:171], a[72:75], v[88:91]
    ds_read_b128 a[224:227], v15 offset:51200
    s_waitcnt lgkmcnt(7)
    v_mfma_f32_16x16x32_bf16 v[92:95], a[172:175], a[72:75], v[92:95]
    ds_read_b128 a[228:231], v15 offset:52224
    s_waitcnt lgkmcnt(7)
    v_mfma_f32_16x16x32_bf16 v[88:91], a[176:179], a[84:87], v[88:91]
    ds_read_b128 a[232:235], v15 offset:53248
    s_waitcnt lgkmcnt(7)
    v_mfma_f32_16x16x32_bf16 v[92:95], a[180:183], a[84:87], v[92:95]
    ds_read_b128 a[236:239], v15 offset:54272
    s_waitcnt lgkmcnt(7)
    v_mfma_f32_16x16x32_bf16 v[88:91], a[184:187], a[96:99], v[88:91]
    v_accvgpr_read_b32 v5, a253
    v_lshlrev_b32 v7, 4, v0
    s_waitcnt lgkmcnt(6)
    v_mfma_f32_16x16x32_bf16 v[92:95], a[188:191], a[96:99], v[92:95]
    v_add_u32 v7, 73728, v7
    s_waitcnt lgkmcnt(5)
    v_mfma_f32_16x16x32_bf16 v[88:91], a[216:219], a[108:111], v[88:91]
    ds_read_b128 v[40:43], v7 offset:0
    s_waitcnt lgkmcnt(5)
    v_mfma_f32_16x16x32_bf16 v[92:95], a[220:223], a[108:111], v[92:95]
    ds_read_b128 v[44:47], v7 offset:768
    s_waitcnt lgkmcnt(5)
    v_mfma_f32_16x16x32_bf16 v[88:91], a[224:227], a[120:123], v[88:91]
    ds_read_b128 v[48:51], v7 offset:1536
    s_waitcnt lgkmcnt(5)
    s_nop 0
    v_mfma_f32_16x16x32_bf16 v[92:95], a[228:231], a[120:123], v[92:95]
    ds_read_b128 v[52:55], v7 offset:2304
    s_waitcnt lgkmcnt(5)
    v_mfma_f32_16x16x32_bf16 v[88:91], a[232:235], a[132:135], v[88:91]
    ds_read_b128 v[56:59], v7 offset:3072
    s_waitcnt lgkmcnt(5)
    v_mfma_f32_16x16x32_bf16 v[92:95], a[236:239], a[132:135], v[92:95]
    ds_read_b128 v[60:63], v7 offset:3840
    v_mfma_f32_16x16x32_bf16 v[96:99], a[144:147], a[40:43], v[96:99]
    ds_read_b128 v[16:19], v7 offset:4608
L_PAD8:
    s_cbranch_execz L_BACKC
    v_mfma_f32_16x16x32_bf16 v[100:103], a[148:151], a[40:43], v[100:103]
    ds_read_b128 v[20:23], v7 offset:5376
    s_nop 0
    v_mfma_f32_16x16x32_bf16 v[96:99], a[152:155], a[52:55], v[96:99]
    v_mfma_f32_16x16x32_bf16 v[100:103], a[156:159], a[52:55], v[100:103]
    v_mfma_f32_16x16x32_bf16 v[96:99], a[160:163], a[64:67], v[96:99]
    v_cvt_pk_bf16_f32 v88, v88, v89
    v_cvt_pk_bf16_f32 v89, v90, v91
    v_mfma_f32_16x16x32_bf16 v[100:103], a[164:167], a[64:67], v[100:103]
    v_cvt_pk_bf16_f32 v90, v92, v93
    v_cvt_pk_bf16_f32 v91, v94, v95
    v_mfma_f32_16x16x32_bf16 v[96:99], a[168:171], a[76:79], v[96:99]
    buffer_store_dwordx4 v[88:91], v1, s[32:35], s51 offen offset:128 sc1 nt
    v_mfma_f32_16x16x32_bf16 v[100:103], a[172:175], a[76:79], v[100:103]
    s_waitcnt lgkmcnt(5)
    v_add_f32 v40, v40, v48
    s_waitcnt lgkmcnt(1)
    v_add_f32 v16, v16, v56
    v_mfma_f32_16x16x32_bf16 v[96:99], a[176:179], a[88:91], v[96:99]
    v_add_f32 v41, v41, v49
    v_add_f32 v17, v17, v57
    v_mfma_f32_16x16x32_bf16 v[100:103], a[180:183], a[88:91], v[100:103]
    v_add_f32 v42, v42, v50
    v_add_f32 v18, v18, v58
    v_mfma_f32_16x16x32_bf16 v[96:99], a[184:187], a[100:103], v[96:99]
    v_add_f32 v43, v43, v51
    v_add_f32 v19, v19, v59
    v_mfma_f32_16x16x32_bf16 v[100:103], a[188:191], a[100:103], v[100:103]
    v_add_f32 v44, v44, v52
    s_waitcnt lgkmcnt(0)
    v_add_f32 v20, v20, v60
    v_mfma_f32_16x16x32_bf16 v[96:99], a[216:219], a[112:115], v[96:99]
    v_add_f32 v45, v45, v53
    v_add_f32 v21, v21, v61
    v_mfma_f32_16x16x32_bf16 v[100:103], a[220:223], a[112:115], v[100:103]
    v_add_f32 v46, v46, v54
    v_add_f32 v22, v22, v62
    v_mfma_f32_16x16x32_bf16 v[96:99], a[224:227], a[124:127], v[96:99]
    v_add_f32 v47, v47, v55
    v_add_f32 v23, v23, v63
    v_mfma_f32_16x16x32_bf16 v[100:103], a[228:231], a[124:127], v[100:103]
    v_add_f32 v40, v40, v116
    v_add_f32 v41, v41, v117
    v_mfma_f32_16x16x32_bf16 v[96:99], a[232:235], a[136:139], v[96:99]
    v_add_f32 v42, v42, v118
    v_add_f32 v43, v43, v119
    v_mfma_f32_16x16x32_bf16 v[100:103], a[236:239], a[136:139], v[100:103]
    v_add_f32 v44, v44, v124
    v_add_f32 v45, v45, v125
    v_mfma_f32_16x16x32_bf16 v[104:107], a[144:147], a[44:47], v[104:107]
    v_add_f32 v46, v46, v126
    v_add_f32 v47, v47, v127
    v_mfma_f32_16x16x32_bf16 v[108:111], a[148:151], a[44:47], v[108:111]
    v_add_f32 v40, v40, v16
    v_add_f32 v41, v41, v17
    v_mfma_f32_16x16x32_bf16 v[104:107], a[152:155], a[56:59], v[104:107]
    v_add_f32 v42, v42, v18
    v_add_f32 v43, v43, v19
    v_mfma_f32_16x16x32_bf16 v[108:111], a[156:159], a[56:59], v[108:111]
    v_add_f32 v44, v44, v20
    v_add_f32_e64 v45, v45, v21
    v_mfma_f32_16x16x32_bf16 v[104:107], a[160:163], a[68:71], v[104:107]
    v_cvt_pk_bf16_f32 v96, v96, v97
    v_cvt_pk_bf16_f32 v97, v98, v99
    v_mfma_f32_16x16x32_bf16 v[108:111], a[164:167], a[68:71], v[108:111]
    v_cvt_pk_bf16_f32 v98, v100, v101
    v_cvt_pk_bf16_f32 v99, v102, v103
    v_mfma_f32_16x16x32_bf16 v[104:107], a[168:171], a[80:83], v[104:107]
    buffer_store_dwordx4 v[96:99], v2, s[32:35], s51 offen offset:128 sc1 nt
    v_mfma_f32_16x16x32_bf16 v[108:111], a[172:175], a[80:83], v[108:111]
    v_add_f32 v46, v46, v22
    v_add_f32 v47, v47, v23
    v_mfma_f32_16x16x32_bf16 v[104:107], a[176:179], a[92:95], v[104:107]
    v_cvt_pk_bf16_f32 v40, v40, v41
    v_cvt_pk_bf16_f32 v41, v42, v43
    v_mfma_f32_16x16x32_bf16 v[108:111], a[180:183], a[92:95], v[108:111]
    v_cvt_pk_bf16_f32 v42, v44, v45
    v_cvt_pk_bf16_f32 v43, v46, v47
    v_mfma_f32_16x16x32_bf16 v[104:107], a[184:187], a[104:107], v[104:107]
    buffer_store_dwordx4 v[40:43], v5, s[32:35], s51 offen sc1 nt
    v_mfma_f32_16x16x32_bf16 v[108:111], a[188:191], a[104:107], v[108:111]
    v_mfma_f32_16x16x32_bf16 v[104:107], a[216:219], a[116:119], v[104:107]
    v_mfma_f32_16x16x32_bf16 v[108:111], a[220:223], a[116:119], v[108:111]
    v_mfma_f32_16x16x32_bf16 v[104:107], a[224:227], a[128:131], v[104:107]
    v_mfma_f32_16x16x32_bf16 v[108:111], a[228:231], a[128:131], v[108:111]
    v_mfma_f32_16x16x32_bf16 v[104:107], a[232:235], a[140:143], v[104:107]
    v_mfma_f32_16x16x32_bf16 v[108:111], a[236:239], a[140:143], v[108:111]
    s_nop 6
    v_cvt_pk_bf16_f32 v104, v104, v105
    v_cvt_pk_bf16_f32 v105, v106, v107
    v_cvt_pk_bf16_f32 v106, v108, v109
    v_cvt_pk_bf16_f32 v107, v110, v111
    buffer_store_dwordx4 v[104:107], v3, s[32:35], s51 offen offset:128 sc1 nt
L_END:
    s_endpgm
L_RED:
L_PAD9:
    s_cbranch_execz L_BACKD
    v_and_b32 v74, 3, v0
    v_lshrrev_b32 v75, 4, v0
    v_lshl_add_u32 v74, v74, 2, v75
    s_lshl_b32 s47, s44, 2
    s_add_u32 s47, s47, 163072
    v_lshl_add_u32 v74, v74, 4, s47
    v_and_b32 v80, 15, v0
    v_lshlrev_b32 v81, 4, v80
    v_add_u32 v81, 163072, v81
    v_lshrrev_b32 v82, 1, v75
    s_lshl_b32 s47, s44, 1
    v_add_u32 v82, s47, v82
    v_cmp_gt_u32 s[70:71], 4, v82
    v_lshlrev_b32 v82, 12, v82
    v_and_b32_e64 v75, 1, v75
    v_lshl_add_u32 v82, v75, 6, v82
    v_lshl_add_u32 v82, v80, 2, v82
    v_mul_u32_u24 v83, v75, v80
    v_bfrev_b32 v88, 1
    v_cmp_eq_u32 vcc, 0, v83
    v_cmp_eq_u32 s[68:69], 1, v75
    s_and_b64 vcc, vcc, s[70:71]
    s_lshl_b32 s47, s3, 7
    s_add_u32 s47, s47, 393216
    v_cndmask_b32 v82, v88, v82, vcc
    v_mov_b32 v88, 0x358637bd
    s_waitcnt vmcnt(7)
    s_branch L_H1CHECK
L_H1POLL:
    buffer_load_dwordx4 v[40:43], v72, s[8:11], s52 offen sc1
    buffer_load_dwordx4 v[48:51], v72, s[8:11], s55 offen sc1
    buffer_load_dwordx4 v[56:59], v72, s[8:11], s56 offen sc1
    buffer_load_dwordx4 v[64:67], v72, s[8:11], s57 offen sc1
    s_waitcnt vmcnt(0)
L_H1CHECK:
    v_or3_b32 v89, v40, v41, v42
    v_or3_b32 v90, v43, v48, v49
    v_or3_b32 v89, v89, v50, v51
    v_or3_b32 v90, v90, v56, v57
    v_or3_b32 v89, v89, v58, v59
    v_or3_b32 v90, v90, v64, v65
    v_or3_b32 v89, v89, v66, v67
    v_or_b32 v89, v89, v90
    v_cmp_gt_i32 vcc, 0, v89
    s_add_u32 s54, s54, 1
    s_cmp_ge_u32 s54, 0x200000
    s_cbranch_scc1 L_H1DONE
    s_cbranch_vccnz L_H1POLL
L_H1DONE:
    v_pk_add_f32 v[40:41], v[40:41], v[48:49]
    v_pk_add_f32 v[42:43], v[42:43], v[50:51]
    v_pk_add_f32 v[56:57], v[56:57], v[64:65]
    v_pk_add_f32 v[58:59], v[58:59], v[66:67]
    v_pk_add_f32 v[40:41], v[40:41], v[56:57]
    v_pk_add_f32 v[42:43], v[42:43], v[58:59]
    v_lshlrev_b32_e64 v73, 16, v73
    v_add_f32_dpp v40, v40, v40 row_ror:4 row_mask:0xf bank_mask:0xf
    v_add_f32_dpp v41, v41, v41 row_ror:4 row_mask:0xf bank_mask:0xf
    v_add_f32_dpp v42, v42, v42 row_ror:4 row_mask:0xf bank_mask:0xf
    v_add_f32_dpp v43, v43, v43 row_ror:4 row_mask:0xf bank_mask:0xf
    v_add_f32_dpp v40, v40, v40 row_ror:8 row_mask:0xf bank_mask:0xf
    v_add_f32_dpp v41, v41, v41 row_ror:8 row_mask:0xf bank_mask:0xf
    v_add_f32_dpp v42, v42, v42 row_ror:8 row_mask:0xf bank_mask:0xf
    v_add_f32_dpp v43, v43, v43 row_ror:8 row_mask:0xf bank_mask:0xf
    v_permlane16_swap_b32 v40, v41
    s_nop 0
    v_permlane16_swap_b32 v42, v43
    v_add_f32 v40, v40, v41
    v_add_f32 v42, v42, v43
    s_nop 1
    v_permlane32_swap_b32 v40, v42
    v_add_f32 v40, v40, v42
    ds_write_b32 v74, v40
    s_waitcnt lgkmcnt(0)
    s_barrier
    ds_read_b128 v[40:43], v81
    s_waitcnt lgkmcnt(0)
    v_pk_add_f32 v[40:41], v[40:41], v[42:43]
    v_add_f32 v40, v40, v41
    v_fmac_f32 v88, 0x4091afa4, v40
    v_sqrt_f32 v88, v88
    s_nop 0
    v_mul_f32 v89, v73, v88
    v_add_f32_dpp v88, v88, v88 row_ror:1 row_mask:0xf bank_mask:0xf
    s_nop 1
    v_add_f32_dpp v88, v88, v88 row_ror:2 row_mask:0xf bank_mask:0xf
    s_nop 1
    v_add_f32_dpp v88, v88, v88 row_ror:4 row_mask:0xf bank_mask:0xf
    s_nop 1
    v_add_f32_dpp v88, v88, v88 row_ror:8 row_mask:0xf bank_mask:0xf
    v_cndmask_b32 v89, v89, v88, s[68:69]
    buffer_store_dword v89, v82, s[40:43], s47 offen sc1
    s_branch L_NORED
L_CODE_END:
.p2align 7
.type L_TABLE,@object
L_TABLE:
.long 0x1e000, 0x210a0, 0x0, 0x0, 0x1e010, 0x210b0, 0x8, 0x4
.long 0x1e020, 0x210c0, 0x10, 0x8, 0x1e030, 0x210d0, 0x18, 0xc
.long 0x1e040, 0x210e0, 0xc0, 0x10, 0x1e050, 0x210f0, 0xc8, 0x14
.long 0x1e060, 0x22800, 0xd0, 0x18, 0x1e070, 0x22810, 0xd8, 0x1c
.long 0x1e080, 0x22820, 0x180, 0x20, 0x1e090, 0x22830, 0x188, 0x24
.long 0x1e0a0, 0x22840, 0x190, 0x28, 0x1e0b0, 0x22850, 0x198, 0x2c
.long 0x1e0c0, 0x22860, 0x240, 0x30, 0x1e0d0, 0x22870, 0x248, 0x34
.long 0x150e0, 0x150e0, 0x250, 0x38, 0x150f0, 0x150f0, 0x258, 0x3c
.long 0x1e200, 0x212a0, 0x20, 0x4000, 0x1e210, 0x212b0, 0x28, 0x4004
.long 0x1e220, 0x212c0, 0x30, 0x4008, 0x1e230, 0x212d0, 0x38, 0x400c
.long 0x1e240, 0x212e0, 0xe0, 0x4010, 0x1e250, 0x212f0, 0xe8, 0x4014
.long 0x1e260, 0x22a00, 0xf0, 0x4018, 0x1e270, 0x22a10, 0xf8, 0x401c
.long 0x1e280, 0x22a20, 0x1a0, 0x4020, 0x1e290, 0x22a30, 0x1a8, 0x4024
.long 0x1e2a0, 0x22a40, 0x1b0, 0x4028, 0x1e2b0, 0x22a50, 0x1b8, 0x402c
.long 0x1e2c0, 0x22a60, 0x260, 0x4030, 0x1e2d0, 0x22a70, 0x268, 0x4034
.long 0x151e0, 0x151e0, 0x270, 0x4038, 0x151f0, 0x151f0, 0x278, 0x403c
.long 0x1e100, 0x211a0, 0x300, 0x8000, 0x1e110, 0x211b0, 0x308, 0x8004
.long 0x1e120, 0x211c0, 0x310, 0x8008, 0x1e130, 0x211d0, 0x318, 0x800c
.long 0x1e140, 0x211e0, 0x3c0, 0x8010, 0x1e150, 0x211f0, 0x3c8, 0x8014
.long 0x1e160, 0x22900, 0x3d0, 0x8018, 0x1e170, 0x22910, 0x3d8, 0x801c
.long 0x1e180, 0x22920, 0x480, 0x8020, 0x1e190, 0x22930, 0x488, 0x8024
.long 0x1e1a0, 0x22940, 0x490, 0x8028, 0x1e1b0, 0x22950, 0x498, 0x802c
.long 0x1e1c0, 0x22960, 0x540, 0x8030, 0x1e1d0, 0x22970, 0x548, 0x8034
.long 0x152e0, 0x152e0, 0x550, 0x8038, 0x152f0, 0x152f0, 0x558, 0x803c
.long 0x1e300, 0x213a0, 0x320, 0xc000, 0x1e310, 0x213b0, 0x328, 0xc004
.long 0x1e320, 0x213c0, 0x330, 0xc008, 0x1e330, 0x213d0, 0x338, 0xc00c
.long 0x1e340, 0x213e0, 0x3e0, 0xc010, 0x1e350, 0x213f0, 0x3e8, 0xc014
.long 0x1e360, 0x22b00, 0x3f0, 0xc018, 0x1e370, 0x22b10, 0x3f8, 0xc01c
.long 0x1e380, 0x22b20, 0x4a0, 0xc020, 0x1e390, 0x22b30, 0x4a8, 0xc024
.long 0x1e3a0, 0x22b40, 0x4b0, 0xc028, 0x1e3b0, 0x22b50, 0x4b8, 0xc02c
.long 0x1e3c0, 0x22b60, 0x560, 0xc030, 0x1e3d0, 0x22b70, 0x568, 0xc034
.long 0x153e0, 0x153e0, 0x570, 0xc038, 0x153f0, 0x153f0, 0x578, 0xc03c
.long 0x1e0e0, 0x22880, 0x4800, 0x18000, 0x1e0f0, 0x22890, 0x4808, 0x18004
.long 0x1f800, 0x228a0, 0x4810, 0x18008, 0x1f810, 0x228b0, 0x4818, 0x1800c
.long 0x1f820, 0x228c0, 0x48c0, 0x18010, 0x1f830, 0x228d0, 0x48c8, 0x18014
.long 0x1f840, 0x228e0, 0x48d0, 0x18018, 0x1f850, 0x228f0, 0x48d8, 0x1801c
.long 0x1f860, 0x12000, 0x4980, 0x18020, 0x1f870, 0x12010, 0x4988, 0x18024
.long 0x1f880, 0x12020, 0x4990, 0x18028, 0x1f890, 0x12030, 0x4998, 0x1802c
.long 0x1f8a0, 0x12040, 0x4a40, 0x18030, 0x1f8b0, 0x12050, 0x4a48, 0x18034
.long 0x150e0, 0x150e0, 0x4a50, 0x18038, 0x150f0, 0x150f0, 0x4a58, 0x1803c
.long 0x1e2e0, 0x22a80, 0x4820, 0x1c000, 0x1e2f0, 0x22a90, 0x4828, 0x1c004
.long 0x1fa00, 0x22aa0, 0x4830, 0x1c008, 0x1fa10, 0x22ab0, 0x4838, 0x1c00c
.long 0x1fa20, 0x22ac0, 0x48e0, 0x1c010, 0x1fa30, 0x22ad0, 0x48e8, 0x1c014
.long 0x1fa40, 0x22ae0, 0x48f0, 0x1c018, 0x1fa50, 0x22af0, 0x48f8, 0x1c01c
.long 0x1fa60, 0x12200, 0x49a0, 0x1c020, 0x1fa70, 0x12210, 0x49a8, 0x1c024
.long 0x1fa80, 0x12220, 0x49b0, 0x1c028, 0x1fa90, 0x12230, 0x49b8, 0x1c02c
.long 0x1faa0, 0x12240, 0x4a60, 0x1c030, 0x1fab0, 0x12250, 0x4a68, 0x1c034
.long 0x151e0, 0x151e0, 0x4a70, 0x1c038, 0x151f0, 0x151f0, 0x4a78, 0x1c03c
.long 0x1e1e0, 0x22980, 0x4b00, 0x20000, 0x1e1f0, 0x22990, 0x4b08, 0x20004
.long 0x1f900, 0x229a0, 0x4b10, 0x20008, 0x1f910, 0x229b0, 0x4b18, 0x2000c
.long 0x1f920, 0x229c0, 0x4bc0, 0x20010, 0x1f930, 0x229d0, 0x4bc8, 0x20014
.long 0x1f940, 0x229e0, 0x4bd0, 0x20018, 0x1f950, 0x229f0, 0x4bd8, 0x2001c
.long 0x1f960, 0x12100, 0x4c80, 0x20020, 0x1f970, 0x12110, 0x4c88, 0x20024
.long 0x1f980, 0x12120, 0x4c90, 0x20028, 0x1f990, 0x12130, 0x4c98, 0x2002c
.long 0x1f9a0, 0x12140, 0x4d40, 0x20030, 0x1f9b0, 0x12150, 0x4d48, 0x20034
.long 0x152e0, 0x152e0, 0x4d50, 0x20038, 0x152f0, 0x152f0, 0x4d58, 0x2003c
.long 0x1e3e0, 0x22b80, 0x4b20, 0x24000, 0x1e3f0, 0x22b90, 0x4b28, 0x24004
.long 0x1fb00, 0x22ba0, 0x4b30, 0x24008, 0x1fb10, 0x22bb0, 0x4b38, 0x2400c
.long 0x1fb20, 0x22bc0, 0x4be0, 0x24010, 0x1fb30, 0x22bd0, 0x4be8, 0x24014
.long 0x1fb40, 0x22be0, 0x4bf0, 0x24018, 0x1fb50, 0x22bf0, 0x4bf8, 0x2401c
.long 0x1fb60, 0x12300, 0x4ca0, 0x24020, 0x1fb70, 0x12310, 0x4ca8, 0x24024
.long 0x1fb80, 0x12320, 0x4cb0, 0x24028, 0x1fb90, 0x12330, 0x4cb8, 0x2402c
.long 0x1fba0, 0x12340, 0x4d60, 0x24030, 0x1fbb0, 0x12350, 0x4d68, 0x24034
.long 0x153e0, 0x153e0, 0x4d70, 0x24038, 0x153f0, 0x153f0, 0x4d78, 0x2403c
.long 0x1f8c0, 0x12060, 0x9000, 0x30000, 0x1f8d0, 0x12070, 0x9008, 0x30004
.long 0x1f8e0, 0x12080, 0x9010, 0x30008, 0x1f8f0, 0x12090, 0x9018, 0x3000c
.long 0x21000, 0x120a0, 0x90c0, 0x30010, 0x21010, 0x120b0, 0x90c8, 0x30014
.long 0x21020, 0x120c0, 0x90d0, 0x30018, 0x21030, 0x120d0, 0x90d8, 0x3001c
.long 0x21040, 0x120e0, 0x9180, 0x30020, 0x21050, 0x120f0, 0x9188, 0x30024
.long 0x21060, 0x13800, 0x9190, 0x30028, 0x21070, 0x13810, 0x9198, 0x3002c
.long 0x21080, 0x13820, 0x9240, 0x30030, 0x21090, 0x13830, 0x9248, 0x30034
.long 0x150e0, 0x150e0, 0x9250, 0x30038, 0x150f0, 0x150f0, 0x9258, 0x3003c
.long 0x1fac0, 0x12260, 0x9020, 0x34000, 0x1fad0, 0x12270, 0x9028, 0x34004
.long 0x1fae0, 0x12280, 0x9030, 0x34008, 0x1faf0, 0x12290, 0x9038, 0x3400c
.long 0x21200, 0x122a0, 0x90e0, 0x34010, 0x21210, 0x122b0, 0x90e8, 0x34014
.long 0x21220, 0x122c0, 0x90f0, 0x34018, 0x21230, 0x122d0, 0x90f8, 0x3401c
.long 0x21240, 0x122e0, 0x91a0, 0x34020, 0x21250, 0x122f0, 0x91a8, 0x34024
.long 0x21260, 0x13a00, 0x91b0, 0x34028, 0x21270, 0x13a10, 0x91b8, 0x3402c
.long 0x21280, 0x13a20, 0x9260, 0x34030, 0x21290, 0x13a30, 0x9268, 0x34034
.long 0x151e0, 0x151e0, 0x9270, 0x34038, 0x151f0, 0x151f0, 0x9278, 0x3403c
.long 0x1f9c0, 0x12160, 0x9300, 0x38000, 0x1f9d0, 0x12170, 0x9308, 0x38004
.long 0x1f9e0, 0x12180, 0x9310, 0x38008, 0x1f9f0, 0x12190, 0x9318, 0x3800c
.long 0x21100, 0x121a0, 0x93c0, 0x38010, 0x21110, 0x121b0, 0x93c8, 0x38014
.long 0x21120, 0x121c0, 0x93d0, 0x38018, 0x21130, 0x121d0, 0x93d8, 0x3801c
.long 0x21140, 0x121e0, 0x9480, 0x38020, 0x21150, 0x121f0, 0x9488, 0x38024
.long 0x21160, 0x13900, 0x9490, 0x38028, 0x21170, 0x13910, 0x9498, 0x3802c
.long 0x21180, 0x13920, 0x9540, 0x38030, 0x21190, 0x13930, 0x9548, 0x38034
.long 0x152e0, 0x152e0, 0x9550, 0x38038, 0x152f0, 0x152f0, 0x9558, 0x3803c
.long 0x1fbc0, 0x12360, 0x9320, 0x3c000, 0x1fbd0, 0x12370, 0x9328, 0x3c004
.long 0x1fbe0, 0x12380, 0x9330, 0x3c008, 0x1fbf0, 0x12390, 0x9338, 0x3c00c
.long 0x21300, 0x123a0, 0x93e0, 0x3c010, 0x21310, 0x123b0, 0x93e8, 0x3c014
.long 0x21320, 0x123c0, 0x93f0, 0x3c018, 0x21330, 0x123d0, 0x93f8, 0x3c01c
.long 0x21340, 0x123e0, 0x94a0, 0x3c020, 0x21350, 0x123f0, 0x94a8, 0x3c024
.long 0x21360, 0x13b00, 0x94b0, 0x3c028, 0x21370, 0x13b10, 0x94b8, 0x3c02c
.long 0x21380, 0x13b20, 0x9560, 0x3c030, 0x21390, 0x13b30, 0x9568, 0x3c034
.long 0x153e0, 0x153e0, 0x9570, 0x3c038, 0x153f0, 0x153f0, 0x9578, 0x3c03c
.long 0x1e000, 0x13840, 0xd800, 0x48000, 0x1e010, 0x13850, 0xd808, 0x48004
.long 0x1e020, 0x13860, 0xd810, 0x48008, 0x1e030, 0x13870, 0xd818, 0x4800c
.long 0x1e040, 0x13880, 0xd8c0, 0x48010, 0x1e050, 0x13890, 0xd8c8, 0x48014
.long 0x1e060, 0x138a0, 0xd8d0, 0x48018, 0x1e070, 0x138b0, 0xd8d8, 0x4801c
.long 0x1e080, 0x138c0, 0xd980, 0x48020, 0x1e090, 0x138d0, 0xd988, 0x48024
.long 0x1e0a0, 0x138e0, 0xd990, 0x48028, 0x1e0b0, 0x138f0, 0xd998, 0x4802c
.long 0x1e0c0, 0x26800, 0xda40, 0x48030, 0x1e0d0, 0x26810, 0xda48, 0x48034
.long 0x150e0, 0x150e0, 0xda50, 0x48038, 0x150f0, 0x150f0, 0xda58, 0x4803c
.long 0x1e200, 0x13a40, 0xd820, 0x4c000, 0x1e210, 0x13a50, 0xd828, 0x4c004
.long 0x1e220, 0x13a60, 0xd830, 0x4c008, 0x1e230, 0x13a70, 0xd838, 0x4c00c
.long 0x1e240, 0x13a80, 0xd8e0, 0x4c010, 0x1e250, 0x13a90, 0xd8e8, 0x4c014
.long 0x1e260, 0x13aa0, 0xd8f0, 0x4c018, 0x1e270, 0x13ab0, 0xd8f8, 0x4c01c
.long 0x1e280, 0x13ac0, 0xd9a0, 0x4c020, 0x1e290, 0x13ad0, 0xd9a8, 0x4c024
.long 0x1e2a0, 0x13ae0, 0xd9b0, 0x4c028, 0x1e2b0, 0x13af0, 0xd9b8, 0x4c02c
.long 0x1e2c0, 0x26a00, 0xda60, 0x4c030, 0x1e2d0, 0x26a10, 0xda68, 0x4c034
.long 0x151e0, 0x151e0, 0xda70, 0x4c038, 0x151f0, 0x151f0, 0xda78, 0x4c03c
.long 0x1e100, 0x13940, 0xdb00, 0x50000, 0x1e110, 0x13950, 0xdb08, 0x50004
.long 0x1e120, 0x13960, 0xdb10, 0x50008, 0x1e130, 0x13970, 0xdb18, 0x5000c
.long 0x1e140, 0x13980, 0xdbc0, 0x50010, 0x1e150, 0x13990, 0xdbc8, 0x50014
.long 0x1e160, 0x139a0, 0xdbd0, 0x50018, 0x1e170, 0x139b0, 0xdbd8, 0x5001c
.long 0x1e180, 0x139c0, 0xdc80, 0x50020, 0x1e190, 0x139d0, 0xdc88, 0x50024
.long 0x1e1a0, 0x139e0, 0xdc90, 0x50028, 0x1e1b0, 0x139f0, 0xdc98, 0x5002c
.long 0x1e1c0, 0x26840, 0xdd40, 0x50030, 0x1e1d0, 0x26850, 0xdd48, 0x50034
.long 0x152e0, 0x152e0, 0xdd50, 0x50038, 0x152f0, 0x152f0, 0xdd58, 0x5003c
.long 0x1e300, 0x13b40, 0xdb20, 0x54000, 0x1e310, 0x13b50, 0xdb28, 0x54004
.long 0x1e320, 0x13b60, 0xdb30, 0x54008, 0x1e330, 0x13b70, 0xdb38, 0x5400c
.long 0x1e340, 0x13b80, 0xdbe0, 0x54010, 0x1e350, 0x13b90, 0xdbe8, 0x54014
.long 0x1e360, 0x13ba0, 0xdbf0, 0x54018, 0x1e370, 0x13bb0, 0xdbf8, 0x5401c
.long 0x1e380, 0x13bc0, 0xdca0, 0x54020, 0x1e390, 0x13bd0, 0xdca8, 0x54024
.long 0x1e3a0, 0x13be0, 0xdcb0, 0x54028, 0x1e3b0, 0x13bf0, 0xdcb8, 0x5402c
.long 0x1e3c0, 0x26a40, 0xdd60, 0x54030, 0x1e3d0, 0x26a50, 0xdd68, 0x54034
.long 0x153e0, 0x153e0, 0xdd70, 0x54038, 0x153f0, 0x153f0, 0xdd78, 0x5403c
.long 0x0, 0xb40, 0x1680, 0x60000, 0x10, 0xb50, 0x1690, 0x60010
.long 0x20, 0xb60, 0x16a0, 0x60020, 0x30, 0xb70, 0x16b0, 0x60030
.long 0x40, 0xb80, 0x1900, 0x60040, 0x50, 0xb90, 0x1910, 0x60050
.long 0x60, 0xba0, 0x1920, 0x60060, 0x70, 0xbb0, 0x1930, 0x60070
.long 0x80, 0xe00, 0x1940, 0x61000, 0x90, 0xe10, 0x1950, 0x61010
.long 0xa0, 0xe20, 0x1960, 0x61020, 0xb0, 0xe30, 0x1970, 0x61030
.long 0x300, 0xe40, 0x1980, 0x61040, 0x310, 0xe50, 0x1990, 0x61050
.long 0x320, 0xe60, 0x19a0, 0x61060, 0x330, 0xe70, 0x19b0, 0x61070
.long 0x340, 0xe80, 0x1c00, 0x62000, 0x350, 0xe90, 0x1c10, 0x62010
.long 0x360, 0xea0, 0x1c20, 0x62020, 0x370, 0xeb0, 0x1c30, 0x62030
.long 0x380, 0x1100, 0x1c40, 0x62040, 0x390, 0x1110, 0x1c50, 0x62050
.long 0x3a0, 0x1120, 0x1c60, 0x62060, 0x3b0, 0x1130, 0x1c70, 0x62070
.long 0x600, 0x1140, 0x1c80, 0x63000, 0x610, 0x1150, 0x1c90, 0x63010
.long 0x620, 0x1160, 0x1ca0, 0x63020, 0x630, 0x1170, 0x1cb0, 0x63030
.long 0x640, 0x1180, 0x1f00, 0x63040, 0x650, 0x1190, 0x1f10, 0x63050
.long 0x660, 0x11a0, 0x1f20, 0x63060, 0x670, 0x11b0, 0x1f30, 0x63070
.long 0x680, 0x1400, 0x1f40, 0x64000, 0x690, 0x1410, 0x1f50, 0x64010
.long 0x6a0, 0x1420, 0x1f60, 0x64020, 0x6b0, 0x1430, 0x1f70, 0x64030
.long 0x900, 0x1440, 0x1f80, 0x64040, 0x910, 0x1450, 0x1f90, 0x64050
.long 0x920, 0x1460, 0x1fa0, 0x64060, 0x930, 0x1470, 0x1fb0, 0x64070
.long 0x940, 0x1480, 0x2200, 0x65000, 0x950, 0x1490, 0x2210, 0x65010
.long 0x960, 0x14a0, 0x2220, 0x65020, 0x970, 0x14b0, 0x2230, 0x65030
.long 0x980, 0x1700, 0x2240, 0x65040, 0x990, 0x1710, 0x2250, 0x65050
.long 0x9a0, 0x1720, 0x2260, 0x65060, 0x9b0, 0x1730, 0x2270, 0x65070
.long 0xc00, 0x1740, 0x2280, 0x66000, 0xc10, 0x1750, 0x2290, 0x66010
.long 0xc20, 0x1760, 0x22a0, 0x66020, 0xc30, 0x1770, 0x22b0, 0x66030
.long 0xc40, 0x1780, 0x2500, 0x66040, 0xc50, 0x1790, 0x2510, 0x66050
.long 0xc60, 0x17a0, 0x2520, 0x66060, 0xc70, 0x17b0, 0x2530, 0x66070
.long 0xc80, 0x1a00, 0x2540, 0x67000, 0xc90, 0x1a10, 0x2550, 0x67010
.long 0xca0, 0x1a20, 0x2560, 0x67020, 0xcb0, 0x1a30, 0x2570, 0x67030
.long 0xf00, 0x1a40, 0x2580, 0x67040, 0xf10, 0x1a50, 0x2590, 0x67050
.long 0xf20, 0x1a60, 0x25a0, 0x67060, 0xf30, 0x1a70, 0x25b0, 0x67070
.long 0x0, 0xb40, 0x1680, 0x60000, 0x10, 0xb50, 0x1690, 0x60010
.long 0x20, 0xb60, 0x16a0, 0x60020, 0x30, 0xb70, 0x16b0, 0x60030
.long 0x40, 0xb80, 0x1900, 0x60040, 0x50, 0xb90, 0x1910, 0x60050
.long 0x60, 0xba0, 0x1920, 0x60060, 0x70, 0xbb0, 0x1930, 0x60070
.long 0x80, 0xe00, 0x1940, 0x61000, 0x90, 0xe10, 0x1950, 0x61010
.long 0xa0, 0xe20, 0x1960, 0x61020, 0xb0, 0xe30, 0x1970, 0x61030
.long 0x300, 0xe40, 0x1980, 0x61040, 0x310, 0xe50, 0x1990, 0x61050
.long 0x320, 0xe60, 0x19a0, 0x61060, 0x330, 0xe70, 0x19b0, 0x61070
.long 0x340, 0xe80, 0x1c00, 0x62000, 0x350, 0xe90, 0x1c10, 0x62010
.long 0x360, 0xea0, 0x1c20, 0x62020, 0x370, 0xeb0, 0x1c30, 0x62030
.long 0x380, 0x1100, 0x1c40, 0x62040, 0x390, 0x1110, 0x1c50, 0x62050
.long 0x3a0, 0x1120, 0x1c60, 0x62060, 0x3b0, 0x1130, 0x1c70, 0x62070
.long 0x600, 0x1140, 0x1c80, 0x63000, 0x610, 0x1150, 0x1c90, 0x63010
.long 0x620, 0x1160, 0x1ca0, 0x63020, 0x630, 0x1170, 0x1cb0, 0x63030
.long 0x640, 0x1180, 0x1f00, 0x63040, 0x650, 0x1190, 0x1f10, 0x63050
.long 0x660, 0x11a0, 0x1f20, 0x63060, 0x670, 0x11b0, 0x1f30, 0x63070
.long 0x680, 0x1400, 0x1f40, 0x64000, 0x690, 0x1410, 0x1f50, 0x64010
.long 0x6a0, 0x1420, 0x1f60, 0x64020, 0x6b0, 0x1430, 0x1f70, 0x64030
.long 0x900, 0x1440, 0x1f80, 0x64040, 0x910, 0x1450, 0x1f90, 0x64050
.long 0x920, 0x1460, 0x1fa0, 0x64060, 0x930, 0x1470, 0x1fb0, 0x64070
.long 0x940, 0x1480, 0x2200, 0x65000, 0x950, 0x1490, 0x2210, 0x65010
.long 0x960, 0x14a0, 0x2220, 0x65020, 0x970, 0x14b0, 0x2230, 0x65030
.long 0x980, 0x1700, 0x2240, 0x65040, 0x990, 0x1710, 0x2250, 0x65050
.long 0x9a0, 0x1720, 0x2260, 0x65060, 0x9b0, 0x1730, 0x2270, 0x65070
.long 0xc00, 0x1740, 0x2280, 0x66000, 0xc10, 0x1750, 0x2290, 0x66010
.long 0xc20, 0x1760, 0x22a0, 0x66020, 0xc30, 0x1770, 0x22b0, 0x66030
.long 0xc40, 0x1780, 0x2500, 0x66040, 0xc50, 0x1790, 0x2510, 0x66050
.long 0xc60, 0x17a0, 0x2520, 0x66060, 0xc70, 0x17b0, 0x2530, 0x66070
.long 0xc80, 0x1a00, 0x2540, 0x67000, 0xc90, 0x1a10, 0x2550, 0x67010
.long 0xca0, 0x1a20, 0x2560, 0x67020, 0xcb0, 0x1a30, 0x2570, 0x67030
.long 0xf00, 0x1a40, 0x2580, 0x67040, 0xf10, 0x1a50, 0x2590, 0x67050
.long 0xf20, 0x1a60, 0x25a0, 0x67060, 0xf30, 0x1a70, 0x25b0, 0x67070
.long 0x0, 0xb40, 0x1680, 0x60000, 0x10, 0xb50, 0x1690, 0x60010
.long 0x20, 0xb60, 0x16a0, 0x60020, 0x30, 0xb70, 0x16b0, 0x60030
.long 0x40, 0xb80, 0x1900, 0x60040, 0x50, 0xb90, 0x1910, 0x60050
.long 0x60, 0xba0, 0x1920, 0x60060, 0x70, 0xbb0, 0x1930, 0x60070
.long 0x80, 0xe00, 0x1940, 0x61000, 0x90, 0xe10, 0x1950, 0x61010
.long 0xa0, 0xe20, 0x1960, 0x61020, 0xb0, 0xe30, 0x1970, 0x61030
.long 0x300, 0xe40, 0x1980, 0x61040, 0x310, 0xe50, 0x1990, 0x61050
.long 0x320, 0xe60, 0x19a0, 0x61060, 0x330, 0xe70, 0x19b0, 0x61070
.long 0x340, 0xe80, 0x1c00, 0x62000, 0x350, 0xe90, 0x1c10, 0x62010
.long 0x360, 0xea0, 0x1c20, 0x62020, 0x370, 0xeb0, 0x1c30, 0x62030
.long 0x380, 0x1100, 0x1c40, 0x62040, 0x390, 0x1110, 0x1c50, 0x62050
.long 0x3a0, 0x1120, 0x1c60, 0x62060, 0x3b0, 0x1130, 0x1c70, 0x62070
.long 0x600, 0x1140, 0x1c80, 0x63000, 0x610, 0x1150, 0x1c90, 0x63010
.long 0x620, 0x1160, 0x1ca0, 0x63020, 0x630, 0x1170, 0x1cb0, 0x63030
.long 0x640, 0x1180, 0x1f00, 0x63040, 0x650, 0x1190, 0x1f10, 0x63050
.long 0x660, 0x11a0, 0x1f20, 0x63060, 0x670, 0x11b0, 0x1f30, 0x63070
.long 0x680, 0x1400, 0x1f40, 0x64000, 0x690, 0x1410, 0x1f50, 0x64010
.long 0x6a0, 0x1420, 0x1f60, 0x64020, 0x6b0, 0x1430, 0x1f70, 0x64030
.long 0x900, 0x1440, 0x1f80, 0x64040, 0x910, 0x1450, 0x1f90, 0x64050
.long 0x920, 0x1460, 0x1fa0, 0x64060, 0x930, 0x1470, 0x1fb0, 0x64070
.long 0x940, 0x1480, 0x2200, 0x65000, 0x950, 0x1490, 0x2210, 0x65010
.long 0x960, 0x14a0, 0x2220, 0x65020, 0x970, 0x14b0, 0x2230, 0x65030
.long 0x980, 0x1700, 0x2240, 0x65040, 0x990, 0x1710, 0x2250, 0x65050
.long 0x9a0, 0x1720, 0x2260, 0x65060, 0x9b0, 0x1730, 0x2270, 0x65070
.long 0xc00, 0x1740, 0x2280, 0x66000, 0xc10, 0x1750, 0x2290, 0x66010
.long 0xc20, 0x1760, 0x22a0, 0x66020, 0xc30, 0x1770, 0x22b0, 0x66030
.long 0xc40, 0x1780, 0x2500, 0x66040, 0xc50, 0x1790, 0x2510, 0x66050
.long 0xc60, 0x17a0, 0x2520, 0x66060, 0xc70, 0x17b0, 0x2530, 0x66070
.long 0xc80, 0x1a00, 0x2540, 0x67000, 0xc90, 0x1a10, 0x2550, 0x67010
.long 0xca0, 0x1a20, 0x2560, 0x67020, 0xcb0, 0x1a30, 0x2570, 0x67030
.long 0xf00, 0x1a40, 0x2580, 0x67040, 0xf10, 0x1a50, 0x2590, 0x67050
.long 0xf20, 0x1a60, 0x25a0, 0x67060, 0xf30, 0x1a70, 0x25b0, 0x67070
.long 0x0, 0xb40, 0x1680, 0x60000, 0x10, 0xb50, 0x1690, 0x60010
.long 0x20, 0xb60, 0x16a0, 0x60020, 0x30, 0xb70, 0x16b0, 0x60030
.long 0x40, 0xb80, 0x1900, 0x60040, 0x50, 0xb90, 0x1910, 0x60050
.long 0x60, 0xba0, 0x1920, 0x60060, 0x70, 0xbb0, 0x1930, 0x60070
.long 0x80, 0xe00, 0x1940, 0x61000, 0x90, 0xe10, 0x1950, 0x61010
.long 0xa0, 0xe20, 0x1960, 0x61020, 0xb0, 0xe30, 0x1970, 0x61030
.long 0x300, 0xe40, 0x1980, 0x61040, 0x310, 0xe50, 0x1990, 0x61050
.long 0x320, 0xe60, 0x19a0, 0x61060, 0x330, 0xe70, 0x19b0, 0x61070
.long 0x340, 0xe80, 0x1c00, 0x62000, 0x350, 0xe90, 0x1c10, 0x62010
.long 0x360, 0xea0, 0x1c20, 0x62020, 0x370, 0xeb0, 0x1c30, 0x62030
.long 0x380, 0x1100, 0x1c40, 0x62040, 0x390, 0x1110, 0x1c50, 0x62050
.long 0x3a0, 0x1120, 0x1c60, 0x62060, 0x3b0, 0x1130, 0x1c70, 0x62070
.long 0x600, 0x1140, 0x1c80, 0x63000, 0x610, 0x1150, 0x1c90, 0x63010
.long 0x620, 0x1160, 0x1ca0, 0x63020, 0x630, 0x1170, 0x1cb0, 0x63030
.long 0x640, 0x1180, 0x1f00, 0x63040, 0x650, 0x1190, 0x1f10, 0x63050
.long 0x660, 0x11a0, 0x1f20, 0x63060, 0x670, 0x11b0, 0x1f30, 0x63070
.long 0x680, 0x1400, 0x1f40, 0x64000, 0x690, 0x1410, 0x1f50, 0x64010
.long 0x6a0, 0x1420, 0x1f60, 0x64020, 0x6b0, 0x1430, 0x1f70, 0x64030
.long 0x900, 0x1440, 0x1f80, 0x64040, 0x910, 0x1450, 0x1f90, 0x64050
.long 0x920, 0x1460, 0x1fa0, 0x64060, 0x930, 0x1470, 0x1fb0, 0x64070
.long 0x940, 0x1480, 0x2200, 0x65000, 0x950, 0x1490, 0x2210, 0x65010
.long 0x960, 0x14a0, 0x2220, 0x65020, 0x970, 0x14b0, 0x2230, 0x65030
.long 0x980, 0x1700, 0x2240, 0x65040, 0x990, 0x1710, 0x2250, 0x65050
.long 0x9a0, 0x1720, 0x2260, 0x65060, 0x9b0, 0x1730, 0x2270, 0x65070
.long 0xc00, 0x1740, 0x2280, 0x66000, 0xc10, 0x1750, 0x2290, 0x66010
.long 0xc20, 0x1760, 0x22a0, 0x66020, 0xc30, 0x1770, 0x22b0, 0x66030
.long 0xc40, 0x1780, 0x2500, 0x66040, 0xc50, 0x1790, 0x2510, 0x66050
.long 0xc60, 0x17a0, 0x2520, 0x66060, 0xc70, 0x17b0, 0x2530, 0x66070
.long 0xc80, 0x1a00, 0x2540, 0x67000, 0xc90, 0x1a10, 0x2550, 0x67010
.long 0xca0, 0x1a20, 0x2560, 0x67020, 0xcb0, 0x1a30, 0x2570, 0x67030
.long 0xf00, 0x1a40, 0x2580, 0x67040, 0xf10, 0x1a50, 0x2590, 0x67050
.long 0xf20, 0x1a60, 0x25a0, 0x67060, 0xf30, 0x1a70, 0x25b0, 0x67070
.long 0x25300, 0x0, 0x80000000, 0x0, 0x25308, 0x280, 0x80000000, 0x4
.long 0x25310, 0x8, 0x80000000, 0x8, 0x25318, 0x288, 0x80000000, 0xc
.long 0x25320, 0x10, 0x80000000, 0x10, 0x25328, 0x290, 0x80000000, 0x14
.long 0x25330, 0x18, 0x80000000, 0x18, 0x25338, 0x298, 0x80000000, 0x1c
.long 0x25340, 0x20, 0x80000000, 0x20, 0x25348, 0x2a0, 0x80000000, 0x24
.long 0x25350, 0x28, 0x80000000, 0x28, 0x25358, 0x2a8, 0x80000000, 0x2c
.long 0x25360, 0x30, 0x80000000, 0x30, 0x25368, 0x2b0, 0x80000000, 0x34
.long 0x25370, 0x38, 0x80000000, 0x38, 0x25378, 0x2b8, 0x80000000, 0x3c
.long 0x25380, 0x40, 0x80000000, 0x40, 0x25388, 0x2c0, 0x80000000, 0x44
.long 0x25390, 0x48, 0x80000000, 0x48, 0x25398, 0x2c8, 0x80000000, 0x4c
.long 0x253a0, 0x50, 0x80000000, 0x50, 0x253a8, 0x2d0, 0x80000000, 0x54
.long 0x253b0, 0x58, 0x80000000, 0x58, 0x253b8, 0x2d8, 0x80000000, 0x5c
.long 0x253c0, 0x60, 0x80000000, 0x60, 0x253c8, 0x2e0, 0x80000000, 0x64
.long 0x253d0, 0x68, 0x80000000, 0x68, 0x253d8, 0x2e8, 0x80000000, 0x6c
.long 0x253e0, 0x70, 0x80000000, 0x70, 0x253e8, 0x2f0, 0x80000000, 0x74
.long 0x253f0, 0x78, 0x80000000, 0x78, 0x253f8, 0x2f8, 0x80000000, 0x7c
.long 0x25304, 0x80, 0x80000000, 0x80, 0x2530c, 0x200, 0x80000000, 0x84
.long 0x25314, 0x88, 0x80000000, 0x88, 0x2531c, 0x208, 0x80000000, 0x8c
.long 0x25324, 0x90, 0x80000000, 0x90, 0x2532c, 0x210, 0x80000000, 0x94
.long 0x25334, 0x98, 0x80000000, 0x98, 0x2533c, 0x218, 0x80000000, 0x9c
.long 0x25344, 0xa0, 0x80000000, 0xa0, 0x2534c, 0x220, 0x80000000, 0xa4
.long 0x25354, 0xa8, 0x80000000, 0xa8, 0x2535c, 0x228, 0x80000000, 0xac
.long 0x25364, 0xb0, 0x80000000, 0xb0, 0x2536c, 0x230, 0x80000000, 0xb4
.long 0x25374, 0xb8, 0x80000000, 0xb8, 0x2537c, 0x238, 0x80000000, 0xbc
.long 0x25384, 0xc0, 0x80000000, 0xbc, 0x2538c, 0x240, 0x80000000, 0xbc
.long 0x25394, 0xc8, 0x80000000, 0xbc, 0x2539c, 0x248, 0x80000000, 0xbc
.long 0x253a4, 0xd0, 0x80000000, 0xbc, 0x253ac, 0x250, 0x80000000, 0xbc
.long 0x253b4, 0xd8, 0x80000000, 0xbc, 0x253bc, 0x258, 0x80000000, 0xbc
.long 0x253c4, 0xe0, 0x80000000, 0xbc, 0x253cc, 0x260, 0x80000000, 0xbc
.long 0x253d4, 0xe8, 0x80000000, 0xbc, 0x253dc, 0x268, 0x80000000, 0xbc
.long 0x253e4, 0xf0, 0x80000000, 0xbc, 0x253ec, 0x270, 0x80000000, 0xbc
.long 0x253f4, 0xf8, 0x80000000, 0xbc, 0x253fc, 0x278, 0x80000000, 0xbc
.long 0x25600, 0x0, 0x80000000, 0x0, 0x25608, 0x280, 0x80000000, 0x4
.long 0x25610, 0x8, 0x80000000, 0x8, 0x25618, 0x288, 0x80000000, 0xc
.long 0x25620, 0x10, 0x80000000, 0x10, 0x25628, 0x290, 0x80000000, 0x14
.long 0x25630, 0x18, 0x80000000, 0x18, 0x25638, 0x298, 0x80000000, 0x1c
.long 0x25640, 0x20, 0x80000000, 0x20, 0x25648, 0x2a0, 0x80000000, 0x24
.long 0x25650, 0x28, 0x80000000, 0x28, 0x25658, 0x2a8, 0x80000000, 0x2c
.long 0x25660, 0x30, 0x80000000, 0x30, 0x25668, 0x2b0, 0x80000000, 0x34
.long 0x25670, 0x38, 0x80000000, 0x38, 0x25678, 0x2b8, 0x80000000, 0x3c
.long 0x25680, 0x40, 0x80000000, 0x40, 0x25688, 0x2c0, 0x80000000, 0x44
.long 0x25690, 0x48, 0x80000000, 0x48, 0x25698, 0x2c8, 0x80000000, 0x4c
.long 0x256a0, 0x50, 0x80000000, 0x50, 0x256a8, 0x2d0, 0x80000000, 0x54
.long 0x256b0, 0x58, 0x80000000, 0x58, 0x256b8, 0x2d8, 0x80000000, 0x5c
.long 0x256c0, 0x60, 0x80000000, 0x60, 0x256c8, 0x2e0, 0x80000000, 0x64
.long 0x256d0, 0x68, 0x80000000, 0x68, 0x256d8, 0x2e8, 0x80000000, 0x6c
.long 0x256e0, 0x70, 0x80000000, 0x70, 0x256e8, 0x2f0, 0x80000000, 0x74
.long 0x256f0, 0x78, 0x80000000, 0x78, 0x256f8, 0x2f8, 0x80000000, 0x7c
.long 0x25604, 0x80, 0x80000000, 0x80, 0x2560c, 0x200, 0x80000000, 0x84
.long 0x25614, 0x88, 0x80000000, 0x88, 0x2561c, 0x208, 0x80000000, 0x8c
.long 0x25624, 0x90, 0x80000000, 0x90, 0x2562c, 0x210, 0x80000000, 0x94
.long 0x25634, 0x98, 0x80000000, 0x98, 0x2563c, 0x218, 0x80000000, 0x9c
.long 0x25644, 0xa0, 0x80000000, 0xa0, 0x2564c, 0x220, 0x80000000, 0xa4
.long 0x25654, 0xa8, 0x80000000, 0xa8, 0x2565c, 0x228, 0x80000000, 0xac
.long 0x25664, 0xb0, 0x80000000, 0xb0, 0x2566c, 0x230, 0x80000000, 0xb4
.long 0x25674, 0xb8, 0x80000000, 0xb8, 0x2567c, 0x238, 0x80000000, 0xbc
.long 0x25684, 0xc0, 0x80000000, 0xbc, 0x2568c, 0x240, 0x80000000, 0xbc
.long 0x25694, 0xc8, 0x80000000, 0xbc, 0x2569c, 0x248, 0x80000000, 0xbc
.long 0x256a4, 0xd0, 0x80000000, 0xbc, 0x256ac, 0x250, 0x80000000, 0xbc
.long 0x256b4, 0xd8, 0x80000000, 0xbc, 0x256bc, 0x258, 0x80000000, 0xbc
.long 0x256c4, 0xe0, 0x80000000, 0xbc, 0x256cc, 0x260, 0x80000000, 0xbc
.long 0x256d4, 0xe8, 0x80000000, 0xbc, 0x256dc, 0x268, 0x80000000, 0xbc
.long 0x256e4, 0xf0, 0x80000000, 0xbc, 0x256ec, 0x270, 0x80000000, 0xbc
.long 0x256f4, 0xf8, 0x80000000, 0xbc, 0x256fc, 0x278, 0x80000000, 0xbc
.long 0x25900, 0x0, 0x80000000, 0x0, 0x25908, 0x280, 0x80000000, 0x4
.long 0x25910, 0x8, 0x80000000, 0x8, 0x25918, 0x288, 0x80000000, 0xc
.long 0x25920, 0x10, 0x80000000, 0x10, 0x25928, 0x290, 0x80000000, 0x14
.long 0x25930, 0x18, 0x80000000, 0x18, 0x25938, 0x298, 0x80000000, 0x1c
.long 0x25940, 0x20, 0x80000000, 0x20, 0x25948, 0x2a0, 0x80000000, 0x24
.long 0x25950, 0x28, 0x80000000, 0x28, 0x25958, 0x2a8, 0x80000000, 0x2c
.long 0x25960, 0x30, 0x80000000, 0x30, 0x25968, 0x2b0, 0x80000000, 0x34
.long 0x25970, 0x38, 0x80000000, 0x38, 0x25978, 0x2b8, 0x80000000, 0x3c
.long 0x25980, 0x40, 0x80000000, 0x40, 0x25988, 0x2c0, 0x80000000, 0x44
.long 0x25990, 0x48, 0x80000000, 0x48, 0x25998, 0x2c8, 0x80000000, 0x4c
.long 0x259a0, 0x50, 0x80000000, 0x50, 0x259a8, 0x2d0, 0x80000000, 0x54
.long 0x259b0, 0x58, 0x80000000, 0x58, 0x259b8, 0x2d8, 0x80000000, 0x5c
.long 0x259c0, 0x60, 0x80000000, 0x60, 0x259c8, 0x2e0, 0x80000000, 0x64
.long 0x259d0, 0x68, 0x80000000, 0x68, 0x259d8, 0x2e8, 0x80000000, 0x6c
.long 0x259e0, 0x70, 0x80000000, 0x70, 0x259e8, 0x2f0, 0x80000000, 0x74
.long 0x259f0, 0x78, 0x80000000, 0x78, 0x259f8, 0x2f8, 0x80000000, 0x7c
.long 0x25904, 0x80, 0x80000000, 0x80, 0x2590c, 0x200, 0x80000000, 0x84
.long 0x25914, 0x88, 0x80000000, 0x88, 0x2591c, 0x208, 0x80000000, 0x8c
.long 0x25924, 0x90, 0x80000000, 0x90, 0x2592c, 0x210, 0x80000000, 0x94
.long 0x25934, 0x98, 0x80000000, 0x98, 0x2593c, 0x218, 0x80000000, 0x9c
.long 0x25944, 0xa0, 0x80000000, 0xa0, 0x2594c, 0x220, 0x80000000, 0xa4
.long 0x25954, 0xa8, 0x80000000, 0xa8, 0x2595c, 0x228, 0x80000000, 0xac
.long 0x25964, 0xb0, 0x80000000, 0xb0, 0x2596c, 0x230, 0x80000000, 0xb4
.long 0x25974, 0xb8, 0x80000000, 0xb8, 0x2597c, 0x238, 0x80000000, 0xbc
.long 0x25984, 0xc0, 0x80000000, 0xbc, 0x2598c, 0x240, 0x80000000, 0xbc
.long 0x25994, 0xc8, 0x80000000, 0xbc, 0x2599c, 0x248, 0x80000000, 0xbc
.long 0x259a4, 0xd0, 0x80000000, 0xbc, 0x259ac, 0x250, 0x80000000, 0xbc
.long 0x259b4, 0xd8, 0x80000000, 0xbc, 0x259bc, 0x258, 0x80000000, 0xbc
.long 0x259c4, 0xe0, 0x80000000, 0xbc, 0x259cc, 0x260, 0x80000000, 0xbc
.long 0x259d4, 0xe8, 0x80000000, 0xbc, 0x259dc, 0x268, 0x80000000, 0xbc
.long 0x259e4, 0xf0, 0x80000000, 0xbc, 0x259ec, 0x270, 0x80000000, 0xbc
.long 0x259f4, 0xf8, 0x80000000, 0xbc, 0x259fc, 0x278, 0x80000000, 0xbc
.long 0x25c00, 0x0, 0x0, 0x0, 0x25c08, 0x280, 0x80000000, 0x4
.long 0x25c10, 0x8, 0x80000000, 0x8, 0x25c18, 0x288, 0x80000000, 0xc
.long 0x25c20, 0x10, 0x80000000, 0x10, 0x25c28, 0x290, 0x80000000, 0x14
.long 0x25c30, 0x18, 0x80000000, 0x18, 0x25c38, 0x298, 0x80000000, 0x1c
.long 0x25c40, 0x20, 0x80000000, 0x20, 0x25c48, 0x2a0, 0x80000000, 0x24
.long 0x25c50, 0x28, 0x80000000, 0x28, 0x25c58, 0x2a8, 0x80000000, 0x2c
.long 0x25c60, 0x30, 0x80000000, 0x30, 0x25c68, 0x2b0, 0x80000000, 0x34
.long 0x25c70, 0x38, 0x80000000, 0x38, 0x25c78, 0x2b8, 0x80000000, 0x3c
.long 0x25c80, 0x40, 0x80000000, 0x40, 0x25c88, 0x2c0, 0x80000000, 0x44
.long 0x25c90, 0x48, 0x80000000, 0x48, 0x25c98, 0x2c8, 0x80000000, 0x4c
.long 0x25ca0, 0x50, 0x80000000, 0x50, 0x25ca8, 0x2d0, 0x80000000, 0x54
.long 0x25cb0, 0x58, 0x80000000, 0x58, 0x25cb8, 0x2d8, 0x80000000, 0x5c
.long 0x25cc0, 0x60, 0x80000000, 0x60, 0x25cc8, 0x2e0, 0x80000000, 0x64
.long 0x25cd0, 0x68, 0x80000000, 0x68, 0x25cd8, 0x2e8, 0x80000000, 0x6c
.long 0x25ce0, 0x70, 0x80000000, 0x70, 0x25ce8, 0x2f0, 0x80000000, 0x74
.long 0x25cf0, 0x78, 0x80000000, 0x78, 0x25cf8, 0x2f8, 0x80000000, 0x7c
.long 0x25c04, 0x80, 0x80000000, 0x80, 0x25c0c, 0x200, 0x80000000, 0x84
.long 0x25c14, 0x88, 0x80000000, 0x88, 0x25c1c, 0x208, 0x80000000, 0x8c
.long 0x25c24, 0x90, 0x80000000, 0x90, 0x25c2c, 0x210, 0x80000000, 0x94
.long 0x25c34, 0x98, 0x80000000, 0x98, 0x25c3c, 0x218, 0x80000000, 0x9c
.long 0x25c44, 0xa0, 0x80000000, 0xa0, 0x25c4c, 0x220, 0x80000000, 0xa4
.long 0x25c54, 0xa8, 0x80000000, 0xa8, 0x25c5c, 0x228, 0x80000000, 0xac
.long 0x25c64, 0xb0, 0x80000000, 0xb0, 0x25c6c, 0x230, 0x80000000, 0xb4
.long 0x25c74, 0xb8, 0x80000000, 0xb8, 0x25c7c, 0x238, 0x80000000, 0xbc
.long 0x25c84, 0xc0, 0x80000000, 0xbc, 0x25c8c, 0x240, 0x80000000, 0xbc
.long 0x25c94, 0xc8, 0x80000000, 0xbc, 0x25c9c, 0x248, 0x80000000, 0xbc
.long 0x25ca4, 0xd0, 0x80000000, 0xbc, 0x25cac, 0x250, 0x80000000, 0xbc
.long 0x25cb4, 0xd8, 0x80000000, 0xbc, 0x25cbc, 0x258, 0x80000000, 0xbc
.long 0x25cc4, 0xe0, 0x80000000, 0xbc, 0x25ccc, 0x260, 0x80000000, 0xbc
.long 0x25cd4, 0xe8, 0x80000000, 0xbc, 0x25cdc, 0x268, 0x80000000, 0xbc
.long 0x25ce4, 0xf0, 0x80000000, 0xbc, 0x25cec, 0x270, 0x80000000, 0xbc
.long 0x25cf4, 0xf8, 0x80000000, 0xbc, 0x25cfc, 0x278, 0x80000000, 0xbc
.long 0x0, 0xa800, 0x15180, 0x7e900, 0xc0, 0xa8c0, 0x15240, 0x7e9c0
.long 0x180, 0xa980, 0x15300, 0x89100, 0x240, 0xaa40, 0x153c0, 0x891c0
.long 0x300, 0xab00, 0x15480, 0x80000000, 0x3c0, 0xabc0, 0x15540, 0x80000000
.long 0x480, 0xac80, 0x15600, 0x80000000, 0x540, 0xad40, 0x156c0, 0x80000000
.long 0x600, 0xae00, 0x15780, 0x80000000, 0x6c0, 0xaec0, 0x15840, 0x80000000
.long 0x780, 0xaf80, 0x15900, 0x80000000, 0x840, 0xb040, 0x159c0, 0x80000000
.long 0x900, 0xb100, 0x2a000, 0x80000000, 0x9c0, 0xb1c0, 0x2a0c0, 0x80000000
.long 0x15000, 0x1f800, 0x2a180, 0x80000000, 0x150c0, 0x1f8c0, 0x2a240, 0x80000000
.long 0x10, 0xa810, 0x15190, 0x7e910, 0xd0, 0xa8d0, 0x15250, 0x7e9d0
.long 0x190, 0xa990, 0x15310, 0x89110, 0x250, 0xaa50, 0x153d0, 0x891d0
.long 0x310, 0xab10, 0x15490, 0x80000000, 0x3d0, 0xabd0, 0x15550, 0x80000000
.long 0x490, 0xac90, 0x15610, 0x80000000, 0x550, 0xad50, 0x156d0, 0x80000000
.long 0x610, 0xae10, 0x15790, 0x80000000, 0x6d0, 0xaed0, 0x15850, 0x80000000
.long 0x790, 0xaf90, 0x15910, 0x80000000, 0x850, 0xb050, 0x159d0, 0x80000000
.long 0x910, 0xb110, 0x2a010, 0x80000000, 0x9d0, 0xb1d0, 0x2a0d0, 0x80000000
.long 0x15010, 0x1f810, 0x2a190, 0x80000000, 0x150d0, 0x1f8d0, 0x2a250, 0x80000000
.long 0x20, 0xa820, 0x151a0, 0x7e920, 0xe0, 0xa8e0, 0x15260, 0x7e9e0
.long 0x1a0, 0xa9a0, 0x15320, 0x89120, 0x260, 0xaa60, 0x153e0, 0x891e0
.long 0x320, 0xab20, 0x154a0, 0x80000000, 0x3e0, 0xabe0, 0x15560, 0x80000000
.long 0x4a0, 0xaca0, 0x15620, 0x80000000, 0x560, 0xad60, 0x156e0, 0x80000000
.long 0x620, 0xae20, 0x157a0, 0x80000000, 0x6e0, 0xaee0, 0x15860, 0x80000000
.long 0x7a0, 0xafa0, 0x15920, 0x80000000, 0x860, 0xb060, 0x159e0, 0x80000000
.long 0x920, 0xb120, 0x2a020, 0x80000000, 0x9e0, 0xb1e0, 0x2a0e0, 0x80000000
.long 0x15020, 0x1f820, 0x2a1a0, 0x80000000, 0x150e0, 0x1f8e0, 0x2a260, 0x80000000
.long 0x30, 0xa830, 0x151b0, 0x7e930, 0xf0, 0xa8f0, 0x15270, 0x7e9f0
.long 0x1b0, 0xa9b0, 0x15330, 0x89130, 0x270, 0xaa70, 0x153f0, 0x891f0
.long 0x330, 0xab30, 0x154b0, 0x80000000, 0x3f0, 0xabf0, 0x15570, 0x80000000
.long 0x4b0, 0xacb0, 0x15630, 0x80000000, 0x570, 0xad70, 0x156f0, 0x80000000
.long 0x630, 0xae30, 0x157b0, 0x80000000, 0x6f0, 0xaef0, 0x15870, 0x80000000
.long 0x7b0, 0xafb0, 0x15930, 0x80000000, 0x870, 0xb070, 0x159f0, 0x80000000
.long 0x930, 0xb130, 0x2a030, 0x80000000, 0x9f0, 0xb1f0, 0x2a0f0, 0x80000000
.long 0x15030, 0x1f830, 0x2a1b0, 0x80000000, 0x150f0, 0x1f8f0, 0x2a270, 0x80000000
.long 0x1f980, 0x2a300, 0x34b00, 0x80000000, 0x1fa40, 0x2a3c0, 0x34bc0, 0x80000000
.long 0x1fb00, 0x2a480, 0x34c80, 0x80000000, 0x1fbc0, 0x2a540, 0x34d40, 0x80000000
.long 0x1fc80, 0x2a600, 0x34e00, 0x80000000, 0x1fd40, 0x2a6c0, 0x34ec0, 0x80000000
.long 0x1fe00, 0x2a780, 0x34f80, 0x80000000, 0x1fec0, 0x2a840, 0x35040, 0x80000000
.long 0x1ff80, 0x2a900, 0x35100, 0x80000000, 0x20040, 0x2a9c0, 0x351c0, 0x80000000
.long 0x20100, 0x3f000, 0x49800, 0x80000000, 0x201c0, 0x3f0c0, 0x498c0, 0x80000000
.long 0x34800, 0x3f180, 0x49980, 0x80000000, 0x348c0, 0x3f240, 0x49a40, 0x80000000
.long 0x34980, 0x3f300, 0x49b00, 0x80000000, 0x34a40, 0x3f3c0, 0x49bc0, 0x80000000
.long 0x1f990, 0x2a310, 0x34b10, 0x80000000, 0x1fa50, 0x2a3d0, 0x34bd0, 0x80000000
.long 0x1fb10, 0x2a490, 0x34c90, 0x80000000, 0x1fbd0, 0x2a550, 0x34d50, 0x80000000
.long 0x1fc90, 0x2a610, 0x34e10, 0x80000000, 0x1fd50, 0x2a6d0, 0x34ed0, 0x80000000
.long 0x1fe10, 0x2a790, 0x34f90, 0x80000000, 0x1fed0, 0x2a850, 0x35050, 0x80000000
.long 0x1ff90, 0x2a910, 0x35110, 0x80000000, 0x20050, 0x2a9d0, 0x351d0, 0x80000000
.long 0x20110, 0x3f010, 0x49810, 0x80000000, 0x201d0, 0x3f0d0, 0x498d0, 0x80000000
.long 0x34810, 0x3f190, 0x49990, 0x80000000, 0x348d0, 0x3f250, 0x49a50, 0x80000000
.long 0x34990, 0x3f310, 0x49b10, 0x80000000, 0x34a50, 0x3f3d0, 0x49bd0, 0x80000000
.long 0x1f9a0, 0x2a320, 0x34b20, 0x80000000, 0x1fa60, 0x2a3e0, 0x34be0, 0x80000000
.long 0x1fb20, 0x2a4a0, 0x34ca0, 0x80000000, 0x1fbe0, 0x2a560, 0x34d60, 0x80000000
.long 0x1fca0, 0x2a620, 0x34e20, 0x80000000, 0x1fd60, 0x2a6e0, 0x34ee0, 0x80000000
.long 0x1fe20, 0x2a7a0, 0x34fa0, 0x80000000, 0x1fee0, 0x2a860, 0x35060, 0x80000000
.long 0x1ffa0, 0x2a920, 0x35120, 0x80000000, 0x20060, 0x2a9e0, 0x351e0, 0x80000000
.long 0x20120, 0x3f020, 0x49820, 0x80000000, 0x201e0, 0x3f0e0, 0x498e0, 0x80000000
.long 0x34820, 0x3f1a0, 0x499a0, 0x80000000, 0x348e0, 0x3f260, 0x49a60, 0x80000000
.long 0x349a0, 0x3f320, 0x49b20, 0x80000000, 0x34a60, 0x3f3e0, 0x49be0, 0x80000000
.long 0x1f9b0, 0x2a330, 0x34b30, 0x80000000, 0x1fa70, 0x2a3f0, 0x34bf0, 0x80000000
.long 0x1fb30, 0x2a4b0, 0x34cb0, 0x80000000, 0x1fbf0, 0x2a570, 0x34d70, 0x80000000
.long 0x1fcb0, 0x2a630, 0x34e30, 0x80000000, 0x1fd70, 0x2a6f0, 0x34ef0, 0x80000000
.long 0x1fe30, 0x2a7b0, 0x34fb0, 0x80000000, 0x1fef0, 0x2a870, 0x35070, 0x80000000
.long 0x1ffb0, 0x2a930, 0x35130, 0x80000000, 0x20070, 0x2a9f0, 0x351f0, 0x80000000
.long 0x20130, 0x3f030, 0x49830, 0x80000000, 0x201f0, 0x3f0f0, 0x498f0, 0x80000000
.long 0x34830, 0x3f1b0, 0x499b0, 0x80000000, 0x348f0, 0x3f270, 0x49a70, 0x80000000
.long 0x349b0, 0x3f330, 0x49b30, 0x80000000, 0x34a70, 0x3f3f0, 0x49bf0, 0x80000000
.long 0x3f480, 0x49c80, 0x54600, 0x80000000, 0x3f540, 0x49d40, 0x546c0, 0x80000000
.long 0x3f600, 0x49e00, 0x54780, 0x80000000, 0x3f6c0, 0x49ec0, 0x54840, 0x80000000
.long 0x3f780, 0x49f80, 0x54900, 0x80000000, 0x3f840, 0x4a040, 0x549c0, 0x80000000
.long 0x3f900, 0x4a100, 0x69000, 0x80000000, 0x3f9c0, 0x4a1c0, 0x690c0, 0x80000000
.long 0x54000, 0x5e800, 0x69180, 0x80000000, 0x540c0, 0x5e8c0, 0x69240, 0x80000000
.long 0x54180, 0x5e980, 0x69300, 0x80000000, 0x54240, 0x5ea40, 0x693c0, 0x80000000
.long 0x54300, 0x5eb00, 0x69480, 0x80000000, 0x543c0, 0x5ebc0, 0x69540, 0x80000000
.long 0x54480, 0x5ec80, 0x69600, 0x80000000, 0x54540, 0x5ed40, 0x696c0, 0x80000000
.long 0x3f490, 0x49c90, 0x54610, 0x80000000, 0x3f550, 0x49d50, 0x546d0, 0x80000000
.long 0x3f610, 0x49e10, 0x54790, 0x80000000, 0x3f6d0, 0x49ed0, 0x54850, 0x80000000
.long 0x3f790, 0x49f90, 0x54910, 0x80000000, 0x3f850, 0x4a050, 0x549d0, 0x80000000
.long 0x3f910, 0x4a110, 0x69010, 0x80000000, 0x3f9d0, 0x4a1d0, 0x690d0, 0x80000000
.long 0x54010, 0x5e810, 0x69190, 0x80000000, 0x540d0, 0x5e8d0, 0x69250, 0x80000000
.long 0x54190, 0x5e990, 0x69310, 0x80000000, 0x54250, 0x5ea50, 0x693d0, 0x80000000
.long 0x54310, 0x5eb10, 0x69490, 0x80000000, 0x543d0, 0x5ebd0, 0x69550, 0x80000000
.long 0x54490, 0x5ec90, 0x69610, 0x80000000, 0x54550, 0x5ed50, 0x696d0, 0x80000000
.long 0x3f4a0, 0x49ca0, 0x54620, 0x80000000, 0x3f560, 0x49d60, 0x546e0, 0x80000000
.long 0x3f620, 0x49e20, 0x547a0, 0x80000000, 0x3f6e0, 0x49ee0, 0x54860, 0x80000000
.long 0x3f7a0, 0x49fa0, 0x54920, 0x80000000, 0x3f860, 0x4a060, 0x549e0, 0x80000000
.long 0x3f920, 0x4a120, 0x69020, 0x80000000, 0x3f9e0, 0x4a1e0, 0x690e0, 0x80000000
.long 0x54020, 0x5e820, 0x691a0, 0x80000000, 0x540e0, 0x5e8e0, 0x69260, 0x80000000
.long 0x541a0, 0x5e9a0, 0x69320, 0x80000000, 0x54260, 0x5ea60, 0x693e0, 0x80000000
.long 0x54320, 0x5eb20, 0x694a0, 0x80000000, 0x543e0, 0x5ebe0, 0x69560, 0x80000000
.long 0x544a0, 0x5eca0, 0x69620, 0x80000000, 0x54560, 0x5ed60, 0x696e0, 0x80000000
.long 0x3f4b0, 0x49cb0, 0x54630, 0x80000000, 0x3f570, 0x49d70, 0x546f0, 0x80000000
.long 0x3f630, 0x49e30, 0x547b0, 0x80000000, 0x3f6f0, 0x49ef0, 0x54870, 0x80000000
.long 0x3f7b0, 0x49fb0, 0x54930, 0x80000000, 0x3f870, 0x4a070, 0x549f0, 0x80000000
.long 0x3f930, 0x4a130, 0x69030, 0x80000000, 0x3f9f0, 0x4a1f0, 0x690f0, 0x80000000
.long 0x54030, 0x5e830, 0x691b0, 0x80000000, 0x540f0, 0x5e8f0, 0x69270, 0x80000000
.long 0x541b0, 0x5e9b0, 0x69330, 0x80000000, 0x54270, 0x5ea70, 0x693f0, 0x80000000
.long 0x54330, 0x5eb30, 0x694b0, 0x80000000, 0x543f0, 0x5ebf0, 0x69570, 0x80000000
.long 0x544b0, 0x5ecb0, 0x69630, 0x80000000, 0x54570, 0x5ed70, 0x696f0, 0x80000000
.long 0x5ee00, 0x69780, 0x73f80, 0x80000000, 0x5eec0, 0x69840, 0x74040, 0x80000000
.long 0x5ef80, 0x69900, 0x74100, 0x80000000, 0x5f040, 0x699c0, 0x741c0, 0x80000000
.long 0x5f100, 0x7e000, 0x88800, 0x80000000, 0x5f1c0, 0x7e0c0, 0x888c0, 0x80000000
.long 0x73800, 0x7e180, 0x88980, 0x80000000, 0x738c0, 0x7e240, 0x88a40, 0x80000000
.long 0x73980, 0x7e300, 0x88b00, 0x80000000, 0x73a40, 0x7e3c0, 0x88bc0, 0x80000000
.long 0x73b00, 0x7e480, 0x88c80, 0x80000000, 0x73bc0, 0x7e540, 0x88d40, 0x80000000
.long 0x73c80, 0x7e600, 0x88e00, 0x80000000, 0x73d40, 0x7e6c0, 0x88ec0, 0x80000000
.long 0x73e00, 0x7e780, 0x88f80, 0x80000000, 0x73ec0, 0x7e840, 0x89040, 0x80000000
.long 0x5ee10, 0x69790, 0x73f90, 0x80000000, 0x5eed0, 0x69850, 0x74050, 0x80000000
.long 0x5ef90, 0x69910, 0x74110, 0x80000000, 0x5f050, 0x699d0, 0x741d0, 0x80000000
.long 0x5f110, 0x7e010, 0x88810, 0x80000000, 0x5f1d0, 0x7e0d0, 0x888d0, 0x80000000
.long 0x73810, 0x7e190, 0x88990, 0x80000000, 0x738d0, 0x7e250, 0x88a50, 0x80000000
.long 0x73990, 0x7e310, 0x88b10, 0x80000000, 0x73a50, 0x7e3d0, 0x88bd0, 0x80000000
.long 0x73b10, 0x7e490, 0x88c90, 0x80000000, 0x73bd0, 0x7e550, 0x88d50, 0x80000000
.long 0x73c90, 0x7e610, 0x88e10, 0x80000000, 0x73d50, 0x7e6d0, 0x88ed0, 0x80000000
.long 0x73e10, 0x7e790, 0x88f90, 0x80000000, 0x73ed0, 0x7e850, 0x89050, 0x80000000
.long 0x5ee20, 0x697a0, 0x73fa0, 0x80000000, 0x5eee0, 0x69860, 0x74060, 0x80000000
.long 0x5efa0, 0x69920, 0x74120, 0x80000000, 0x5f060, 0x699e0, 0x741e0, 0x80000000
.long 0x5f120, 0x7e020, 0x88820, 0x80000000, 0x5f1e0, 0x7e0e0, 0x888e0, 0x80000000
.long 0x73820, 0x7e1a0, 0x889a0, 0x80000000, 0x738e0, 0x7e260, 0x88a60, 0x80000000
.long 0x739a0, 0x7e320, 0x88b20, 0x80000000, 0x73a60, 0x7e3e0, 0x88be0, 0x80000000
.long 0x73b20, 0x7e4a0, 0x88ca0, 0x80000000, 0x73be0, 0x7e560, 0x88d60, 0x80000000
.long 0x73ca0, 0x7e620, 0x88e20, 0x80000000, 0x73d60, 0x7e6e0, 0x88ee0, 0x80000000
.long 0x73e20, 0x7e7a0, 0x88fa0, 0x80000000, 0x73ee0, 0x7e860, 0x89060, 0x80000000
.long 0x5ee30, 0x697b0, 0x73fb0, 0x80000000, 0x5eef0, 0x69870, 0x74070, 0x80000000
.long 0x5efb0, 0x69930, 0x74130, 0x80000000, 0x5f070, 0x699f0, 0x741f0, 0x80000000
.long 0x5f130, 0x7e030, 0x88830, 0x80000000, 0x5f1f0, 0x7e0f0, 0x888f0, 0x80000000
.long 0x73830, 0x7e1b0, 0x889b0, 0x80000000, 0x738f0, 0x7e270, 0x88a70, 0x80000000
.long 0x739b0, 0x7e330, 0x88b30, 0x80000000, 0x73a70, 0x7e3f0, 0x88bf0, 0x80000000
.long 0x73b30, 0x7e4b0, 0x88cb0, 0x80000000, 0x73bf0, 0x7e570, 0x88d70, 0x80000000
.long 0x73cb0, 0x7e630, 0x88e30, 0x80000000, 0x73d70, 0x7e6f0, 0x88ef0, 0x80000000
.long 0x73e30, 0x7e7b0, 0x88fb0, 0x80000000, 0x73ef0, 0x7e870, 0x89070, 0x80000000
.long 0x0, 0x3f80, 0x0, 0x0, 0x10, 0x3f800000, 0x0, 0x10
.long 0x20, 0x0, 0x3f80, 0x20, 0x30, 0x0, 0x3f800000, 0x30
.long 0xc0, 0x0, 0x0, 0x40, 0xd0, 0x0, 0x0, 0x50
.long 0xe0, 0x0, 0x0, 0x60, 0xf0, 0x0, 0x0, 0x70
.long 0x180, 0x0, 0x0, 0x80, 0x190, 0x0, 0x0, 0x90
.long 0x1a0, 0x0, 0x0, 0xa0, 0x1b0, 0x0, 0x0, 0xb0
.long 0x240, 0x0, 0x0, 0xc0, 0x250, 0x0, 0x0, 0xd0
.long 0x260, 0x0, 0x0, 0xe0, 0x270, 0x0, 0x0, 0xf0
.long 0x300, 0x0, 0x0, 0x100, 0x310, 0x0, 0x0, 0x110
.long 0x320, 0x0, 0x0, 0x120, 0x330, 0x0, 0x0, 0x130
.long 0x3c0, 0x3f80, 0x0, 0x140, 0x3d0, 0x3f800000, 0x0, 0x150
.long 0x3e0, 0x0, 0x3f80, 0x160, 0x3f0, 0x0, 0x3f800000, 0x170
.long 0x480, 0x0, 0x0, 0x180, 0x490, 0x0, 0x0, 0x190
.long 0x4a0, 0x0, 0x0, 0x1a0, 0x4b0, 0x0, 0x0, 0x1b0
.long 0x540, 0x0, 0x0, 0x1c0, 0x550, 0x0, 0x0, 0x1d0
.long 0x560, 0x0, 0x0, 0x1e0, 0x570, 0x0, 0x0, 0x1f0
.long 0x600, 0x0, 0x0, 0x280, 0x610, 0x0, 0x0, 0x290
.long 0x620, 0x0, 0x0, 0x2a0, 0x630, 0x0, 0x0, 0x2b0
.long 0x6c0, 0x0, 0x0, 0x2c0, 0x6d0, 0x0, 0x0, 0x2d0
.long 0x6e0, 0x0, 0x0, 0x2e0, 0x6f0, 0x0, 0x0, 0x2f0
.long 0x780, 0x3f80, 0x0, 0x200, 0x790, 0x3f800000, 0x0, 0x210
.long 0x7a0, 0x0, 0x3f80, 0x220, 0x7b0, 0x0, 0x3f800000, 0x230
.long 0x840, 0x0, 0x0, 0x240, 0x850, 0x0, 0x0, 0x250
.long 0x860, 0x0, 0x0, 0x260, 0x870, 0x0, 0x0, 0x270
.long 0x900, 0x0, 0x0, 0x380, 0x910, 0x0, 0x0, 0x390
.long 0x920, 0x0, 0x0, 0x3a0, 0x930, 0x0, 0x0, 0x3b0
.long 0x9c0, 0x0, 0x0, 0x3c0, 0x9d0, 0x0, 0x0, 0x3d0
.long 0x9e0, 0x0, 0x0, 0x3e0, 0x9f0, 0x0, 0x0, 0x3f0
.long 0xa80, 0x0, 0x0, 0x300, 0xa90, 0x0, 0x0, 0x310
.long 0xaa0, 0x0, 0x0, 0x320, 0xab0, 0x0, 0x0, 0x330
.long 0xb40, 0x3f80, 0x0, 0x340, 0xb50, 0x3f800000, 0x0, 0x350
.long 0xb60, 0x0, 0x3f80, 0x360, 0xb70, 0x0, 0x3f800000, 0x370
.long 0x4800, 0x3f80, 0x0, 0x3000, 0x4810, 0x3f800000, 0x0, 0x3010
.long 0x4820, 0x0, 0x3f80, 0x3020, 0x4830, 0x0, 0x3f800000, 0x3030
.long 0x48c0, 0x0, 0x0, 0x3040, 0x48d0, 0x0, 0x0, 0x3050
.long 0x48e0, 0x0, 0x0, 0x3060, 0x48f0, 0x0, 0x0, 0x3070
.long 0x4980, 0x0, 0x0, 0x3080, 0x4990, 0x0, 0x0, 0x3090
.long 0x49a0, 0x0, 0x0, 0x30a0, 0x49b0, 0x0, 0x0, 0x30b0
.long 0x4a40, 0x0, 0x0, 0x30c0, 0x4a50, 0x0, 0x0, 0x30d0
.long 0x4a60, 0x0, 0x0, 0x30e0, 0x4a70, 0x0, 0x0, 0x30f0
.long 0x4b00, 0x0, 0x0, 0x3100, 0x4b10, 0x0, 0x0, 0x3110
.long 0x4b20, 0x0, 0x0, 0x3120, 0x4b30, 0x0, 0x0, 0x3130
.long 0x4bc0, 0x3f80, 0x0, 0x3140, 0x4bd0, 0x3f800000, 0x0, 0x3150
.long 0x4be0, 0x0, 0x3f80, 0x3160, 0x4bf0, 0x0, 0x3f800000, 0x3170
.long 0x4c80, 0x0, 0x0, 0x3180, 0x4c90, 0x0, 0x0, 0x3190
.long 0x4ca0, 0x0, 0x0, 0x31a0, 0x4cb0, 0x0, 0x0, 0x31b0
.long 0x4d40, 0x0, 0x0, 0x31c0, 0x4d50, 0x0, 0x0, 0x31d0
.long 0x4d60, 0x0, 0x0, 0x31e0, 0x4d70, 0x0, 0x0, 0x31f0
.long 0x4e00, 0x0, 0x0, 0x3280, 0x4e10, 0x0, 0x0, 0x3290
.long 0x4e20, 0x0, 0x0, 0x32a0, 0x4e30, 0x0, 0x0, 0x32b0
.long 0x4ec0, 0x0, 0x0, 0x32c0, 0x4ed0, 0x0, 0x0, 0x32d0
.long 0x4ee0, 0x0, 0x0, 0x32e0, 0x4ef0, 0x0, 0x0, 0x32f0
.long 0x4f80, 0x3f80, 0x0, 0x3200, 0x4f90, 0x3f800000, 0x0, 0x3210
.long 0x4fa0, 0x0, 0x3f80, 0x3220, 0x4fb0, 0x0, 0x3f800000, 0x3230
.long 0x5040, 0x0, 0x0, 0x3240, 0x5050, 0x0, 0x0, 0x3250
.long 0x5060, 0x0, 0x0, 0x3260, 0x5070, 0x0, 0x0, 0x3270
.long 0x5100, 0x0, 0x0, 0x3380, 0x5110, 0x0, 0x0, 0x3390
.long 0x5120, 0x0, 0x0, 0x33a0, 0x5130, 0x0, 0x0, 0x33b0
.long 0x51c0, 0x0, 0x0, 0x33c0, 0x51d0, 0x0, 0x0, 0x33d0
.long 0x51e0, 0x0, 0x0, 0x33e0, 0x51f0, 0x0, 0x0, 0x33f0
.long 0x5280, 0x0, 0x0, 0x3300, 0x5290, 0x0, 0x0, 0x3310
.long 0x52a0, 0x0, 0x0, 0x3320, 0x52b0, 0x0, 0x0, 0x3330
.long 0x5340, 0x3f80, 0x0, 0x3340, 0x5350, 0x3f800000, 0x0, 0x3350
.long 0x5360, 0x0, 0x3f80, 0x3360, 0x5370, 0x0, 0x3f800000, 0x3370
.long 0x9000, 0x3f80, 0x0, 0x6000, 0x9010, 0x3f800000, 0x0, 0x6010
.long 0x9020, 0x0, 0x3f80, 0x6020, 0x9030, 0x0, 0x3f800000, 0x6030
.long 0x90c0, 0x0, 0x0, 0x6040, 0x90d0, 0x0, 0x0, 0x6050
.long 0x90e0, 0x0, 0x0, 0x6060, 0x90f0, 0x0, 0x0, 0x6070
.long 0x9180, 0x0, 0x0, 0x6080, 0x9190, 0x0, 0x0, 0x6090
.long 0x91a0, 0x0, 0x0, 0x60a0, 0x91b0, 0x0, 0x0, 0x60b0
.long 0x9240, 0x0, 0x0, 0x60c0, 0x9250, 0x0, 0x0, 0x60d0
.long 0x9260, 0x0, 0x0, 0x60e0, 0x9270, 0x0, 0x0, 0x60f0
.long 0x9300, 0x0, 0x0, 0x6100, 0x9310, 0x0, 0x0, 0x6110
.long 0x9320, 0x0, 0x0, 0x6120, 0x9330, 0x0, 0x0, 0x6130
.long 0x93c0, 0x3f80, 0x0, 0x6140, 0x93d0, 0x3f800000, 0x0, 0x6150
.long 0x93e0, 0x0, 0x3f80, 0x6160, 0x93f0, 0x0, 0x3f800000, 0x6170
.long 0x9480, 0x0, 0x0, 0x6180, 0x9490, 0x0, 0x0, 0x6190
.long 0x94a0, 0x0, 0x0, 0x61a0, 0x94b0, 0x0, 0x0, 0x61b0
.long 0x9540, 0x0, 0x0, 0x61c0, 0x9550, 0x0, 0x0, 0x61d0
.long 0x9560, 0x0, 0x0, 0x61e0, 0x9570, 0x0, 0x0, 0x61f0
.long 0x9600, 0x0, 0x0, 0x6280, 0x9610, 0x0, 0x0, 0x6290
.long 0x9620, 0x0, 0x0, 0x62a0, 0x9630, 0x0, 0x0, 0x62b0
.long 0x96c0, 0x0, 0x0, 0x62c0, 0x96d0, 0x0, 0x0, 0x62d0
.long 0x96e0, 0x0, 0x0, 0x62e0, 0x96f0, 0x0, 0x0, 0x62f0
.long 0x9780, 0x3f80, 0x0, 0x6200, 0x9790, 0x3f800000, 0x0, 0x6210
.long 0x97a0, 0x0, 0x3f80, 0x6220, 0x97b0, 0x0, 0x3f800000, 0x6230
.long 0x9840, 0x0, 0x0, 0x6240, 0x9850, 0x0, 0x0, 0x6250
.long 0x9860, 0x0, 0x0, 0x6260, 0x9870, 0x0, 0x0, 0x6270
.long 0x9900, 0x0, 0x0, 0x6380, 0x9910, 0x0, 0x0, 0x6390
.long 0x9920, 0x0, 0x0, 0x63a0, 0x9930, 0x0, 0x0, 0x63b0
.long 0x99c0, 0x0, 0x0, 0x63c0, 0x99d0, 0x0, 0x0, 0x63d0
.long 0x99e0, 0x0, 0x0, 0x63e0, 0x99f0, 0x0, 0x0, 0x63f0
.long 0x9a80, 0x0, 0x0, 0x6300, 0x9a90, 0x0, 0x0, 0x6310
.long 0x9aa0, 0x0, 0x0, 0x6320, 0x9ab0, 0x0, 0x0, 0x6330
.long 0x9b40, 0x3f80, 0x0, 0x6340, 0x9b50, 0x3f800000, 0x0, 0x6350
.long 0x9b60, 0x0, 0x3f80, 0x6360, 0x9b70, 0x0, 0x3f800000, 0x6370
.long 0xd800, 0x3f80, 0x0, 0x9000, 0xd810, 0x3f800000, 0x0, 0x9010
.long 0xd820, 0x0, 0x3f80, 0x9020, 0xd830, 0x0, 0x3f800000, 0x9030
.long 0xd8c0, 0x0, 0x0, 0x9040, 0xd8d0, 0x0, 0x0, 0x9050
.long 0xd8e0, 0x0, 0x0, 0x9060, 0xd8f0, 0x0, 0x0, 0x9070
.long 0xd980, 0x0, 0x0, 0x9080, 0xd990, 0x0, 0x0, 0x9090
.long 0xd9a0, 0x0, 0x0, 0x90a0, 0xd9b0, 0x0, 0x0, 0x90b0
.long 0xda40, 0x0, 0x0, 0x90c0, 0xda50, 0x0, 0x0, 0x90d0
.long 0xda60, 0x0, 0x0, 0x90e0, 0xda70, 0x0, 0x0, 0x90f0
.long 0xdb00, 0x0, 0x0, 0x9100, 0xdb10, 0x0, 0x0, 0x9110
.long 0xdb20, 0x0, 0x0, 0x9120, 0xdb30, 0x0, 0x0, 0x9130
.long 0xdbc0, 0x3f80, 0x0, 0x9140, 0xdbd0, 0x3f800000, 0x0, 0x9150
.long 0xdbe0, 0x0, 0x3f80, 0x9160, 0xdbf0, 0x0, 0x3f800000, 0x9170
.long 0xdc80, 0x0, 0x0, 0x9180, 0xdc90, 0x0, 0x0, 0x9190
.long 0xdca0, 0x0, 0x0, 0x91a0, 0xdcb0, 0x0, 0x0, 0x91b0
.long 0xdd40, 0x0, 0x0, 0x91c0, 0xdd50, 0x0, 0x0, 0x91d0
.long 0xdd60, 0x0, 0x0, 0x91e0, 0xdd70, 0x0, 0x0, 0x91f0
.long 0xde00, 0x0, 0x0, 0x9280, 0xde10, 0x0, 0x0, 0x9290
.long 0xde20, 0x0, 0x0, 0x92a0, 0xde30, 0x0, 0x0, 0x92b0
.long 0xdec0, 0x0, 0x0, 0x92c0, 0xded0, 0x0, 0x0, 0x92d0
.long 0xdee0, 0x0, 0x0, 0x92e0, 0xdef0, 0x0, 0x0, 0x92f0
.long 0xdf80, 0x3f80, 0x0, 0x9200, 0xdf90, 0x3f800000, 0x0, 0x9210
.long 0xdfa0, 0x0, 0x3f80, 0x9220, 0xdfb0, 0x0, 0x3f800000, 0x9230
.long 0xe040, 0x0, 0x0, 0x9240, 0xe050, 0x0, 0x0, 0x9250
.long 0xe060, 0x0, 0x0, 0x9260, 0xe070, 0x0, 0x0, 0x9270
.long 0xe100, 0x0, 0x0, 0x9380, 0xe110, 0x0, 0x0, 0x9390
.long 0xe120, 0x0, 0x0, 0x93a0, 0xe130, 0x0, 0x0, 0x93b0
.long 0xe1c0, 0x0, 0x0, 0x93c0, 0xe1d0, 0x0, 0x0, 0x93d0
.long 0xe1e0, 0x0, 0x0, 0x93e0, 0xe1f0, 0x0, 0x0, 0x93f0
.long 0xe280, 0x0, 0x0, 0x9300, 0xe290, 0x0, 0x0, 0x9310
.long 0xe2a0, 0x0, 0x0, 0x9320, 0xe2b0, 0x0, 0x0, 0x9330
.long 0xe340, 0x3f80, 0x0, 0x9340, 0xe350, 0x3f800000, 0x0, 0x9350
.long 0xe360, 0x0, 0x3f80, 0x9360, 0xe370, 0x0, 0x3f800000, 0x9370
.long 0x68000, 0x0, 0x40, 0x25300, 0x68000, 0x0, 0xc0, 0x26500
.long 0x68000, 0x0, 0x140, 0x26500, 0x68000, 0x0, 0x1c0, 0x26500
.long 0x68000, 0x0, 0x240, 0x25308, 0x68000, 0x0, 0x2c0, 0x26500
.long 0x68000, 0x0, 0x340, 0x26500, 0x68000, 0x0, 0x3c0, 0x26500
.long 0x68000, 0x0, 0x440, 0x25310, 0x68000, 0x0, 0x4c0, 0x26500
.long 0x68000, 0x0, 0x540, 0x26500, 0x68000, 0x0, 0x5c0, 0x26500
.long 0x68000, 0x0, 0x80000000, 0x25318, 0x68000, 0x0, 0x80000000, 0x26500
.long 0x68000, 0x0, 0x80000000, 0x26500, 0x68000, 0x0, 0x80000000, 0x26500
.long 0x68020, 0x10, 0x40, 0x25320, 0x68020, 0x10, 0xc0, 0x26500
.long 0x68020, 0x10, 0x140, 0x26500, 0x68020, 0x10, 0x1c0, 0x26500
.long 0x68020, 0x10, 0x240, 0x25328, 0x68020, 0x10, 0x2c0, 0x26500
.long 0x68020, 0x10, 0x340, 0x26500, 0x68020, 0x10, 0x3c0, 0x26500
.long 0x68020, 0x10, 0x440, 0x25330, 0x68020, 0x10, 0x4c0, 0x26500
.long 0x68020, 0x10, 0x540, 0x26500, 0x68020, 0x10, 0x5c0, 0x26500
.long 0x68020, 0x10, 0x80000000, 0x25338, 0x68020, 0x10, 0x80000000, 0x26500
.long 0x68020, 0x10, 0x80000000, 0x26500, 0x68020, 0x10, 0x80000000, 0x26500
.long 0x68040, 0x20, 0x40, 0x25340, 0x68040, 0x20, 0xc0, 0x26500
.long 0x68040, 0x20, 0x140, 0x26500, 0x68040, 0x20, 0x1c0, 0x26500
.long 0x68040, 0x20, 0x240, 0x25348, 0x68040, 0x20, 0x2c0, 0x26500
.long 0x68040, 0x20, 0x340, 0x26500, 0x68040, 0x20, 0x3c0, 0x26500
.long 0x68040, 0x20, 0x440, 0x25350, 0x68040, 0x20, 0x4c0, 0x26500
.long 0x68040, 0x20, 0x540, 0x26500, 0x68040, 0x20, 0x5c0, 0x26500
.long 0x68040, 0x20, 0x80000000, 0x25358, 0x68040, 0x20, 0x80000000, 0x26500
.long 0x68040, 0x20, 0x80000000, 0x26500, 0x68040, 0x20, 0x80000000, 0x26500
.long 0x68060, 0x30, 0x40, 0x25360, 0x68060, 0x30, 0xc0, 0x26500
.long 0x68060, 0x30, 0x140, 0x26500, 0x68060, 0x30, 0x1c0, 0x26500
.long 0x68060, 0x30, 0x240, 0x25368, 0x68060, 0x30, 0x2c0, 0x26500
.long 0x68060, 0x30, 0x340, 0x26500, 0x68060, 0x30, 0x3c0, 0x26500
.long 0x68060, 0x30, 0x440, 0x25370, 0x68060, 0x30, 0x4c0, 0x26500
.long 0x68060, 0x30, 0x540, 0x26500, 0x68060, 0x30, 0x5c0, 0x26500
.long 0x68060, 0x30, 0x80000000, 0x25378, 0x68060, 0x30, 0x80000000, 0x26500
.long 0x68060, 0x30, 0x80000000, 0x26500, 0x68060, 0x30, 0x80000000, 0x26500
.long 0x68000, 0x300, 0x40, 0x25600, 0x68000, 0x300, 0xc0, 0x26500
.long 0x68000, 0x300, 0x140, 0x26500, 0x68000, 0x300, 0x1c0, 0x26500
.long 0x68000, 0x300, 0x240, 0x25608, 0x68000, 0x300, 0x2c0, 0x26500
.long 0x68000, 0x300, 0x340, 0x26500, 0x68000, 0x300, 0x3c0, 0x26500
.long 0x68000, 0x300, 0x440, 0x25610, 0x68000, 0x300, 0x4c0, 0x26500
.long 0x68000, 0x300, 0x540, 0x26500, 0x68000, 0x300, 0x5c0, 0x26500
.long 0x68000, 0x300, 0x80000000, 0x25618, 0x68000, 0x300, 0x80000000, 0x26500
.long 0x68000, 0x300, 0x80000000, 0x26500, 0x68000, 0x300, 0x80000000, 0x26500
.long 0x68020, 0x310, 0x40, 0x25620, 0x68020, 0x310, 0xc0, 0x26500
.long 0x68020, 0x310, 0x140, 0x26500, 0x68020, 0x310, 0x1c0, 0x26500
.long 0x68020, 0x310, 0x240, 0x25628, 0x68020, 0x310, 0x2c0, 0x26500
.long 0x68020, 0x310, 0x340, 0x26500, 0x68020, 0x310, 0x3c0, 0x26500
.long 0x68020, 0x310, 0x440, 0x25630, 0x68020, 0x310, 0x4c0, 0x26500
.long 0x68020, 0x310, 0x540, 0x26500, 0x68020, 0x310, 0x5c0, 0x26500
.long 0x68020, 0x310, 0x80000000, 0x25638, 0x68020, 0x310, 0x80000000, 0x26500
.long 0x68020, 0x310, 0x80000000, 0x26500, 0x68020, 0x310, 0x80000000, 0x26500
.long 0x68040, 0x320, 0x40, 0x25640, 0x68040, 0x320, 0xc0, 0x26500
.long 0x68040, 0x320, 0x140, 0x26500, 0x68040, 0x320, 0x1c0, 0x26500
.long 0x68040, 0x320, 0x240, 0x25648, 0x68040, 0x320, 0x2c0, 0x26500
.long 0x68040, 0x320, 0x340, 0x26500, 0x68040, 0x320, 0x3c0, 0x26500
.long 0x68040, 0x320, 0x440, 0x25650, 0x68040, 0x320, 0x4c0, 0x26500
.long 0x68040, 0x320, 0x540, 0x26500, 0x68040, 0x320, 0x5c0, 0x26500
.long 0x68040, 0x320, 0x80000000, 0x25658, 0x68040, 0x320, 0x80000000, 0x26500
.long 0x68040, 0x320, 0x80000000, 0x26500, 0x68040, 0x320, 0x80000000, 0x26500
.long 0x68060, 0x330, 0x40, 0x25660, 0x68060, 0x330, 0xc0, 0x26500
.long 0x68060, 0x330, 0x140, 0x26500, 0x68060, 0x330, 0x1c0, 0x26500
.long 0x68060, 0x330, 0x240, 0x25668, 0x68060, 0x330, 0x2c0, 0x26500
.long 0x68060, 0x330, 0x340, 0x26500, 0x68060, 0x330, 0x3c0, 0x26500
.long 0x68060, 0x330, 0x440, 0x25670, 0x68060, 0x330, 0x4c0, 0x26500
.long 0x68060, 0x330, 0x540, 0x26500, 0x68060, 0x330, 0x5c0, 0x26500
.long 0x68060, 0x330, 0x80000000, 0x25678, 0x68060, 0x330, 0x80000000, 0x26500
.long 0x68060, 0x330, 0x80000000, 0x26500, 0x68060, 0x330, 0x80000000, 0x26500
.long 0x68000, 0x600, 0x40, 0x25900, 0x68000, 0x600, 0xc0, 0x26500
.long 0x68000, 0x600, 0x140, 0x26500, 0x68000, 0x600, 0x1c0, 0x26500
.long 0x68000, 0x600, 0x240, 0x25908, 0x68000, 0x600, 0x2c0, 0x26500
.long 0x68000, 0x600, 0x340, 0x26500, 0x68000, 0x600, 0x3c0, 0x26500
.long 0x68000, 0x600, 0x440, 0x25910, 0x68000, 0x600, 0x4c0, 0x26500
.long 0x68000, 0x600, 0x540, 0x26500, 0x68000, 0x600, 0x5c0, 0x26500
.long 0x68000, 0x600, 0x80000000, 0x25918, 0x68000, 0x600, 0x80000000, 0x26500
.long 0x68000, 0x600, 0x80000000, 0x26500, 0x68000, 0x600, 0x80000000, 0x26500
.long 0x68020, 0x610, 0x40, 0x25920, 0x68020, 0x610, 0xc0, 0x26500
.long 0x68020, 0x610, 0x140, 0x26500, 0x68020, 0x610, 0x1c0, 0x26500
.long 0x68020, 0x610, 0x240, 0x25928, 0x68020, 0x610, 0x2c0, 0x26500
.long 0x68020, 0x610, 0x340, 0x26500, 0x68020, 0x610, 0x3c0, 0x26500
.long 0x68020, 0x610, 0x440, 0x25930, 0x68020, 0x610, 0x4c0, 0x26500
.long 0x68020, 0x610, 0x540, 0x26500, 0x68020, 0x610, 0x5c0, 0x26500
.long 0x68020, 0x610, 0x80000000, 0x25938, 0x68020, 0x610, 0x80000000, 0x26500
.long 0x68020, 0x610, 0x80000000, 0x26500, 0x68020, 0x610, 0x80000000, 0x26500
.long 0x68040, 0x620, 0x40, 0x25940, 0x68040, 0x620, 0xc0, 0x26500
.long 0x68040, 0x620, 0x140, 0x26500, 0x68040, 0x620, 0x1c0, 0x26500
.long 0x68040, 0x620, 0x240, 0x25948, 0x68040, 0x620, 0x2c0, 0x26500
.long 0x68040, 0x620, 0x340, 0x26500, 0x68040, 0x620, 0x3c0, 0x26500
.long 0x68040, 0x620, 0x440, 0x25950, 0x68040, 0x620, 0x4c0, 0x26500
.long 0x68040, 0x620, 0x540, 0x26500, 0x68040, 0x620, 0x5c0, 0x26500
.long 0x68040, 0x620, 0x80000000, 0x25958, 0x68040, 0x620, 0x80000000, 0x26500
.long 0x68040, 0x620, 0x80000000, 0x26500, 0x68040, 0x620, 0x80000000, 0x26500
.long 0x68060, 0x630, 0x40, 0x25960, 0x68060, 0x630, 0xc0, 0x26500
.long 0x68060, 0x630, 0x140, 0x26500, 0x68060, 0x630, 0x1c0, 0x26500
.long 0x68060, 0x630, 0x240, 0x25968, 0x68060, 0x630, 0x2c0, 0x26500
.long 0x68060, 0x630, 0x340, 0x26500, 0x68060, 0x630, 0x3c0, 0x26500
.long 0x68060, 0x630, 0x440, 0x25970, 0x68060, 0x630, 0x4c0, 0x26500
.long 0x68060, 0x630, 0x540, 0x26500, 0x68060, 0x630, 0x5c0, 0x26500
.long 0x68060, 0x630, 0x80000000, 0x25978, 0x68060, 0x630, 0x80000000, 0x26500
.long 0x68060, 0x630, 0x80000000, 0x26500, 0x68060, 0x630, 0x80000000, 0x26500
.long 0x68000, 0x900, 0x40, 0x25c00, 0x68000, 0x900, 0xc0, 0x26500
.long 0x68000, 0x900, 0x140, 0x26500, 0x68000, 0x900, 0x1c0, 0x26500
.long 0x68000, 0x900, 0x240, 0x25c08, 0x68000, 0x900, 0x2c0, 0x26500
.long 0x68000, 0x900, 0x340, 0x26500, 0x68000, 0x900, 0x3c0, 0x26500
.long 0x68000, 0x900, 0x440, 0x25c10, 0x68000, 0x900, 0x4c0, 0x26500
.long 0x68000, 0x900, 0x540, 0x26500, 0x68000, 0x900, 0x5c0, 0x26500
.long 0x68000, 0x900, 0x80000000, 0x25c18, 0x68000, 0x900, 0x80000000, 0x26500
.long 0x68000, 0x900, 0x80000000, 0x26500, 0x68000, 0x900, 0x80000000, 0x26500
.long 0x68020, 0x910, 0x40, 0x25c20, 0x68020, 0x910, 0xc0, 0x26500
.long 0x68020, 0x910, 0x140, 0x26500, 0x68020, 0x910, 0x1c0, 0x26500
.long 0x68020, 0x910, 0x240, 0x25c28, 0x68020, 0x910, 0x2c0, 0x26500
.long 0x68020, 0x910, 0x340, 0x26500, 0x68020, 0x910, 0x3c0, 0x26500
.long 0x68020, 0x910, 0x440, 0x25c30, 0x68020, 0x910, 0x4c0, 0x26500
.long 0x68020, 0x910, 0x540, 0x26500, 0x68020, 0x910, 0x5c0, 0x26500
.long 0x68020, 0x910, 0x80000000, 0x25c38, 0x68020, 0x910, 0x80000000, 0x26500
.long 0x68020, 0x910, 0x80000000, 0x26500, 0x68020, 0x910, 0x80000000, 0x26500
.long 0x68040, 0x920, 0x40, 0x25c40, 0x68040, 0x920, 0xc0, 0x26500
.long 0x68040, 0x920, 0x140, 0x26500, 0x68040, 0x920, 0x1c0, 0x26500
.long 0x68040, 0x920, 0x240, 0x25c48, 0x68040, 0x920, 0x2c0, 0x26500
.long 0x68040, 0x920, 0x340, 0x26500, 0x68040, 0x920, 0x3c0, 0x26500
.long 0x68040, 0x920, 0x440, 0x25c50, 0x68040, 0x920, 0x4c0, 0x26500
.long 0x68040, 0x920, 0x540, 0x26500, 0x68040, 0x920, 0x5c0, 0x26500
.long 0x68040, 0x920, 0x80000000, 0x25c58, 0x68040, 0x920, 0x80000000, 0x26500
.long 0x68040, 0x920, 0x80000000, 0x26500, 0x68040, 0x920, 0x80000000, 0x26500
.long 0x68060, 0x930, 0x40, 0x25c60, 0x68060, 0x930, 0xc0, 0x26500
.long 0x68060, 0x930, 0x140, 0x26500, 0x68060, 0x930, 0x1c0, 0x26500
.long 0x68060, 0x930, 0x240, 0x25c68, 0x68060, 0x930, 0x2c0, 0x26500
.long 0x68060, 0x930, 0x340, 0x26500, 0x68060, 0x930, 0x3c0, 0x26500
.long 0x68060, 0x930, 0x440, 0x25c70, 0x68060, 0x930, 0x4c0, 0x26500
.long 0x68060, 0x930, 0x540, 0x26500, 0x68060, 0x930, 0x5c0, 0x26500
.long 0x68060, 0x930, 0x80000000, 0x25c78, 0x68060, 0x930, 0x80000000, 0x26500
.long 0x68060, 0x930, 0x80000000, 0x26500, 0x68060, 0x930, 0x80000000, 0x26500
.long 0x68000, 0x7e900, 0x12000, 0x26500, 0x68020, 0x7e910, 0x120c0, 0x26580
.long 0x68040, 0x7e920, 0x12180, 0x26600, 0x68060, 0x7e930, 0x12240, 0x26680
.long 0x68080, 0x7e940, 0x14040, 0x26700, 0x680a0, 0x7e950, 0x14050, 0x26780
.long 0x680c0, 0x7e960, 0x14060, 0x26500, 0x680e0, 0x7e970, 0x14070, 0x26580
.long 0x68100, 0x7e980, 0x14080, 0x26600, 0x68120, 0x7e990, 0x14090, 0x26680
.long 0x68140, 0x7e9a0, 0x140a0, 0x26700, 0x68160, 0x7e9b0, 0x140b0, 0x26780
.long 0x68000, 0x7e9c0, 0x140c0, 0x26500, 0x68020, 0x7e9d0, 0x140d0, 0x26580
.long 0x68040, 0x7e9e0, 0x140e0, 0x26600, 0x68060, 0x7e9f0, 0x140f0, 0x26680
.long 0x68080, 0x7ea00, 0x12010, 0x26700, 0x680a0, 0x7ea10, 0x120d0, 0x26780
.long 0x680c0, 0x7ea20, 0x12190, 0x26500, 0x680e0, 0x7ea30, 0x12250, 0x26580
.long 0x68100, 0x7ea40, 0x14140, 0x26600, 0x68120, 0x7ea50, 0x14150, 0x26680
.long 0x68140, 0x7ea60, 0x14160, 0x26700, 0x68160, 0x7ea70, 0x14170, 0x26780
.long 0x68000, 0x89100, 0x14180, 0x26500, 0x68020, 0x89110, 0x14190, 0x26580
.long 0x68040, 0x89120, 0x141a0, 0x26600, 0x68060, 0x89130, 0x141b0, 0x26680
.long 0x68080, 0x89140, 0x141c0, 0x26700, 0x680a0, 0x89150, 0x141d0, 0x26780
.long 0x680c0, 0x89160, 0x141e0, 0x26500, 0x680e0, 0x89170, 0x141f0, 0x26580
.long 0x68100, 0x89180, 0x12020, 0x26600, 0x68120, 0x89190, 0x120e0, 0x26680
.long 0x68140, 0x891a0, 0x121a0, 0x26700, 0x68160, 0x891b0, 0x12260, 0x26780
.long 0x68000, 0x891c0, 0x14240, 0x26500, 0x68020, 0x891d0, 0x14250, 0x26580
.long 0x68040, 0x891e0, 0x14260, 0x26600, 0x68060, 0x891f0, 0x14270, 0x26680
.long 0x68080, 0x89200, 0x14280, 0x26700, 0x680a0, 0x89210, 0x14290, 0x26780
.long 0x680c0, 0x89220, 0x142a0, 0x26500, 0x680e0, 0x89230, 0x142b0, 0x26580
.long 0x68100, 0x89240, 0x142c0, 0x26600, 0x68120, 0x89250, 0x142d0, 0x26680
.long 0x68140, 0x89260, 0x142e0, 0x26700, 0x68160, 0x89270, 0x142f0, 0x26780
.long 0x68000, 0x80000000, 0x12030, 0x26500, 0x68020, 0x80000000, 0x120f0, 0x26580
.long 0x68040, 0x80000000, 0x121b0, 0x26600, 0x68060, 0x80000000, 0x12270, 0x26680
.long 0x68080, 0x80000000, 0x14340, 0x26700, 0x680a0, 0x80000000, 0x14350, 0x26780
.long 0x680c0, 0x80000000, 0x14360, 0x26500, 0x680e0, 0x80000000, 0x14370, 0x26580
.long 0x68100, 0x80000000, 0x14380, 0x26600, 0x68120, 0x80000000, 0x14390, 0x26680
.long 0x68140, 0x80000000, 0x143a0, 0x26700, 0x68160, 0x80000000, 0x143b0, 0x26780
.long 0x68000, 0x80000000, 0x143c0, 0x26500, 0x68020, 0x80000000, 0x143d0, 0x26580
.long 0x68040, 0x80000000, 0x143e0, 0x26600, 0x68060, 0x80000000, 0x143f0, 0x26680
.long 0x68000, 0x80000000, 0x12600, 0x26500, 0x68020, 0x80000000, 0x126c0, 0x26580
.long 0x68040, 0x80000000, 0x12780, 0x26600, 0x68060, 0x80000000, 0x12840, 0x26680
.long 0x68080, 0x80000000, 0x14840, 0x26700, 0x680a0, 0x80000000, 0x14850, 0x26780
.long 0x680c0, 0x80000000, 0x14860, 0x26500, 0x680e0, 0x80000000, 0x14870, 0x26580
.long 0x68100, 0x80000000, 0x14880, 0x26600, 0x68120, 0x80000000, 0x14890, 0x26680
.long 0x68140, 0x80000000, 0x148a0, 0x26700, 0x68160, 0x80000000, 0x148b0, 0x26780
.long 0x68000, 0x80000000, 0x148c0, 0x26500, 0x68020, 0x80000000, 0x148d0, 0x26580
.long 0x68040, 0x80000000, 0x148e0, 0x26600, 0x68060, 0x80000000, 0x148f0, 0x26680
.long 0x68080, 0x80000000, 0x12610, 0x26700, 0x680a0, 0x80000000, 0x126d0, 0x26780
.long 0x680c0, 0x80000000, 0x12790, 0x26500, 0x680e0, 0x80000000, 0x12850, 0x26580
.long 0x68100, 0x80000000, 0x14940, 0x26600, 0x68120, 0x80000000, 0x14950, 0x26680
.long 0x68140, 0x80000000, 0x14960, 0x26700, 0x68160, 0x80000000, 0x14970, 0x26780
.long 0x68000, 0x80000000, 0x14980, 0x26500, 0x68020, 0x80000000, 0x14990, 0x26580
.long 0x68040, 0x80000000, 0x149a0, 0x26600, 0x68060, 0x80000000, 0x149b0, 0x26680
.long 0x68080, 0x80000000, 0x149c0, 0x26700, 0x680a0, 0x80000000, 0x149d0, 0x26780
.long 0x680c0, 0x80000000, 0x149e0, 0x26500, 0x680e0, 0x80000000, 0x149f0, 0x26580
.long 0x68100, 0x80000000, 0x12620, 0x26600, 0x68120, 0x80000000, 0x126e0, 0x26680
.long 0x68140, 0x80000000, 0x127a0, 0x26700, 0x68160, 0x80000000, 0x12860, 0x26780
.long 0x68000, 0x80000000, 0x14a40, 0x26500, 0x68020, 0x80000000, 0x14a50, 0x26580
.long 0x68040, 0x80000000, 0x14a60, 0x26600, 0x68060, 0x80000000, 0x14a70, 0x26680
.long 0x68080, 0x80000000, 0x14a80, 0x26700, 0x680a0, 0x80000000, 0x14a90, 0x26780
.long 0x680c0, 0x80000000, 0x14aa0, 0x26500, 0x680e0, 0x80000000, 0x14ab0, 0x26580
.long 0x68100, 0x80000000, 0x14ac0, 0x26600, 0x68120, 0x80000000, 0x14ad0, 0x26680
.long 0x68140, 0x80000000, 0x14ae0, 0x26700, 0x68160, 0x80000000, 0x14af0, 0x26780
.long 0x68000, 0x80000000, 0x12630, 0x26500, 0x68020, 0x80000000, 0x126f0, 0x26580
.long 0x68040, 0x80000000, 0x127b0, 0x26600, 0x68060, 0x80000000, 0x12870, 0x26680
.long 0x68080, 0x80000000, 0x14b40, 0x26700, 0x680a0, 0x80000000, 0x14b50, 0x26780
.long 0x680c0, 0x80000000, 0x14b60, 0x26500, 0x680e0, 0x80000000, 0x14b70, 0x26580
.long 0x68100, 0x80000000, 0x14b80, 0x26600, 0x68120, 0x80000000, 0x14b90, 0x26680
.long 0x68140, 0x80000000, 0x14ba0, 0x26700, 0x68160, 0x80000000, 0x14bb0, 0x26780
.long 0x68000, 0x80000000, 0x14bc0, 0x26500, 0x68020, 0x80000000, 0x14bd0, 0x26580
.long 0x68040, 0x80000000, 0x14be0, 0x26600, 0x68060, 0x80000000, 0x14bf0, 0x26680
.long 0x68000, 0x80000000, 0x12c00, 0x26500, 0x68020, 0x80000000, 0x12cc0, 0x26580
.long 0x68040, 0x80000000, 0x12d80, 0x26600, 0x68060, 0x80000000, 0x12e40, 0x26680
.long 0x68080, 0x80000000, 0x15040, 0x26700, 0x680a0, 0x80000000, 0x15050, 0x26780
.long 0x680c0, 0x80000000, 0x15060, 0x26500, 0x680e0, 0x80000000, 0x15070, 0x26580
.long 0x68100, 0x80000000, 0x15080, 0x26600, 0x68120, 0x80000000, 0x15090, 0x26680
.long 0x68140, 0x80000000, 0x150a0, 0x26700, 0x68160, 0x80000000, 0x150b0, 0x26780
.long 0x68000, 0x80000000, 0x150c0, 0x26500, 0x68020, 0x80000000, 0x150d0, 0x26580
.long 0x68040, 0x80000000, 0x150e0, 0x26600, 0x68060, 0x80000000, 0x150f0, 0x26680
.long 0x68080, 0x80000000, 0x12c10, 0x26700, 0x680a0, 0x80000000, 0x12cd0, 0x26780
.long 0x680c0, 0x80000000, 0x12d90, 0x26500, 0x680e0, 0x80000000, 0x12e50, 0x26580
.long 0x68100, 0x80000000, 0x15140, 0x26600, 0x68120, 0x80000000, 0x15150, 0x26680
.long 0x68140, 0x80000000, 0x15160, 0x26700, 0x68160, 0x80000000, 0x15170, 0x26780
.long 0x68000, 0x80000000, 0x15180, 0x26500, 0x68020, 0x80000000, 0x15190, 0x26580
.long 0x68040, 0x80000000, 0x151a0, 0x26600, 0x68060, 0x80000000, 0x151b0, 0x26680
.long 0x68080, 0x80000000, 0x151c0, 0x26700, 0x680a0, 0x80000000, 0x151d0, 0x26780
.long 0x680c0, 0x80000000, 0x151e0, 0x26500, 0x680e0, 0x80000000, 0x151f0, 0x26580
.long 0x68100, 0x80000000, 0x12c20, 0x26600, 0x68120, 0x80000000, 0x12ce0, 0x26680
.long 0x68140, 0x80000000, 0x12da0, 0x26700, 0x68160, 0x80000000, 0x12e60, 0x26780
.long 0x68000, 0x80000000, 0x15240, 0x26500, 0x68020, 0x80000000, 0x15250, 0x26580
.long 0x68040, 0x80000000, 0x15260, 0x26600, 0x68060, 0x80000000, 0x15270, 0x26680
.long 0x68080, 0x80000000, 0x15280, 0x26700, 0x680a0, 0x80000000, 0x15290, 0x26780
.long 0x680c0, 0x80000000, 0x152a0, 0x26500, 0x680e0, 0x80000000, 0x152b0, 0x26580
.long 0x68100, 0x80000000, 0x152c0, 0x26600, 0x68120, 0x80000000, 0x152d0, 0x26680
.long 0x68140, 0x80000000, 0x152e0, 0x26700, 0x68160, 0x80000000, 0x152f0, 0x26780
.long 0x68000, 0x80000000, 0x12c30, 0x26500, 0x68020, 0x80000000, 0x12cf0, 0x26580
.long 0x68040, 0x80000000, 0x12db0, 0x26600, 0x68060, 0x80000000, 0x12e70, 0x26680
.long 0x68080, 0x80000000, 0x15340, 0x26700, 0x680a0, 0x80000000, 0x15350, 0x26780
.long 0x680c0, 0x80000000, 0x15360, 0x26500, 0x680e0, 0x80000000, 0x15370, 0x26580
.long 0x68100, 0x80000000, 0x15380, 0x26600, 0x68120, 0x80000000, 0x15390, 0x26680
.long 0x68140, 0x80000000, 0x153a0, 0x26700, 0x68160, 0x80000000, 0x153b0, 0x26780
.long 0x68000, 0x80000000, 0x153c0, 0x26500, 0x68020, 0x80000000, 0x153d0, 0x26580
.long 0x68040, 0x80000000, 0x153e0, 0x26600, 0x68060, 0x80000000, 0x153f0, 0x26680
.long 0x68000, 0x80000000, 0x13200, 0x26500, 0x68020, 0x80000000, 0x132c0, 0x26580
.long 0x68040, 0x80000000, 0x13380, 0x26600, 0x68060, 0x80000000, 0x13440, 0x26680
.long 0x68080, 0x80000000, 0x15840, 0x26700, 0x680a0, 0x80000000, 0x15850, 0x26780
.long 0x680c0, 0x80000000, 0x15860, 0x26500, 0x680e0, 0x80000000, 0x15870, 0x26580
.long 0x68100, 0x80000000, 0x15880, 0x26600, 0x68120, 0x80000000, 0x15890, 0x26680
.long 0x68140, 0x80000000, 0x158a0, 0x26700, 0x68160, 0x80000000, 0x158b0, 0x26780
.long 0x68000, 0x80000000, 0x158c0, 0x26500, 0x68020, 0x80000000, 0x158d0, 0x26580
.long 0x68040, 0x80000000, 0x158e0, 0x26600, 0x68060, 0x80000000, 0x158f0, 0x26680
.long 0x68080, 0x80000000, 0x13210, 0x26700, 0x680a0, 0x80000000, 0x132d0, 0x26780
.long 0x680c0, 0x80000000, 0x13390, 0x26500, 0x680e0, 0x80000000, 0x13450, 0x26580
.long 0x68100, 0x80000000, 0x15940, 0x26600, 0x68120, 0x80000000, 0x15950, 0x26680
.long 0x68140, 0x80000000, 0x15960, 0x26700, 0x68160, 0x80000000, 0x15970, 0x26780
.long 0x68000, 0x80000000, 0x15980, 0x26500, 0x68020, 0x80000000, 0x15990, 0x26580
.long 0x68040, 0x80000000, 0x159a0, 0x26600, 0x68060, 0x80000000, 0x159b0, 0x26680
.long 0x68080, 0x80000000, 0x159c0, 0x26700, 0x680a0, 0x80000000, 0x159d0, 0x26780
.long 0x680c0, 0x80000000, 0x159e0, 0x26500, 0x680e0, 0x80000000, 0x159f0, 0x26580
.long 0x68100, 0x80000000, 0x13220, 0x26600, 0x68120, 0x80000000, 0x132e0, 0x26680
.long 0x68140, 0x80000000, 0x133a0, 0x26700, 0x68160, 0x80000000, 0x13460, 0x26780
.long 0x68000, 0x80000000, 0x15a40, 0x26500, 0x68020, 0x80000000, 0x15a50, 0x26580
.long 0x68040, 0x80000000, 0x15a60, 0x26600, 0x68060, 0x80000000, 0x15a70, 0x26680
.long 0x68080, 0x80000000, 0x15a80, 0x26700, 0x680a0, 0x80000000, 0x15a90, 0x26780
.long 0x680c0, 0x80000000, 0x15aa0, 0x26500, 0x680e0, 0x80000000, 0x15ab0, 0x26580
.long 0x68100, 0x80000000, 0x15ac0, 0x26600, 0x68120, 0x80000000, 0x15ad0, 0x26680
.long 0x68140, 0x80000000, 0x15ae0, 0x26700, 0x68160, 0x80000000, 0x15af0, 0x26780
.long 0x68000, 0x80000000, 0x13230, 0x26500, 0x68020, 0x80000000, 0x132f0, 0x26580
.long 0x68040, 0x80000000, 0x133b0, 0x26600, 0x68060, 0x80000000, 0x13470, 0x26680
.long 0x68080, 0x80000000, 0x15b40, 0x26700, 0x680a0, 0x80000000, 0x15b50, 0x26780
.long 0x680c0, 0x80000000, 0x15b60, 0x26500, 0x680e0, 0x80000000, 0x15b70, 0x26580
.long 0x68100, 0x80000000, 0x15b80, 0x26600, 0x68120, 0x80000000, 0x15b90, 0x26680
.long 0x68140, 0x80000000, 0x15ba0, 0x26700, 0x68160, 0x80000000, 0x15bb0, 0x26780
.long 0x68000, 0x80000000, 0x15bc0, 0x26500, 0x68020, 0x80000000, 0x15bd0, 0x26580
.long 0x68040, 0x80000000, 0x15be0, 0x26600, 0x68060, 0x80000000, 0x15bf0, 0x26680
.section .rodata,"a"
.p2align 6
.amdhsa_kernel standalone__modern_conv_block_slak__vision_kernel
  .amdhsa_next_free_vgpr 512
  .amdhsa_next_free_sgpr 102
  .amdhsa_accum_offset 256
  .amdhsa_group_segment_fixed_size 0
  .amdhsa_kernarg_size 72
  .amdhsa_user_sgpr_count 2
  .amdhsa_user_sgpr_kernarg_segment_ptr 1
  .amdhsa_system_sgpr_workgroup_id_x 1
  .amdhsa_float_denorm_mode_32 3
.end_amdhsa_kernel
```
